```python
import torch

def _softmax(x, axis=-1):
    return torch.softmax(x, dim=axis)

def _gelu(x):
    return torch.nn.functional.gelu(x, approximate='tanh')

def _silu(x):
    return torch.nn.functional.silu(x)

def _sigmoid(x):
    return torch.sigmoid(x)

def _layernorm(x, axis=-1, eps=1e-05):
    m = x.mean(dim=axis, keepdim=True)
    v = x.var(dim=axis, keepdim=True, unbiased=False)
    return (x - m) / torch.sqrt(v + eps)

def _scatter_add(tgt, idx, src, axis=0):
    return tgt.clone().index_add_(axis, idx, src)

def _segment_sum(src, seg, n):
    out = torch.zeros((n,) + src.shape[1:], dtype=src.dtype)
    return out.index_add_(0, seg, src)

def _pad(x, pw):
    flat = tuple((v for pair in reversed(pw) for v in pair))
    return torch.nn.functional.pad(x, flat)
kernel_name = 'standalone__dilated_atrous__vision'

def setup_inputs():

    _w = lambda a: (lambda t: t.to(torch.bfloat16) if t.is_floating_point() else t)(torch.as_tensor(a))
    H = W = 224
    C = 96
    k = 7
    return {'x': _w((lambda *s: torch.randn(*s, dtype=torch.bfloat16) * 0.05)(1, H, W, C)), 'w': _w((lambda *s: torch.randn(*s, dtype=torch.bfloat16) * 0.05)(k, k, C, C) * (1.0 / (k * C ** 0.5)))}

def reference(x, w):
    B, H, W, C = x.shape
    k = 7
    rate = 2
    pad = (k - 1) * rate // 2
    xp = _pad(x, ((0, 0), (pad, pad), (pad, pad), (0, 0)))
    out = torch.zeros_like(x)
    for i in range(k):
        for j in range(k):
            tap = xp[:, i * rate:i * rate + H, j * rate:j * rate + W, :].clone()
            out = out + torch.einsum('bhwc,co->bhwo', tap, w[i, j])
    return out
```

```asm
; @launch grid=(256,1,1) block=(512,1,1) lds=152576
.amdgcn_target "amdgcn-amd-amdhsa--gfx950"
.text
.globl standalone__dilated_atrous__vision_kernel
.p2align 8
.type standalone__dilated_atrous__vision_kernel,@function
standalone__dilated_atrous__vision_kernel:
    s_load_dwordx4 s[4:7], s[0:1], 0
    s_load_dwordx2 s[8:9], s[0:1], 16
    v_lshrrev_b32 v172, 6, v0
    v_and_b32 v179, 63, v0
    v_readfirstlane_b32 s24, v172
    s_cmp_ge_u32 s2, 256
    s_cbranch_scc1 L_EXIT
    s_bfe_u32 s44, s2, 0x20001
    s_and_b32 s45, s2, 1
    s_lshr_b32 s46, s2, 3
    s_cmp_eq_u32 s45, 1
    s_cbranch_scc1 L_LIGHT
    s_sub_u32 s47, s46, 21
    s_cmp_lt_u32 s46, 21
    s_cselect_b32 s47, s46, s47
    s_cselect_b32 s30, 0, 38
    s_mov_b32 s26, 0
    s_mov_b32 s32, 44
    s_branch L_MAPPED
L_LIGHT:
    s_cmp_ge_u32 s46, 31
    s_cbranch_scc1 L_EXIT
    s_lshr_b32 s47, s46, 1
    s_add_u32 s47, s47, 11
    s_and_b32 s30, s46, 1
    s_mul_i32 s30, s30, 37
    s_add_u32 s30, s30, 38
    s_mov_b32 s26, 1
    s_mov_b32 s32, 43
    s_cmp_lt_u32 s46, 20
    s_cbranch_scc1 L_MAPPED
    s_sub_u32 s47, s46, 20
    s_mov_b32 s30, 76
    s_mov_b32 s26, 2
    s_mov_b32 s32, 42
L_MAPPED:
    s_mul_i32 s45, s47, 43
    s_lshr_b32 s45, s45, 7
    s_mul_i32 s46, s45, 3
    s_sub_u32 s31, s47, s46
    s_mul_i32 s25, s44, 7
    s_add_u32 s25, s25, s45
    s_lshr_b32 s27, s25, 2
    s_and_b32 s29, s25, 1
    s_bfe_u32 s28, s25, 0x10001
    s_cmp_lt_u32 s24, 4
    s_cbranch_scc1 L_CONS
    s_setprio 3
    s_sub_u32 s35, s24, 4
    s_cmp_eq_u32 s29, 0
    s_cselect_b32 s34, 2, 0
    v_lshrrev_b32 v172, 4, v179
    v_bfe_u32 v173, v179, 2, 2
    v_lshl_add_u32 v173, v172, 3, v173
    s_and_b32 s44, s35, 1
    s_lshl_b32 s45, s44, 2
    v_add_u32 v173, s45, v173
    v_mul_u32_u24 v173, 192, v173
    v_and_b32 v172, 1, v172
    v_lshlrev_b32 v172, 1, v172
    v_and_b32 v174, 3, v179
    v_xor_b32 v174, v174, v172
    v_lshl_add_u32 v171, v174, 4, v173
    s_lshl_b32 s44, s44, 10
    s_lshr_b32 s45, s35, 1
    s_lshl_b32 s46, s45, 11
    s_add_u32 s52, s44, s46
    s_add_u32 s52, s52, 123904
    s_add_u32 s46, s52, 14336
    s_xor_b32 s53, s52, s46
    s_mul_i32 s61, s34, 6144
    s_lshl_b32 s44, s31, 6
    s_add_u32 s61, s61, s44
    s_mul_i32 s45, s45, 129024
    s_add_u32 s61, s61, s45
    s_mov_b32 s48, 0
    s_lshl_b32 s62, s34, 6
    v_lshrrev_b32 v172, 2, v179
    v_and_b32 v174, 4, v172
    v_lshrrev_b32 v174, 1, v174
    v_and_b32 v175, 3, v179
    v_xor_b32 v174, v174, v175
    v_lshlrev_b32 v174, 4, v174
    v_mul_u32_u24 v175, 384, v172
    v_add_u32 v174, v174, v175
    s_lshl_b32 s47, s27, 4
    s_sub_u32 s47, s47, 3
    v_add_u32 v172, s47, v172
    v_cmp_gt_u32 vcc, 112, v172
    v_mov_b32 v172, 0x40000000
    s_nop 0
    v_cndmask_b32 v177, v172, v174, vcc
    s_lshl_b32 s44, s30, 1
    s_add_u32 s44, s44, s28
    s_sub_u32 s44, s44, 6
    s_mul_i32 s44, s44, 43008
    s_lshl_b32 s45, s27, 5
    s_add_u32 s45, s45, s29
    s_sub_u32 s45, s45, 6
    s_mul_i32 s45, s45, 192
    s_add_u32 s33, s44, s45
    s_mul_i32 s63, s35, 9
    s_cmp_eq_u32 s26, 0
    s_cselect_b32 s44, 1, 0
    s_lshr_b32 s45, s35, 1
    s_and_b32 s45, s45, s44
    s_add_u32 s63, s63, s45
    s_mov_b32 s18, 903168
    s_mov_b32 s19, 0x00020000
    s_mov_b32 s14, 9633792
    s_mov_b32 s15, 0x00020000
    s_waitcnt lgkmcnt(0)
    s_mov_b32 s16, s6
    s_mov_b32 s17, s7
    s_mov_b32 s12, s4
    s_mov_b32 s13, s5
    s_add_u32 m0, s52, 0
    s_add_u32 s57, s61, 0
    buffer_load_dwordx4 v171, s[16:19], s57 offen lds
    s_mul_i32 s90, s63, 86016
    s_add_u32 s90, s90, s33
    s_add_u32 s90, s90, s62
    s_mul_i32 s91, s63, 1408
    s_add_u32 m0, s91, 0
    v_add_u32 v176, s90, v177
    buffer_load_dwordx4 v176, s[12:15], 0 offen lds
    s_add_u32 s90, s90, 86016
    s_add_u32 s91, s91, 1408
    s_add_u32 m0, s91, 0
    v_add_u32 v176, s90, v177
    buffer_load_dwordx4 v176, s[12:15], 0 offen lds
    s_add_u32 s90, s90, 86016
    s_add_u32 s91, s91, 1408
    s_add_u32 m0, s52, 4096
    s_add_u32 s57, s61, 258048
    buffer_load_dwordx4 v171, s[16:19], s57 offen lds
    s_add_u32 m0, s91, 0
    v_add_u32 v176, s90, v177
    buffer_load_dwordx4 v176, s[12:15], 0 offen lds
    s_add_u32 s90, s90, 86016
    s_add_u32 s91, s91, 1408
    s_add_u32 m0, s91, 0
    v_add_u32 v176, s90, v177
    buffer_load_dwordx4 v176, s[12:15], 0 offen lds
    s_add_u32 s90, s90, 86016
    s_add_u32 s91, s91, 1408
    s_add_u32 s58, s35, 36
    s_add_u32 s59, s35, 40
    s_lshl_b32 s46, s26, 4
    s_add_u32 s46, s46, s35
    s_cmp_eq_u32 s46, 0
    s_cselect_b32 s58, 18, s58
    v_lshrrev_b32 v172, 2, v179
    v_add_u32 v172, 16, v172
    v_and_b32 v174, 4, v172
    v_lshrrev_b32 v174, 1, v174
    v_and_b32 v175, 3, v179
    v_xor_b32 v174, v174, v175
    v_lshlrev_b32 v174, 4, v174
    v_mul_u32_u24 v175, 384, v172
    v_add_u32 v174, v174, v175
    s_lshl_b32 s47, s27, 4
    s_sub_u32 s47, s47, 3
    v_add_u32 v172, s47, v172
    v_cmp_gt_u32 vcc, 112, v172
    v_mov_b32 v172, 0x40000000
    s_nop 0
    v_cndmask_b32 v178, v172, v174, vcc
    s_waitcnt vmcnt(3)
    s_barrier
    s_add_u32 m0, s52, 8192
    s_add_u32 s57, s61, 516096
    buffer_load_dwordx4 v171, s[16:19], s57 offen lds
    s_add_u32 m0, s91, 0
    v_add_u32 v176, s90, v177
    buffer_load_dwordx4 v176, s[12:15], 0 offen lds
    s_add_u32 s90, s90, 86016
    s_add_u32 s91, s91, 1408
    s_add_u32 m0, s91, 0
    v_add_u32 v176, s90, v177
    buffer_load_dwordx4 v176, s[12:15], 0 offen lds
    s_add_u32 s90, s90, 86016
    s_add_u32 s91, s91, 1408
    s_waitcnt vmcnt(3)
    s_barrier
    s_cmp_ge_u32 s35, 2
    s_cbranch_scc1 WM_0
    s_add_u32 m0, s52, 12288
    s_add_u32 s57, s61, 774144
    buffer_load_dwordx4 v171, s[16:19], s57 offen lds
WM_0:
    s_add_u32 m0, s91, 0
    v_add_u32 v176, s90, v177
    buffer_load_dwordx4 v176, s[12:15], 0 offen lds
    s_add_u32 s90, s90, 86016
    s_add_u32 s91, s91, 1408
    s_add_u32 m0, s91, 0
    v_add_u32 v176, s90, v177
    buffer_load_dwordx4 v176, s[12:15], 0 offen lds
    s_add_u32 s90, s90, 86016
    s_add_u32 s91, s91, 1408
    s_add_u32 s48, s48, 1
    s_add_u32 s61, s61, 18432
    s_cmp_lg_u32 s48, 7
    s_cbranch_scc1 WADV_1
    s_mov_b32 s48, 0
    s_sub_u32 s61, s61, 122880
    s_add_u32 s34, s34, 1
    s_cmp_lg_u32 s34, 3
    s_cbranch_scc1 WADV_1
    s_mov_b32 s34, 0
    s_sub_u32 s61, s61, 18432
WADV_1:
    s_xor_b32 s52, s52, s53
    s_waitcnt vmcnt(2)
    s_barrier
    s_add_u32 m0, s91, 0
    v_add_u32 v176, s90, v177
    buffer_load_dwordx4 v176, s[12:15], 0 offen lds
    s_add_u32 s90, s90, 86016
    s_add_u32 s91, s91, 1408
    s_add_u32 s45, s58, 0
    s_mul_i32 s46, s45, 86016
    s_add_u32 s46, s46, s33
    s_add_u32 s46, s46, s62
    s_mul_i32 s56, s45, 1408
    s_add_u32 m0, s56, 0
    v_add_u32 v176, s46, v177
    buffer_load_dwordx4 v176, s[12:15], 0 offen lds
    s_cmp_ge_u32 s59, s32
    s_cbranch_scc1 XR_2
    s_add_u32 s45, s59, 0
    s_mul_i32 s46, s45, 86016
    s_add_u32 s46, s46, s33
    s_add_u32 s46, s46, s62
    s_mul_i32 s56, s45, 1408
    s_add_u32 m0, s56, 0
    v_add_u32 v176, s46, v177
    buffer_load_dwordx4 v176, s[12:15], 0 offen lds
XR_2:
    s_mov_b32 s49, 255
    s_branch PL_WISSUE
PL_RETA:
    s_waitcnt vmcnt(5)
    s_barrier
    s_mov_b32 exec_lo, 0x000000ff
    s_mov_b32 exec_hi, 0
    s_mul_i32 s92, s63, 86016
    s_add_u32 s92, s92, s33
    s_add_u32 s92, s92, s62
    s_mul_i32 s93, s63, 1408
    s_add_u32 m0, s93, 1024
    v_add_u32 v176, s92, v178
    buffer_load_dwordx4 v176, s[12:15], 0 offen lds
    s_add_u32 s92, s92, 86016
    s_add_u32 s93, s93, 1408
    s_add_u32 m0, s93, 1024
    v_add_u32 v176, s92, v178
    buffer_load_dwordx4 v176, s[12:15], 0 offen lds
    s_add_u32 s92, s92, 86016
    s_add_u32 s93, s93, 1408
    s_add_u32 m0, s93, 1024
    v_add_u32 v176, s92, v178
    buffer_load_dwordx4 v176, s[12:15], 0 offen lds
    s_add_u32 s92, s92, 86016
    s_add_u32 s93, s93, 1408
    s_add_u32 m0, s93, 1024
    v_add_u32 v176, s92, v178
    buffer_load_dwordx4 v176, s[12:15], 0 offen lds
    s_add_u32 s92, s92, 86016
    s_add_u32 s93, s93, 1408
    s_add_u32 m0, s93, 1024
    v_add_u32 v176, s92, v178
    buffer_load_dwordx4 v176, s[12:15], 0 offen lds
    s_add_u32 s92, s92, 86016
    s_add_u32 s93, s93, 1408
    s_add_u32 m0, s93, 1024
    v_add_u32 v176, s92, v178
    buffer_load_dwordx4 v176, s[12:15], 0 offen lds
    s_add_u32 s92, s92, 86016
    s_add_u32 s93, s93, 1408
    s_add_u32 m0, s93, 1024
    v_add_u32 v176, s92, v178
    buffer_load_dwordx4 v176, s[12:15], 0 offen lds
    s_add_u32 s92, s92, 86016
    s_add_u32 s93, s93, 1408
    s_add_u32 m0, s93, 1024
    v_add_u32 v176, s92, v178
    buffer_load_dwordx4 v176, s[12:15], 0 offen lds
    s_add_u32 s92, s92, 86016
    s_add_u32 s93, s93, 1408
    s_add_u32 m0, s93, 1024
    v_add_u32 v176, s92, v178
    buffer_load_dwordx4 v176, s[12:15], 0 offen lds
    s_add_u32 s92, s92, 86016
    s_add_u32 s93, s93, 1408
    s_add_u32 s45, s58, 0
    s_mul_i32 s46, s45, 86016
    s_add_u32 s46, s46, s33
    s_add_u32 s46, s46, s62
    s_mul_i32 s56, s45, 1408
    s_add_u32 m0, s56, 1024
    v_add_u32 v176, s46, v178
    buffer_load_dwordx4 v176, s[12:15], 0 offen lds
    s_cmp_ge_u32 s59, s32
    s_cbranch_scc1 XR_3
    s_add_u32 s45, s59, 0
    s_mul_i32 s46, s45, 86016
    s_add_u32 s46, s46, s33
    s_add_u32 s46, s46, s62
    s_mul_i32 s56, s45, 1408
    s_add_u32 m0, s56, 1024
    v_add_u32 v176, s46, v178
    buffer_load_dwordx4 v176, s[12:15], 0 offen lds
XR_3:
    s_mov_b64 exec, -1
    s_waitcnt vmcnt(13)
    s_barrier
    s_waitcnt vmcnt(11)
    s_barrier
    s_waitcnt vmcnt(0)
    s_barrier
    s_mov_b32 s49, 0
    s_branch PL_WISSUE
PL_RET0:
    s_waitcnt vmcnt(13)
    s_barrier
    s_setprio 0
    s_mov_b32 exec_lo, 0x00ffff00
    s_mov_b32 exec_hi, 0
    s_mul_i32 s92, s63, 86016
    s_add_u32 s92, s92, s33
    s_add_u32 s92, s92, s62
    s_mul_i32 s93, s63, 1408
    s_add_u32 m0, s93, 1024
    v_add_u32 v176, s92, v178
    buffer_load_dwordx4 v176, s[12:15], 0 offen lds
    s_add_u32 s92, s92, 86016
    s_add_u32 s93, s93, 1408
    s_add_u32 m0, s93, 1024
    v_add_u32 v176, s92, v178
    buffer_load_dwordx4 v176, s[12:15], 0 offen lds
    s_add_u32 s92, s92, 86016
    s_add_u32 s93, s93, 1408
    s_add_u32 m0, s93, 1024
    v_add_u32 v176, s92, v178
    buffer_load_dwordx4 v176, s[12:15], 0 offen lds
    s_add_u32 s92, s92, 86016
    s_add_u32 s93, s93, 1408
    s_add_u32 m0, s93, 1024
    v_add_u32 v176, s92, v178
    buffer_load_dwordx4 v176, s[12:15], 0 offen lds
    s_add_u32 s92, s92, 86016
    s_add_u32 s93, s93, 1408
    s_add_u32 m0, s93, 1024
    v_add_u32 v176, s92, v178
    buffer_load_dwordx4 v176, s[12:15], 0 offen lds
    s_add_u32 s92, s92, 86016
    s_add_u32 s93, s93, 1408
    s_add_u32 m0, s93, 1024
    v_add_u32 v176, s92, v178
    buffer_load_dwordx4 v176, s[12:15], 0 offen lds
    s_add_u32 s92, s92, 86016
    s_add_u32 s93, s93, 1408
    s_add_u32 m0, s93, 1024
    v_add_u32 v176, s92, v178
    buffer_load_dwordx4 v176, s[12:15], 0 offen lds
    s_add_u32 s92, s92, 86016
    s_add_u32 s93, s93, 1408
    s_add_u32 m0, s93, 1024
    v_add_u32 v176, s92, v178
    buffer_load_dwordx4 v176, s[12:15], 0 offen lds
    s_add_u32 s92, s92, 86016
    s_add_u32 s93, s93, 1408
    s_add_u32 m0, s93, 1024
    v_add_u32 v176, s92, v178
    buffer_load_dwordx4 v176, s[12:15], 0 offen lds
    s_add_u32 s92, s92, 86016
    s_add_u32 s93, s93, 1408
    s_add_u32 s45, s58, 0
    s_mul_i32 s46, s45, 86016
    s_add_u32 s46, s46, s33
    s_add_u32 s46, s46, s62
    s_mul_i32 s56, s45, 1408
    s_add_u32 m0, s56, 1024
    v_add_u32 v176, s46, v178
    buffer_load_dwordx4 v176, s[12:15], 0 offen lds
    s_cmp_ge_u32 s59, s32
    s_cbranch_scc1 XR_4
    s_add_u32 s45, s59, 0
    s_mul_i32 s46, s45, 86016
    s_add_u32 s46, s46, s33
    s_add_u32 s46, s46, s62
    s_mul_i32 s56, s45, 1408
    s_add_u32 m0, s56, 1024
    v_add_u32 v176, s46, v178
    buffer_load_dwordx4 v176, s[12:15], 0 offen lds
XR_4:
    s_mov_b64 exec, -1
    s_add_u32 s62, s62, 64
    s_cmp_eq_u32 s62, 192
    s_cselect_b32 s62, 0, s62
    s_mov_b32 s26, 61952
    s_mov_b32 s49, 1
    s_waitcnt vmcnt(10)
    s_branch PL_BAR
PL:
    s_cmp_eq_u32 s60, 1
    s_cbranch_scc1 PL_W4
    s_waitcnt vmcnt(0)
PL_W4:
    s_waitcnt vmcnt(4)
PL_BAR:
    s_barrier
    s_mov_b32 s60, 0
    s_cmp_gt_u32 s49, 18
    s_cbranch_scc1 PLN
PL_WISSUE:
    s_add_u32 m0, s52, 0
    s_add_u32 s57, s61, 0
    buffer_load_dwordx4 v171, s[16:19], s57 offen lds
    s_add_u32 m0, s52, 4096
    s_add_u32 s57, s61, 258048
    buffer_load_dwordx4 v171, s[16:19], s57 offen lds
    s_add_u32 m0, s52, 8192
    s_add_u32 s57, s61, 516096
    buffer_load_dwordx4 v171, s[16:19], s57 offen lds
    s_cmp_ge_u32 s35, 2
    s_cbranch_scc1 WM_5
    s_add_u32 m0, s52, 12288
    s_add_u32 s57, s61, 774144
    buffer_load_dwordx4 v171, s[16:19], s57 offen lds
WM_5:
    s_add_u32 s48, s48, 1
    s_add_u32 s61, s61, 18432
    s_cmp_lg_u32 s48, 7
    s_cbranch_scc1 WADV_6
    s_mov_b32 s48, 0
    s_sub_u32 s61, s61, 122880
    s_add_u32 s34, s34, 1
    s_cmp_lg_u32 s34, 3
    s_cbranch_scc1 WADV_6
    s_mov_b32 s34, 0
    s_sub_u32 s61, s61, 18432
WADV_6:
    s_xor_b32 s52, s52, s53
    s_cmp_eq_u32 s49, 0
    s_cbranch_scc1 PL_RET0
    s_cmp_eq_u32 s49, 255
    s_cbranch_scc1 PL_RETA
PLN:
    s_lshl_b32 s47, 1, s49
    s_and_b32 s44, s47, 130
    s_cbranch_scc0 PX_NOINIT
    s_mul_i32 s90, s63, 86016
    s_add_u32 s90, s90, s33
    s_add_u32 s90, s90, s62
    s_mul_i32 s91, s63, 1408
    s_add_u32 s91, s91, s26
    s_mov_b32 s92, s90
    s_mov_b32 s93, s91
PX_NOINIT:
    s_and_b32 s44, s47, 4030
    s_cbranch_scc0 PX_DONE
    s_add_u32 m0, s91, 0
    v_add_u32 v176, s90, v177
    buffer_load_dwordx4 v176, s[12:15], 0 offen lds
    s_add_u32 s90, s90, 86016
    s_add_u32 s91, s91, 1408
    s_mov_b32 exec_lo, 0x00ffffff
    s_mov_b32 exec_hi, 0
    s_add_u32 m0, s93, 1024
    v_add_u32 v176, s92, v178
    buffer_load_dwordx4 v176, s[12:15], 0 offen lds
    s_add_u32 s92, s92, 86016
    s_add_u32 s93, s93, 1408
    s_mov_b64 exec, -1
    s_and_b32 s44, s47, 2080
    s_cbranch_scc1 PX_EXTRA
    s_add_u32 m0, s91, 0
    v_add_u32 v176, s90, v177
    buffer_load_dwordx4 v176, s[12:15], 0 offen lds
    s_add_u32 s90, s90, 86016
    s_add_u32 s91, s91, 1408
    s_mov_b32 exec_lo, 0x00ffffff
    s_mov_b32 exec_hi, 0
    s_add_u32 m0, s93, 1024
    v_add_u32 v176, s92, v178
    buffer_load_dwordx4 v176, s[12:15], 0 offen lds
    s_add_u32 s92, s92, 86016
    s_add_u32 s93, s93, 1408
    s_mov_b64 exec, -1
    s_mov_b32 s60, 1
    s_branch PX_DONE
PX_EXTRA:
    s_mul_i32 s46, s58, 86016
    s_add_u32 s46, s46, s33
    s_add_u32 s46, s46, s62
    s_mul_i32 s56, s58, 1408
    s_add_u32 s56, s56, s26
    s_add_u32 m0, s56, 0
    v_add_u32 v176, s46, v177
    buffer_load_dwordx4 v176, s[12:15], 0 offen lds
    s_mov_b32 exec_lo, 0x00ffffff
    s_mov_b32 exec_hi, 0
    s_mul_i32 s46, s58, 86016
    s_add_u32 s46, s46, s33
    s_add_u32 s46, s46, s62
    s_mul_i32 s56, s58, 1408
    s_add_u32 s56, s56, s26
    s_add_u32 m0, s56, 1024
    v_add_u32 v176, s46, v178
    buffer_load_dwordx4 v176, s[12:15], 0 offen lds
    s_mov_b64 exec, -1
    s_cmp_ge_u32 s59, s32
    s_cbranch_scc1 PX_E2
    s_mul_i32 s46, s59, 86016
    s_add_u32 s46, s46, s33
    s_add_u32 s46, s46, s62
    s_mul_i32 s56, s59, 1408
    s_add_u32 s56, s56, s26
    s_add_u32 m0, s56, 0
    v_add_u32 v176, s46, v177
    buffer_load_dwordx4 v176, s[12:15], 0 offen lds
    s_mov_b32 exec_lo, 0x00ffffff
    s_mov_b32 exec_hi, 0
    s_mul_i32 s46, s59, 86016
    s_add_u32 s46, s46, s33
    s_add_u32 s46, s46, s62
    s_mul_i32 s56, s59, 1408
    s_add_u32 s56, s56, s26
    s_add_u32 m0, s56, 1024
    v_add_u32 v176, s46, v178
    buffer_load_dwordx4 v176, s[12:15], 0 offen lds
    s_mov_b64 exec, -1
PX_E2:
    s_add_u32 s62, s62, 64
    s_cmp_eq_u32 s62, 192
    s_cselect_b32 s62, 0, s62
    s_mov_b32 s26, 0
    s_cmp_eq_u32 s49, 11
    s_cselect_b32 s60, 1, 0
PX_DONE:
    s_add_u32 s49, s49, 1
    s_cmp_le_u32 s49, 20
    s_cbranch_scc1 PL
    s_barrier
L_EXIT:
    s_endpgm
.p2align 6
L_CONS:
    v_and_b32 v167, 15, v179
    v_lshrrev_b32 v172, 4, v179
    v_lshlrev_b32 v168, 4, v172
    v_lshrrev_b32 v173, 2, v179
    v_lshlrev_b32 v173, 6, v173
    v_and_b32 v174, 1, v172
    v_lshl_add_u32 v173, v174, 5, v173
    v_and_b32 v174, 3, v179
    v_lshl_add_u32 v169, v174, 3, v173
    s_mul_i32 s44, s24, 9
    s_cmp_eq_u32 s26, 0
    s_cselect_b32 s45, 1, 0
    s_lshr_b32 s46, s24, 1
    s_and_b32 s45, s45, s46
    s_add_u32 s44, s44, s45
    s_mov_b32 s52, 123904
    s_mov_b32 s53, 260096
    v_add_u32 v165, s52, v169
    v_xor_b32 v166, 32, v165
    s_mul_i32 s50, s44, 1408
    s_add_u32 s46, s50, 61952
    s_xor_b32 s51, s50, s46
    s_mov_b32 s48, 0
    s_mov_b32 s49, 1
    v_add_u32 v172, s48, v167
    v_and_b32 v173, 4, v172
    v_lshlrev_b32 v173, 3, v173
    v_xor_b32 v173, v173, v168
    v_lshl_add_u32 v173, v172, 6, v173
    v_add_u32 v164, s50, v173
    s_add_u32 s44, s44, s30
    s_lshl_b32 s44, s44, 1
    s_add_u32 s44, s44, s28
    s_mul_i32 s44, s44, 43008
    s_lshl_b32 s45, s27, 5
    s_add_u32 s45, s45, s29
    s_mul_i32 s45, s45, 192
    s_add_u32 s44, s44, s45
    s_lshl_b32 s45, s31, 6
    s_add_u32 s44, s44, s45
    v_mul_u32_u24 v172, 384, v167
    v_lshrrev_b32 v173, 1, v168
    v_add_u32 v172, v172, v173
    v_add_u32 v180, s44, v172
    s_mul_i32 s45, s24, 7168
    s_add_u32 s45, s45, 123904
    v_mul_u32_u24 v172, 80, v167
    v_lshrrev_b32 v174, 1, v168
    v_add_u32 v172, v172, v174
    v_add_u32 v181, s45, v172
    v_lshrrev_b32 v172, 2, v179
    v_and_b32 v174, 3, v179
    v_lshlrev_b32 v174, 4, v174
    v_mul_u32_u24 v175, 80, v172
    v_add3_u32 v182, v175, v174, s45
    v_mul_u32_u24 v175, 384, v172
    v_add3_u32 v183, v175, v174, s44
    v_lshlrev_b32 v172, 4, v179
    v_add_u32 v184, 61952, v172
    s_waitcnt lgkmcnt(0)
    s_mov_b32 s20, s8
    s_mov_b32 s21, s9
    s_mov_b32 s22, 9633792
    s_mov_b32 s23, 0x00020000
    s_setprio 3
    s_cmp_eq_u32 s26, 2
    s_cbranch_scc1 C_PC
    s_cmp_eq_u32 s26, 1
    s_cbranch_scc1 L_K37
    s_bitcmp1_b32 s24, 0
    s_cbranch_scc1 C_PB
    s_branch C_PA
L_K37:
    s_cmp_eq_u32 s24, 0
    s_cbranch_scc1 C_Q0
    s_cmp_eq_u32 s24, 1
    s_cbranch_scc1 C_Q1
    s_cmp_eq_u32 s24, 2
    s_cbranch_scc1 C_Q2
    s_branch C_Q3
.p2align 6
C_PA:
    s_barrier
    ds_read_b64_tr_b16 v[76:77], v165 offset:0
    ds_read_b64_tr_b16 v[78:79], v165 offset:1024
    ds_read_b128 v[132:135], v164 offset:0
    ds_read_b64_tr_b16 v[80:81], v166 offset:0
    ds_read_b64_tr_b16 v[82:83], v166 offset:1024
    ds_read_b128 v[136:139], v164 offset:1408
    ds_read_b64_tr_b16 v[84:85], v165 offset:2048
    ds_read_b64_tr_b16 v[86:87], v165 offset:3072
    ds_read_b64_tr_b16 v[88:89], v166 offset:2048
    ds_read_b64_tr_b16 v[90:91], v166 offset:3072
    s_waitcnt lgkmcnt(7)
    v_mfma_f32_16x16x32_bf16 v[0:3], v[76:79], v[132:135], 0
    s_waitcnt lgkmcnt(5)
    v_mfma_f32_16x16x32_bf16 v[4:7], v[80:83], v[132:135], 0
    s_barrier
    ds_read_b128 v[140:143], v164 offset:2816
    s_waitcnt lgkmcnt(5)
    v_mfma_f32_16x16x32_bf16 v[8:11], v[76:79], v[136:139], 0
    ds_read_b64_tr_b16 v[92:93], v165 offset:4096
    ds_read_b64_tr_b16 v[94:95], v165 offset:5120
    v_mfma_f32_16x16x32_bf16 v[12:15], v[80:83], v[136:139], 0
    ds_read_b64_tr_b16 v[96:97], v166 offset:4096
    ds_read_b64_tr_b16 v[98:99], v166 offset:5120
    s_waitcnt lgkmcnt(7)
    v_mfma_f32_16x16x32_bf16 v[0:3], v[84:87], v[136:139], v[0:3]
    ds_read_b128 v[144:147], v164 offset:4224
    ds_read_b64_tr_b16 v[100:101], v165 offset:6144
    s_waitcnt lgkmcnt(7)
    v_mfma_f32_16x16x32_bf16 v[4:7], v[88:91], v[136:139], v[4:7]
    ds_read_b64_tr_b16 v[102:103], v165 offset:7168
    ds_read_b64_tr_b16 v[104:105], v166 offset:6144
    s_waitcnt lgkmcnt(8)
    v_mfma_f32_16x16x32_bf16 v[16:19], v[76:79], v[140:143], 0
    ds_read_b64_tr_b16 v[106:107], v166 offset:7168
    v_mfma_f32_16x16x32_bf16 v[20:23], v[80:83], v[140:143], 0
    v_mfma_f32_16x16x32_bf16 v[8:11], v[84:87], v[140:143], v[8:11]
    v_mfma_f32_16x16x32_bf16 v[12:15], v[88:91], v[140:143], v[12:15]
    s_waitcnt lgkmcnt(7)
    v_mfma_f32_16x16x32_bf16 v[0:3], v[92:95], v[140:143], v[0:3]
    s_waitcnt lgkmcnt(5)
    v_mfma_f32_16x16x32_bf16 v[4:7], v[96:99], v[140:143], v[4:7]
    s_barrier
    s_waitcnt lgkmcnt(4)
    v_mfma_f32_16x16x32_bf16 v[24:27], v[76:79], v[144:147], 0
    ds_read_b128 v[148:151], v164 offset:5632
    ds_read_b64_tr_b16 v[108:109], v165 offset:8192
    v_mfma_f32_16x16x32_bf16 v[28:31], v[80:83], v[144:147], 0
    ds_read_b64_tr_b16 v[110:111], v165 offset:9216
    ds_read_b64_tr_b16 v[112:113], v166 offset:8192
    v_mfma_f32_16x16x32_bf16 v[16:19], v[84:87], v[144:147], v[16:19]
    ds_read_b64_tr_b16 v[114:115], v166 offset:9216
    ds_read_b128 v[152:155], v164 offset:7040
    v_mfma_f32_16x16x32_bf16 v[20:23], v[88:91], v[144:147], v[20:23]
    ds_read_b64_tr_b16 v[116:117], v165 offset:10240
    ds_read_b64_tr_b16 v[118:119], v165 offset:11264
    v_mfma_f32_16x16x32_bf16 v[8:11], v[92:95], v[144:147], v[8:11]
    ds_read_b64_tr_b16 v[120:121], v166 offset:10240
    ds_read_b64_tr_b16 v[122:123], v166 offset:11264
    v_mfma_f32_16x16x32_bf16 v[12:15], v[96:99], v[144:147], v[12:15]
    s_waitcnt lgkmcnt(10)
    v_mfma_f32_16x16x32_bf16 v[0:3], v[100:103], v[144:147], v[0:3]
    v_mfma_f32_16x16x32_bf16 v[4:7], v[104:107], v[144:147], v[4:7]
    s_waitcnt lgkmcnt(9)
    v_mfma_f32_16x16x32_bf16 v[32:35], v[76:79], v[148:151], 0
    v_mfma_f32_16x16x32_bf16 v[36:39], v[80:83], v[148:151], 0
    v_mfma_f32_16x16x32_bf16 v[24:27], v[84:87], v[148:151], v[24:27]
    v_mfma_f32_16x16x32_bf16 v[28:31], v[88:91], v[148:151], v[28:31]
    v_mfma_f32_16x16x32_bf16 v[16:19], v[92:95], v[148:151], v[16:19]
    v_mfma_f32_16x16x32_bf16 v[20:23], v[96:99], v[148:151], v[20:23]
    v_mfma_f32_16x16x32_bf16 v[8:11], v[100:103], v[148:151], v[8:11]
    v_mfma_f32_16x16x32_bf16 v[12:15], v[104:107], v[148:151], v[12:15]
    s_waitcnt lgkmcnt(0)
    v_mfma_f32_16x16x32_bf16 v[0:3], v[108:111], v[148:151], v[0:3]
    v_mfma_f32_16x16x32_bf16 v[4:7], v[112:115], v[148:151], v[4:7]
    v_mfma_f32_16x16x32_bf16 v[40:43], v[76:79], v[152:155], 0
    v_mfma_f32_16x16x32_bf16 v[44:47], v[80:83], v[152:155], 0
    s_barrier
    v_mfma_f32_16x16x32_bf16 v[32:35], v[84:87], v[152:155], v[32:35]
    ds_read_b128 v[156:159], v164 offset:8448
    ds_read_b64_tr_b16 v[124:125], v165 offset:12288
    v_mfma_f32_16x16x32_bf16 v[36:39], v[88:91], v[152:155], v[36:39]
    ds_read_b64_tr_b16 v[126:127], v165 offset:13312
    ds_read_b64_tr_b16 v[128:129], v166 offset:12288
    v_mfma_f32_16x16x32_bf16 v[24:27], v[92:95], v[152:155], v[24:27]
    ds_read_b64_tr_b16 v[130:131], v166 offset:13312
    ds_read_b128 v[160:163], v164 offset:9856
    v_mfma_f32_16x16x32_bf16 v[28:31], v[96:99], v[152:155], v[28:31]
    v_mfma_f32_16x16x32_bf16 v[16:19], v[100:103], v[152:155], v[16:19]
    v_mfma_f32_16x16x32_bf16 v[20:23], v[104:107], v[152:155], v[20:23]
    v_mfma_f32_16x16x32_bf16 v[8:11], v[108:111], v[152:155], v[8:11]
    v_mfma_f32_16x16x32_bf16 v[12:15], v[112:115], v[152:155], v[12:15]
    v_mfma_f32_16x16x32_bf16 v[0:3], v[116:119], v[152:155], v[0:3]
    v_mfma_f32_16x16x32_bf16 v[4:7], v[120:123], v[152:155], v[4:7]
    s_waitcnt lgkmcnt(2)
    v_mfma_f32_16x16x32_bf16 v[48:51], v[76:79], v[156:159], 0
    v_mfma_f32_16x16x32_bf16 v[52:55], v[80:83], v[156:159], 0
    v_mfma_f32_16x16x32_bf16 v[40:43], v[84:87], v[156:159], v[40:43]
    ds_read_b128 v[136:139], v164 offset:12672
    v_mfma_f32_16x16x32_bf16 v[44:47], v[88:91], v[156:159], v[44:47]
    v_mfma_f32_16x16x32_bf16 v[32:35], v[92:95], v[156:159], v[32:35]
    v_mfma_f32_16x16x32_bf16 v[36:39], v[96:99], v[156:159], v[36:39]
    v_mfma_f32_16x16x32_bf16 v[24:27], v[100:103], v[156:159], v[24:27]
    v_mfma_f32_16x16x32_bf16 v[28:31], v[104:107], v[156:159], v[28:31]
    v_mfma_f32_16x16x32_bf16 v[16:19], v[108:111], v[156:159], v[16:19]
    v_mfma_f32_16x16x32_bf16 v[20:23], v[112:115], v[156:159], v[20:23]
    v_mfma_f32_16x16x32_bf16 v[8:11], v[116:119], v[156:159], v[8:11]
    v_mfma_f32_16x16x32_bf16 v[12:15], v[120:123], v[156:159], v[12:15]
    v_mfma_f32_16x16x32_bf16 v[0:3], v[124:127], v[156:159], v[0:3]
    s_waitcnt lgkmcnt(0)
    v_mfma_f32_16x16x32_bf16 v[4:7], v[128:131], v[156:159], v[4:7]
    v_mfma_f32_16x16x32_bf16 v[56:59], v[76:79], v[160:163], 0
    v_mfma_f32_16x16x32_bf16 v[60:63], v[80:83], v[160:163], 0
    ds_read_b128 v[140:143], v164 offset:14080
    s_barrier
    v_mfma_f32_16x16x32_bf16 v[48:51], v[84:87], v[160:163], v[48:51]
    ds_read_b128 v[132:135], v164 offset:11264
    v_mfma_f32_16x16x32_bf16 v[52:55], v[88:91], v[160:163], v[52:55]
    v_mfma_f32_16x16x32_bf16 v[40:43], v[92:95], v[160:163], v[40:43]
    v_mfma_f32_16x16x32_bf16 v[44:47], v[96:99], v[160:163], v[44:47]
    v_mfma_f32_16x16x32_bf16 v[32:35], v[100:103], v[160:163], v[32:35]
    s_add_u32 s48, s48, 1
    v_mfma_f32_16x16x32_bf16 v[36:39], v[104:107], v[160:163], v[36:39]
    s_cmp_eq_u32 s48, 7
    v_mfma_f32_16x16x32_bf16 v[24:27], v[108:111], v[160:163], v[24:27]
    s_cselect_b32 s44, s51, 0
    v_mfma_f32_16x16x32_bf16 v[28:31], v[112:115], v[160:163], v[28:31]
    s_cselect_b32 s48, 0, s48
    v_mfma_f32_16x16x32_bf16 v[16:19], v[116:119], v[160:163], v[16:19]
    s_xor_b32 s50, s50, s44
    v_mfma_f32_16x16x32_bf16 v[20:23], v[120:123], v[160:163], v[20:23]
    v_add_u32 v172, s48, v167
    v_mfma_f32_16x16x32_bf16 v[8:11], v[124:127], v[160:163], v[8:11]
    ds_read_b128 v[144:147], v164 offset:15488
    v_mfma_f32_16x16x32_bf16 v[12:15], v[128:131], v[160:163], v[12:15]
    v_and_b32 v173, 4, v172
    s_waitcnt lgkmcnt(1)
    v_mfma_f32_16x16x32_bf16 v[64:67], v[76:79], v[132:135], 0
    v_lshlrev_b32 v173, 3, v173
    v_mfma_f32_16x16x32_bf16 v[68:71], v[80:83], v[132:135], 0
    v_xor_b32 v173, v173, v168
    v_mfma_f32_16x16x32_bf16 v[56:59], v[84:87], v[132:135], v[56:59]
    v_lshl_add_u32 v173, v172, 6, v173
    v_mfma_f32_16x16x32_bf16 v[60:63], v[88:91], v[132:135], v[60:63]
    v_add_u32 v170, s50, v173
    v_mfma_f32_16x16x32_bf16 v[48:51], v[92:95], v[132:135], v[48:51]
    v_mfma_f32_16x16x32_bf16 v[52:55], v[96:99], v[132:135], v[52:55]
    v_mfma_f32_16x16x32_bf16 v[40:43], v[100:103], v[132:135], v[40:43]
    v_mfma_f32_16x16x32_bf16 v[44:47], v[104:107], v[132:135], v[44:47]
    ds_read_b128 v[148:151], v164 offset:16896
    v_mfma_f32_16x16x32_bf16 v[32:35], v[108:111], v[132:135], v[32:35]
    v_mfma_f32_16x16x32_bf16 v[36:39], v[112:115], v[132:135], v[36:39]
    v_mfma_f32_16x16x32_bf16 v[24:27], v[116:119], v[132:135], v[24:27]
    v_mfma_f32_16x16x32_bf16 v[28:31], v[120:123], v[132:135], v[28:31]
    v_mfma_f32_16x16x32_bf16 v[16:19], v[124:127], v[132:135], v[16:19]
    v_mfma_f32_16x16x32_bf16 v[20:23], v[128:131], v[132:135], v[20:23]
    s_barrier
    v_mfma_f32_16x16x32_bf16 v[72:75], v[76:79], v[136:139], 0
    ds_read_b128 v[152:155], v164 offset:18304
    v_mfma_f32_16x16x32_bf16 v[64:67], v[84:87], v[136:139], v[64:67]
    s_xor_b32 s52, s52, s53
    v_mfma_f32_16x16x32_bf16 v[68:71], v[88:91], v[136:139], v[68:71]
    v_add_u32 v165, s52, v169
    v_mfma_f32_16x16x32_bf16 v[56:59], v[92:95], v[136:139], v[56:59]
    v_xor_b32 v166, 32, v165
    v_mfma_f32_16x16x32_bf16 v[60:63], v[96:99], v[136:139], v[60:63]
    v_mfma_f32_16x16x32_bf16 v[48:51], v[100:103], v[136:139], v[48:51]
    ds_read_b128 v[156:159], v164 offset:19712
    v_mfma_f32_16x16x32_bf16 v[52:55], v[104:107], v[136:139], v[52:55]
    v_mfma_f32_16x16x32_bf16 v[40:43], v[108:111], v[136:139], v[40:43]
    v_mfma_f32_16x16x32_bf16 v[44:47], v[112:115], v[136:139], v[44:47]
    ds_read_b128 v[160:163], v164 offset:21120
    v_mfma_f32_16x16x32_bf16 v[32:35], v[116:119], v[136:139], v[32:35]
    v_mfma_f32_16x16x32_bf16 v[36:39], v[120:123], v[136:139], v[36:39]
    v_mfma_f32_16x16x32_bf16 v[24:27], v[124:127], v[136:139], v[24:27]
    v_mfma_f32_16x16x32_bf16 v[28:31], v[128:131], v[136:139], v[28:31]
    v_mfma_f32_16x16x32_bf16 v[72:75], v[84:87], v[140:143], v[72:75]
    v_mfma_f32_16x16x32_bf16 v[64:67], v[92:95], v[140:143], v[64:67]
    v_mfma_f32_16x16x32_bf16 v[68:71], v[96:99], v[140:143], v[68:71]
    v_mfma_f32_16x16x32_bf16 v[56:59], v[100:103], v[140:143], v[56:59]
    v_mov_b32 v164, v170
    v_mfma_f32_16x16x32_bf16 v[60:63], v[104:107], v[140:143], v[60:63]
    v_mfma_f32_16x16x32_bf16 v[48:51], v[108:111], v[140:143], v[48:51]
    v_mfma_f32_16x16x32_bf16 v[52:55], v[112:115], v[140:143], v[52:55]
    v_mfma_f32_16x16x32_bf16 v[40:43], v[116:119], v[140:143], v[40:43]
    v_mfma_f32_16x16x32_bf16 v[44:47], v[120:123], v[140:143], v[44:47]
    s_barrier
    v_mfma_f32_16x16x32_bf16 v[32:35], v[124:127], v[140:143], v[32:35]
    v_mfma_f32_16x16x32_bf16 v[36:39], v[128:131], v[140:143], v[36:39]
    s_waitcnt lgkmcnt(0)
    v_mfma_f32_16x16x32_bf16 v[72:75], v[92:95], v[144:147], v[72:75]
    v_mfma_f32_16x16x32_bf16 v[64:67], v[100:103], v[144:147], v[64:67]
    v_mfma_f32_16x16x32_bf16 v[68:71], v[104:107], v[144:147], v[68:71]
    v_mfma_f32_16x16x32_bf16 v[56:59], v[108:111], v[144:147], v[56:59]
    v_mfma_f32_16x16x32_bf16 v[60:63], v[112:115], v[144:147], v[60:63]
    v_mfma_f32_16x16x32_bf16 v[48:51], v[116:119], v[144:147], v[48:51]
    ds_read_b64_tr_b16 v[98:99], v166 offset:5120
    v_mfma_f32_16x16x32_bf16 v[52:55], v[120:123], v[144:147], v[52:55]
    ds_read_b64_tr_b16 v[90:91], v166 offset:3072
    v_mfma_f32_16x16x32_bf16 v[40:43], v[124:127], v[144:147], v[40:43]
    ds_read_b64_tr_b16 v[88:89], v166 offset:2048
    v_mfma_f32_16x16x32_bf16 v[44:47], v[128:131], v[144:147], v[44:47]
    ds_read_b64_tr_b16 v[86:87], v165 offset:3072
    v_mfma_f32_16x16x32_bf16 v[72:75], v[100:103], v[148:151], v[72:75]
    ds_read_b64_tr_b16 v[82:83], v166 offset:1024
    v_mfma_f32_16x16x32_bf16 v[64:67], v[108:111], v[148:151], v[64:67]
    ds_read_b64_tr_b16 v[80:81], v166 offset:0
    v_mfma_f32_16x16x32_bf16 v[68:71], v[112:115], v[148:151], v[68:71]
    ds_read_b128 v[132:135], v170 offset:0
    v_mfma_f32_16x16x32_bf16 v[56:59], v[116:119], v[148:151], v[56:59]
    ds_read_b64_tr_b16 v[78:79], v165 offset:1024
    v_mfma_f32_16x16x32_bf16 v[60:63], v[120:123], v[148:151], v[60:63]
    ds_read_b64_tr_b16 v[76:77], v165 offset:0
    v_mfma_f32_16x16x32_bf16 v[48:51], v[124:127], v[148:151], v[48:51]
    v_mfma_f32_16x16x32_bf16 v[52:55], v[128:131], v[148:151], v[52:55]
    ds_read_b128 v[136:139], v170 offset:1408
    v_mfma_f32_16x16x32_bf16 v[72:75], v[108:111], v[152:155], v[72:75]
    v_mfma_f32_16x16x32_bf16 v[64:67], v[116:119], v[152:155], v[64:67]
    ds_read_b64_tr_b16 v[84:85], v165 offset:2048
    v_mfma_f32_16x16x32_bf16 v[68:71], v[120:123], v[152:155], v[68:71]
    v_mfma_f32_16x16x32_bf16 v[56:59], v[124:127], v[152:155], v[56:59]
    ds_read_b128 v[140:143], v170 offset:2816
    v_mfma_f32_16x16x32_bf16 v[60:63], v[128:131], v[152:155], v[60:63]
    v_mfma_f32_16x16x32_bf16 v[72:75], v[116:119], v[156:159], v[72:75]
    ds_read_b64_tr_b16 v[96:97], v166 offset:4096
    v_mfma_f32_16x16x32_bf16 v[64:67], v[124:127], v[156:159], v[64:67]
    ds_read_b64_tr_b16 v[94:95], v165 offset:5120
    v_mfma_f32_16x16x32_bf16 v[68:71], v[128:131], v[156:159], v[68:71]
    ds_read_b64_tr_b16 v[92:93], v165 offset:4096
    v_mfma_f32_16x16x32_bf16 v[72:75], v[124:127], v[160:163], v[72:75]
    s_waitcnt lgkmcnt(5)
    s_barrier
C_PA_LOOP:
    v_mfma_f32_16x16x32_bf16 v[0:3], v[76:79], v[132:135], v[0:3]
    ds_read_b128 v[144:147], v164 offset:4224
    v_mfma_f32_16x16x32_bf16 v[4:7], v[80:83], v[132:135], v[4:7]
    v_mfma_f32_16x16x32_bf16 v[8:11], v[76:79], v[136:139], v[8:11]
    v_mfma_f32_16x16x32_bf16 v[12:15], v[80:83], v[136:139], v[12:15]
    ds_read_b64_tr_b16 v[106:107], v166 offset:7168
    s_waitcnt lgkmcnt(5)
    v_mfma_f32_16x16x32_bf16 v[0:3], v[84:87], v[136:139], v[0:3]
    ds_read_b64_tr_b16 v[104:105], v166 offset:6144
    v_mfma_f32_16x16x32_bf16 v[4:7], v[88:91], v[136:139], v[4:7]
    ds_read_b64_tr_b16 v[102:103], v165 offset:7168
    v_mfma_f32_16x16x32_bf16 v[16:19], v[76:79], v[140:143], v[16:19]
    ds_read_b64_tr_b16 v[100:101], v165 offset:6144
    v_mfma_f32_16x16x32_bf16 v[20:23], v[80:83], v[140:143], v[20:23]
    v_mfma_f32_16x16x32_bf16 v[8:11], v[84:87], v[140:143], v[8:11]
    ds_read_b128 v[148:151], v164 offset:5632
    v_mfma_f32_16x16x32_bf16 v[12:15], v[88:91], v[140:143], v[12:15]
    s_waitcnt lgkmcnt(5)
    v_mfma_f32_16x16x32_bf16 v[0:3], v[92:95], v[140:143], v[0:3]
    v_mfma_f32_16x16x32_bf16 v[4:7], v[96:99], v[140:143], v[4:7]
    v_mfma_f32_16x16x32_bf16 v[24:27], v[76:79], v[144:147], v[24:27]
    v_mfma_f32_16x16x32_bf16 v[28:31], v[80:83], v[144:147], v[28:31]
    ds_read_b64_tr_b16 v[114:115], v166 offset:9216
    v_mfma_f32_16x16x32_bf16 v[16:19], v[84:87], v[144:147], v[16:19]
    ds_read_b64_tr_b16 v[112:113], v166 offset:8192
    v_mfma_f32_16x16x32_bf16 v[20:23], v[88:91], v[144:147], v[20:23]
    ds_read_b64_tr_b16 v[110:111], v165 offset:9216
    v_mfma_f32_16x16x32_bf16 v[8:11], v[92:95], v[144:147], v[8:11]
    ds_read_b64_tr_b16 v[108:109], v165 offset:8192
    v_mfma_f32_16x16x32_bf16 v[12:15], v[96:99], v[144:147], v[12:15]
    s_waitcnt lgkmcnt(4)
    v_mfma_f32_16x16x32_bf16 v[0:3], v[100:103], v[144:147], v[0:3]
    ds_read_b128 v[152:155], v164 offset:7040
    v_mfma_f32_16x16x32_bf16 v[4:7], v[104:107], v[144:147], v[4:7]
    v_mfma_f32_16x16x32_bf16 v[32:35], v[76:79], v[148:151], v[32:35]
    v_mfma_f32_16x16x32_bf16 v[36:39], v[80:83], v[148:151], v[36:39]
    v_mfma_f32_16x16x32_bf16 v[24:27], v[84:87], v[148:151], v[24:27]
    v_mfma_f32_16x16x32_bf16 v[28:31], v[88:91], v[148:151], v[28:31]
    v_mfma_f32_16x16x32_bf16 v[16:19], v[92:95], v[148:151], v[16:19]
    v_mfma_f32_16x16x32_bf16 v[20:23], v[96:99], v[148:151], v[20:23]
    ds_read_b64_tr_b16 v[122:123], v166 offset:11264
    v_mfma_f32_16x16x32_bf16 v[8:11], v[100:103], v[148:151], v[8:11]
    ds_read_b64_tr_b16 v[120:121], v166 offset:10240
    v_mfma_f32_16x16x32_bf16 v[12:15], v[104:107], v[148:151], v[12:15]
    ds_read_b64_tr_b16 v[118:119], v165 offset:11264
    s_waitcnt lgkmcnt(3)
    v_mfma_f32_16x16x32_bf16 v[0:3], v[108:111], v[148:151], v[0:3]
    ds_read_b64_tr_b16 v[116:117], v165 offset:10240
    v_mfma_f32_16x16x32_bf16 v[4:7], v[112:115], v[148:151], v[4:7]
    v_mfma_f32_16x16x32_bf16 v[40:43], v[76:79], v[152:155], v[40:43]
    ds_read_b128 v[156:159], v164 offset:8448
    v_mfma_f32_16x16x32_bf16 v[44:47], v[80:83], v[152:155], v[44:47]
    v_mfma_f32_16x16x32_bf16 v[32:35], v[84:87], v[152:155], v[32:35]
    v_mfma_f32_16x16x32_bf16 v[36:39], v[88:91], v[152:155], v[36:39]
    v_mfma_f32_16x16x32_bf16 v[24:27], v[92:95], v[152:155], v[24:27]
    v_mfma_f32_16x16x32_bf16 v[28:31], v[96:99], v[152:155], v[28:31]
    v_mfma_f32_16x16x32_bf16 v[16:19], v[100:103], v[152:155], v[16:19]
    v_mfma_f32_16x16x32_bf16 v[20:23], v[104:107], v[152:155], v[20:23]
    v_mfma_f32_16x16x32_bf16 v[8:11], v[108:111], v[152:155], v[8:11]
    v_mfma_f32_16x16x32_bf16 v[12:15], v[112:115], v[152:155], v[12:15]
    ds_read_b64_tr_b16 v[130:131], v166 offset:13312
    s_waitcnt lgkmcnt(1)
    v_mfma_f32_16x16x32_bf16 v[0:3], v[116:119], v[152:155], v[0:3]
    ds_read_b64_tr_b16 v[128:129], v166 offset:12288
    v_mfma_f32_16x16x32_bf16 v[4:7], v[120:123], v[152:155], v[4:7]
    ds_read_b64_tr_b16 v[126:127], v165 offset:13312
    v_mfma_f32_16x16x32_bf16 v[48:51], v[76:79], v[156:159], v[48:51]
    ds_read_b64_tr_b16 v[124:125], v165 offset:12288
    v_mfma_f32_16x16x32_bf16 v[52:55], v[80:83], v[156:159], v[52:55]
    v_mfma_f32_16x16x32_bf16 v[40:43], v[84:87], v[156:159], v[40:43]
    ds_read_b128 v[160:163], v164 offset:9856
    v_mfma_f32_16x16x32_bf16 v[44:47], v[88:91], v[156:159], v[44:47]
    v_mfma_f32_16x16x32_bf16 v[32:35], v[92:95], v[156:159], v[32:35]
    v_mfma_f32_16x16x32_bf16 v[36:39], v[96:99], v[156:159], v[36:39]
    v_mfma_f32_16x16x32_bf16 v[24:27], v[100:103], v[156:159], v[24:27]
    v_mfma_f32_16x16x32_bf16 v[28:31], v[104:107], v[156:159], v[28:31]
    v_mfma_f32_16x16x32_bf16 v[16:19], v[108:111], v[156:159], v[16:19]
    v_mfma_f32_16x16x32_bf16 v[20:23], v[112:115], v[156:159], v[20:23]
    v_mfma_f32_16x16x32_bf16 v[8:11], v[116:119], v[156:159], v[8:11]
    v_mfma_f32_16x16x32_bf16 v[12:15], v[120:123], v[156:159], v[12:15]
    s_waitcnt lgkmcnt(0)
    v_mfma_f32_16x16x32_bf16 v[0:3], v[124:127], v[156:159], v[0:3]
    v_mfma_f32_16x16x32_bf16 v[4:7], v[128:131], v[156:159], v[4:7]
    v_mfma_f32_16x16x32_bf16 v[56:59], v[76:79], v[160:163], v[56:59]
    v_mfma_f32_16x16x32_bf16 v[60:63], v[80:83], v[160:163], v[60:63]
    v_mfma_f32_16x16x32_bf16 v[48:51], v[84:87], v[160:163], v[48:51]
    ds_read_b128 v[132:135], v164 offset:11264
    v_mfma_f32_16x16x32_bf16 v[52:55], v[88:91], v[160:163], v[52:55]
    s_barrier
    v_mfma_f32_16x16x32_bf16 v[40:43], v[92:95], v[160:163], v[40:43]
    s_xor_b32 s52, s52, s53
    v_mfma_f32_16x16x32_bf16 v[44:47], v[96:99], v[160:163], v[44:47]
    v_add_u32 v165, s52, v169
    v_mfma_f32_16x16x32_bf16 v[32:35], v[100:103], v[160:163], v[32:35]
    v_xor_b32 v166, 32, v165
    v_mfma_f32_16x16x32_bf16 v[36:39], v[104:107], v[160:163], v[36:39]
    v_mfma_f32_16x16x32_bf16 v[24:27], v[108:111], v[160:163], v[24:27]
    s_add_u32 s48, s48, 1
    v_mfma_f32_16x16x32_bf16 v[28:31], v[112:115], v[160:163], v[28:31]
    s_cmp_eq_u32 s48, 7
    v_mfma_f32_16x16x32_bf16 v[16:19], v[116:119], v[160:163], v[16:19]
    s_cselect_b32 s44, s51, 0
    v_mfma_f32_16x16x32_bf16 v[20:23], v[120:123], v[160:163], v[20:23]
    s_cselect_b32 s48, 0, s48
    v_mfma_f32_16x16x32_bf16 v[8:11], v[124:127], v[160:163], v[8:11]
    s_xor_b32 s50, s50, s44
    v_mfma_f32_16x16x32_bf16 v[12:15], v[128:131], v[160:163], v[12:15]
    v_add_u32 v172, s48, v167
    s_waitcnt lgkmcnt(0)
    v_mfma_f32_16x16x32_bf16 v[64:67], v[76:79], v[132:135], v[64:67]
    v_and_b32 v173, 4, v172
    v_mfma_f32_16x16x32_bf16 v[68:71], v[80:83], v[132:135], v[68:71]
    v_lshlrev_b32 v173, 3, v173
    v_mfma_f32_16x16x32_bf16 v[56:59], v[84:87], v[132:135], v[56:59]
    ds_read_b128 v[136:139], v164 offset:12672
    v_mfma_f32_16x16x32_bf16 v[60:63], v[88:91], v[132:135], v[60:63]
    v_xor_b32 v173, v173, v168
    v_mfma_f32_16x16x32_bf16 v[48:51], v[92:95], v[132:135], v[48:51]
    v_lshl_add_u32 v173, v172, 6, v173
    v_mfma_f32_16x16x32_bf16 v[52:55], v[96:99], v[132:135], v[52:55]
    v_add_u32 v170, s50, v173
    v_mfma_f32_16x16x32_bf16 v[40:43], v[100:103], v[132:135], v[40:43]
    v_mfma_f32_16x16x32_bf16 v[44:47], v[104:107], v[132:135], v[44:47]
    v_mfma_f32_16x16x32_bf16 v[32:35], v[108:111], v[132:135], v[32:35]
    v_mfma_f32_16x16x32_bf16 v[36:39], v[112:115], v[132:135], v[36:39]
    v_mfma_f32_16x16x32_bf16 v[24:27], v[116:119], v[132:135], v[24:27]
    v_mfma_f32_16x16x32_bf16 v[28:31], v[120:123], v[132:135], v[28:31]
    v_mfma_f32_16x16x32_bf16 v[16:19], v[124:127], v[132:135], v[16:19]
    v_mfma_f32_16x16x32_bf16 v[20:23], v[128:131], v[132:135], v[20:23]
    s_waitcnt lgkmcnt(0)
    v_mfma_f32_16x16x32_bf16 v[72:75], v[76:79], v[136:139], v[72:75]
    v_mfma_f32_16x16x32_bf16 v[64:67], v[84:87], v[136:139], v[64:67]
    ds_read_b128 v[140:143], v164 offset:14080
    v_mfma_f32_16x16x32_bf16 v[68:71], v[88:91], v[136:139], v[68:71]
    v_mfma_f32_16x16x32_bf16 v[56:59], v[92:95], v[136:139], v[56:59]
    v_mfma_f32_16x16x32_bf16 v[60:63], v[96:99], v[136:139], v[60:63]
    v_mfma_f32_16x16x32_bf16 v[48:51], v[100:103], v[136:139], v[48:51]
    v_mfma_f32_16x16x32_bf16 v[52:55], v[104:107], v[136:139], v[52:55]
    v_mfma_f32_16x16x32_bf16 v[40:43], v[108:111], v[136:139], v[40:43]
    v_mfma_f32_16x16x32_bf16 v[44:47], v[112:115], v[136:139], v[44:47]
    v_mfma_f32_16x16x32_bf16 v[32:35], v[116:119], v[136:139], v[32:35]
    v_mfma_f32_16x16x32_bf16 v[36:39], v[120:123], v[136:139], v[36:39]
    v_mfma_f32_16x16x32_bf16 v[24:27], v[124:127], v[136:139], v[24:27]
    v_mfma_f32_16x16x32_bf16 v[28:31], v[128:131], v[136:139], v[28:31]
    ds_read_b128 v[144:147], v164 offset:15488
    s_waitcnt lgkmcnt(1)
    v_mfma_f32_16x16x32_bf16 v[72:75], v[84:87], v[140:143], v[72:75]
    v_mfma_f32_16x16x32_bf16 v[64:67], v[92:95], v[140:143], v[64:67]
    v_mfma_f32_16x16x32_bf16 v[68:71], v[96:99], v[140:143], v[68:71]
    v_mfma_f32_16x16x32_bf16 v[56:59], v[100:103], v[140:143], v[56:59]
    v_mfma_f32_16x16x32_bf16 v[60:63], v[104:107], v[140:143], v[60:63]
    v_mfma_f32_16x16x32_bf16 v[48:51], v[108:111], v[140:143], v[48:51]
    v_mfma_f32_16x16x32_bf16 v[52:55], v[112:115], v[140:143], v[52:55]
    v_mfma_f32_16x16x32_bf16 v[40:43], v[116:119], v[140:143], v[40:43]
    v_mfma_f32_16x16x32_bf16 v[44:47], v[120:123], v[140:143], v[44:47]
    ds_read_b128 v[148:151], v164 offset:16896
    v_mfma_f32_16x16x32_bf16 v[32:35], v[124:127], v[140:143], v[32:35]
    v_mfma_f32_16x16x32_bf16 v[36:39], v[128:131], v[140:143], v[36:39]
    s_waitcnt lgkmcnt(1)
    v_mfma_f32_16x16x32_bf16 v[72:75], v[92:95], v[144:147], v[72:75]
    v_mfma_f32_16x16x32_bf16 v[64:67], v[100:103], v[144:147], v[64:67]
    v_mfma_f32_16x16x32_bf16 v[68:71], v[104:107], v[144:147], v[68:71]
    ds_read_b128 v[160:163], v164 offset:21120
    v_mfma_f32_16x16x32_bf16 v[56:59], v[108:111], v[144:147], v[56:59]
    ds_read_b128 v[156:159], v164 offset:19712
    v_mfma_f32_16x16x32_bf16 v[60:63], v[112:115], v[144:147], v[60:63]
    ds_read_b128 v[152:155], v164 offset:18304
    v_mfma_f32_16x16x32_bf16 v[48:51], v[116:119], v[144:147], v[48:51]
    ds_read_b64_tr_b16 v[98:99], v166 offset:5120
    v_mfma_f32_16x16x32_bf16 v[52:55], v[120:123], v[144:147], v[52:55]
    ds_read_b64_tr_b16 v[90:91], v166 offset:3072
    v_mfma_f32_16x16x32_bf16 v[40:43], v[124:127], v[144:147], v[40:43]
    ds_read_b64_tr_b16 v[88:89], v166 offset:2048
    v_mfma_f32_16x16x32_bf16 v[44:47], v[128:131], v[144:147], v[44:47]
    ds_read_b64_tr_b16 v[86:87], v165 offset:3072
    s_waitcnt lgkmcnt(7)
    v_mfma_f32_16x16x32_bf16 v[72:75], v[100:103], v[148:151], v[72:75]
    ds_read_b64_tr_b16 v[82:83], v166 offset:1024
    v_mfma_f32_16x16x32_bf16 v[64:67], v[108:111], v[148:151], v[64:67]
    ds_read_b64_tr_b16 v[80:81], v166 offset:0
    v_mfma_f32_16x16x32_bf16 v[68:71], v[112:115], v[148:151], v[68:71]
    ds_read_b128 v[132:135], v170 offset:0
    v_mfma_f32_16x16x32_bf16 v[56:59], v[116:119], v[148:151], v[56:59]
    ds_read_b64_tr_b16 v[78:79], v165 offset:1024
    v_mfma_f32_16x16x32_bf16 v[60:63], v[120:123], v[148:151], v[60:63]
    ds_read_b64_tr_b16 v[76:77], v165 offset:0
    v_mfma_f32_16x16x32_bf16 v[48:51], v[124:127], v[148:151], v[48:51]
    v_mov_b32 v164, v170
    v_mfma_f32_16x16x32_bf16 v[52:55], v[128:131], v[148:151], v[52:55]
    ds_read_b128 v[136:139], v170 offset:1408
    s_waitcnt lgkmcnt(7)
    v_mfma_f32_16x16x32_bf16 v[72:75], v[108:111], v[152:155], v[72:75]
    s_add_u32 s49, s49, 1
    v_mfma_f32_16x16x32_bf16 v[64:67], v[116:119], v[152:155], v[64:67]
    ds_read_b64_tr_b16 v[84:85], v165 offset:2048
    v_mfma_f32_16x16x32_bf16 v[68:71], v[120:123], v[152:155], v[68:71]
    s_cmp_lt_u32 s49, 20
    v_mfma_f32_16x16x32_bf16 v[56:59], v[124:127], v[152:155], v[56:59]
    ds_read_b128 v[140:143], v170 offset:2816
    v_mfma_f32_16x16x32_bf16 v[60:63], v[128:131], v[152:155], v[60:63]
    v_mfma_f32_16x16x32_bf16 v[72:75], v[116:119], v[156:159], v[72:75]
    ds_read_b64_tr_b16 v[96:97], v166 offset:4096
    v_mfma_f32_16x16x32_bf16 v[64:67], v[124:127], v[156:159], v[64:67]
    ds_read_b64_tr_b16 v[94:95], v165 offset:5120
    v_mfma_f32_16x16x32_bf16 v[68:71], v[128:131], v[156:159], v[68:71]
    ds_read_b64_tr_b16 v[92:93], v165 offset:4096
    s_waitcnt lgkmcnt(5)
    v_mfma_f32_16x16x32_bf16 v[72:75], v[124:127], v[160:163], v[72:75]
    s_cbranch_scc1 C_PA_LOOP
    v_mfma_f32_16x16x32_bf16 v[0:3], v[76:79], v[132:135], v[0:3]
    ds_read_b128 v[144:147], v164 offset:4224
    v_mfma_f32_16x16x32_bf16 v[4:7], v[80:83], v[132:135], v[4:7]
    v_mfma_f32_16x16x32_bf16 v[8:11], v[76:79], v[136:139], v[8:11]
    v_mfma_f32_16x16x32_bf16 v[12:15], v[80:83], v[136:139], v[12:15]
    s_waitcnt lgkmcnt(4)
    v_mfma_f32_16x16x32_bf16 v[0:3], v[84:87], v[136:139], v[0:3]
    ds_read_b64_tr_b16 v[106:107], v166 offset:7168
    v_mfma_f32_16x16x32_bf16 v[4:7], v[88:91], v[136:139], v[4:7]
    ds_read_b64_tr_b16 v[102:103], v165 offset:7168
    v_mfma_f32_16x16x32_bf16 v[16:19], v[76:79], v[140:143], v[16:19]
    ds_read_b64_tr_b16 v[100:101], v165 offset:6144
    v_mfma_f32_16x16x32_bf16 v[20:23], v[80:83], v[140:143], v[20:23]
    ds_read_b64_tr_b16 v[104:105], v166 offset:6144
    v_mfma_f32_16x16x32_bf16 v[8:11], v[84:87], v[140:143], v[8:11]
    ds_read_b128 v[148:151], v164 offset:5632
    v_mfma_f32_16x16x32_bf16 v[12:15], v[88:91], v[140:143], v[12:15]
    s_waitcnt lgkmcnt(5)
    v_mfma_f32_16x16x32_bf16 v[0:3], v[92:95], v[140:143], v[0:3]
    v_mfma_f32_16x16x32_bf16 v[4:7], v[96:99], v[140:143], v[4:7]
    v_mfma_f32_16x16x32_bf16 v[24:27], v[76:79], v[144:147], v[24:27]
    v_mfma_f32_16x16x32_bf16 v[28:31], v[80:83], v[144:147], v[28:31]
    v_mfma_f32_16x16x32_bf16 v[16:19], v[84:87], v[144:147], v[16:19]
    v_mfma_f32_16x16x32_bf16 v[20:23], v[88:91], v[144:147], v[20:23]
    v_mfma_f32_16x16x32_bf16 v[8:11], v[92:95], v[144:147], v[8:11]
    ds_read_b128 v[152:155], v164 offset:7040
    v_mfma_f32_16x16x32_bf16 v[12:15], v[96:99], v[144:147], v[12:15]
    s_waitcnt lgkmcnt(1)
    v_mfma_f32_16x16x32_bf16 v[0:3], v[100:103], v[144:147], v[0:3]
    v_mfma_f32_16x16x32_bf16 v[4:7], v[104:107], v[144:147], v[4:7]
    v_mfma_f32_16x16x32_bf16 v[32:35], v[76:79], v[148:151], v[32:35]
    v_mfma_f32_16x16x32_bf16 v[36:39], v[80:83], v[148:151], v[36:39]
    v_mfma_f32_16x16x32_bf16 v[24:27], v[84:87], v[148:151], v[24:27]
    v_mfma_f32_16x16x32_bf16 v[28:31], v[88:91], v[148:151], v[28:31]
    v_mfma_f32_16x16x32_bf16 v[16:19], v[92:95], v[148:151], v[16:19]
    ds_read_b128 v[156:159], v164 offset:8448
    v_mfma_f32_16x16x32_bf16 v[20:23], v[96:99], v[148:151], v[20:23]
    v_mfma_f32_16x16x32_bf16 v[8:11], v[100:103], v[148:151], v[8:11]
    v_mfma_f32_16x16x32_bf16 v[12:15], v[104:107], v[148:151], v[12:15]
    s_waitcnt lgkmcnt(1)
    v_mfma_f32_16x16x32_bf16 v[40:43], v[76:79], v[152:155], v[40:43]
    v_mfma_f32_16x16x32_bf16 v[44:47], v[80:83], v[152:155], v[44:47]
    v_mfma_f32_16x16x32_bf16 v[32:35], v[84:87], v[152:155], v[32:35]
    v_mfma_f32_16x16x32_bf16 v[36:39], v[88:91], v[152:155], v[36:39]
    ds_read_b64_tr_b16 v[130:131], v166 offset:13312
    v_mfma_f32_16x16x32_bf16 v[24:27], v[92:95], v[152:155], v[24:27]
    ds_read_b128 v[160:163], v164 offset:9856
    v_mfma_f32_16x16x32_bf16 v[28:31], v[96:99], v[152:155], v[28:31]
    ds_read_b64_tr_b16 v[128:129], v166 offset:12288
    v_mfma_f32_16x16x32_bf16 v[16:19], v[100:103], v[152:155], v[16:19]
    ds_read_b64_tr_b16 v[126:127], v165 offset:13312
    v_mfma_f32_16x16x32_bf16 v[20:23], v[104:107], v[152:155], v[20:23]
    ds_read_b64_tr_b16 v[124:125], v165 offset:12288
    s_waitcnt lgkmcnt(5)
    v_mfma_f32_16x16x32_bf16 v[48:51], v[76:79], v[156:159], v[48:51]
    ds_read_b64_tr_b16 v[122:123], v166 offset:11264
    v_mfma_f32_16x16x32_bf16 v[52:55], v[80:83], v[156:159], v[52:55]
    ds_read_b64_tr_b16 v[120:121], v166 offset:10240
    v_mfma_f32_16x16x32_bf16 v[40:43], v[84:87], v[156:159], v[40:43]
    ds_read_b64_tr_b16 v[118:119], v165 offset:11264
    v_mfma_f32_16x16x32_bf16 v[44:47], v[88:91], v[156:159], v[44:47]
    ds_read_b64_tr_b16 v[116:117], v165 offset:10240
    v_mfma_f32_16x16x32_bf16 v[32:35], v[92:95], v[156:159], v[32:35]
    ds_read_b128 v[132:135], v164 offset:11264
    v_mfma_f32_16x16x32_bf16 v[36:39], v[96:99], v[156:159], v[36:39]
    ds_read_b64_tr_b16 v[114:115], v166 offset:9216
    v_mfma_f32_16x16x32_bf16 v[24:27], v[100:103], v[156:159], v[24:27]
    ds_read_b64_tr_b16 v[112:113], v166 offset:8192
    v_mfma_f32_16x16x32_bf16 v[28:31], v[104:107], v[156:159], v[28:31]
    ds_read_b64_tr_b16 v[110:111], v165 offset:9216
    s_waitcnt lgkmcnt(8)
    v_mfma_f32_16x16x32_bf16 v[56:59], v[76:79], v[160:163], v[56:59]
    ds_read_b64_tr_b16 v[108:109], v165 offset:8192
    v_mfma_f32_16x16x32_bf16 v[60:63], v[80:83], v[160:163], v[60:63]
    v_mfma_f32_16x16x32_bf16 v[48:51], v[84:87], v[160:163], v[48:51]
    v_mfma_f32_16x16x32_bf16 v[52:55], v[88:91], v[160:163], v[52:55]
    v_mfma_f32_16x16x32_bf16 v[40:43], v[92:95], v[160:163], v[40:43]
    ds_read_b128 v[136:139], v164 offset:12672
    v_mfma_f32_16x16x32_bf16 v[44:47], v[96:99], v[160:163], v[44:47]
    v_mfma_f32_16x16x32_bf16 v[32:35], v[100:103], v[160:163], v[32:35]
    v_mfma_f32_16x16x32_bf16 v[36:39], v[104:107], v[160:163], v[36:39]
    s_waitcnt lgkmcnt(2)
    v_mfma_f32_16x16x32_bf16 v[64:67], v[76:79], v[132:135], v[64:67]
    v_mfma_f32_16x16x32_bf16 v[68:71], v[80:83], v[132:135], v[68:71]
    v_mfma_f32_16x16x32_bf16 v[56:59], v[84:87], v[132:135], v[56:59]
    v_mfma_f32_16x16x32_bf16 v[60:63], v[88:91], v[132:135], v[60:63]
    ds_read_b128 v[140:143], v164 offset:14080
    v_mfma_f32_16x16x32_bf16 v[48:51], v[92:95], v[132:135], v[48:51]
    v_mfma_f32_16x16x32_bf16 v[52:55], v[96:99], v[132:135], v[52:55]
    v_mfma_f32_16x16x32_bf16 v[40:43], v[100:103], v[132:135], v[40:43]
    v_mfma_f32_16x16x32_bf16 v[44:47], v[104:107], v[132:135], v[44:47]
    s_waitcnt lgkmcnt(2)
    s_barrier
    s_waitcnt lgkmcnt(1)
    v_mfma_f32_16x16x32_bf16 v[72:75], v[76:79], v[136:139], v[72:75]
    ds_read_b128 v[144:147], v164 offset:15488
    v_mfma_f32_16x16x32_bf16 v[64:67], v[84:87], v[136:139], v[64:67]
    v_mfma_f32_16x16x32_bf16 v[68:71], v[88:91], v[136:139], v[68:71]
    v_mfma_f32_16x16x32_bf16 v[56:59], v[92:95], v[136:139], v[56:59]
    v_mfma_f32_16x16x32_bf16 v[60:63], v[96:99], v[136:139], v[60:63]
    v_mfma_f32_16x16x32_bf16 v[48:51], v[100:103], v[136:139], v[48:51]
    v_mfma_f32_16x16x32_bf16 v[52:55], v[104:107], v[136:139], v[52:55]
    s_waitcnt lgkmcnt(1)
    v_mfma_f32_16x16x32_bf16 v[72:75], v[84:87], v[140:143], v[72:75]
    v_mfma_f32_16x16x32_bf16 v[64:67], v[92:95], v[140:143], v[64:67]
    v_mfma_f32_16x16x32_bf16 v[68:71], v[96:99], v[140:143], v[68:71]
    v_mfma_f32_16x16x32_bf16 v[56:59], v[100:103], v[140:143], v[56:59]
    v_mfma_f32_16x16x32_bf16 v[60:63], v[104:107], v[140:143], v[60:63]
    s_waitcnt lgkmcnt(0)
    v_mfma_f32_16x16x32_bf16 v[72:75], v[92:95], v[144:147], v[72:75]
    ds_read_b128 v[140:143], v164 offset:16896
    v_mfma_f32_16x16x32_bf16 v[64:67], v[100:103], v[144:147], v[64:67]
    v_mfma_f32_16x16x32_bf16 v[68:71], v[104:107], v[144:147], v[68:71]
    s_waitcnt lgkmcnt(0)
    v_mfma_f32_16x16x32_bf16 v[72:75], v[100:103], v[140:143], v[72:75]
    v_mfma_f32_16x16x32_bf16 v[0:3], v[108:111], v[148:151], v[0:3]
    v_mfma_f32_16x16x32_bf16 v[4:7], v[112:115], v[148:151], v[4:7]
    v_mfma_f32_16x16x32_bf16 v[0:3], v[116:119], v[152:155], v[0:3]
    v_mfma_f32_16x16x32_bf16 v[4:7], v[120:123], v[152:155], v[4:7]
    v_mfma_f32_16x16x32_bf16 v[0:3], v[124:127], v[156:159], v[0:3]
    v_mfma_f32_16x16x32_bf16 v[4:7], v[128:131], v[156:159], v[4:7]
    v_mfma_f32_16x16x32_bf16 v[8:11], v[108:111], v[152:155], v[8:11]
    v_mfma_f32_16x16x32_bf16 v[12:15], v[112:115], v[152:155], v[12:15]
    v_mfma_f32_16x16x32_bf16 v[8:11], v[116:119], v[156:159], v[8:11]
    v_mfma_f32_16x16x32_bf16 v[12:15], v[120:123], v[156:159], v[12:15]
    v_mfma_f32_16x16x32_bf16 v[8:11], v[124:127], v[160:163], v[8:11]
    s_nop 1
    v_cvt_pk_bf16_f32 v0, v0, v1
    v_cvt_pk_bf16_f32 v1, v2, v3
    v_mfma_f32_16x16x32_bf16 v[12:15], v[128:131], v[160:163], v[12:15]
    ds_write_b64 v181, v[0:1] offset:0
    v_cvt_pk_bf16_f32 v4, v4, v5
    v_mfma_f32_16x16x32_bf16 v[16:19], v[108:111], v[156:159], v[16:19]
    v_cvt_pk_bf16_f32 v5, v6, v7
    ds_write_b64 v181, v[4:5] offset:32
    v_mfma_f32_16x16x32_bf16 v[20:23], v[112:115], v[156:159], v[20:23]
    ds_read_b128 v[188:191], v182 offset:0
    v_mfma_f32_16x16x32_bf16 v[16:19], v[116:119], v[160:163], v[16:19]
    v_mfma_f32_16x16x32_bf16 v[20:23], v[120:123], v[160:163], v[20:23]
    v_mfma_f32_16x16x32_bf16 v[16:19], v[124:127], v[132:135], v[16:19]
    ds_read_b128 v[148:151], v164 offset:14080
    v_cvt_pk_bf16_f32 v8, v8, v9
    v_cvt_pk_bf16_f32 v9, v10, v11
    v_mfma_f32_16x16x32_bf16 v[20:23], v[128:131], v[132:135], v[20:23]
    ds_write_b64 v181, v[8:9] offset:1280
    v_cvt_pk_bf16_f32 v12, v12, v13
    v_mfma_f32_16x16x32_bf16 v[24:27], v[108:111], v[160:163], v[24:27]
    v_cvt_pk_bf16_f32 v13, v14, v15
    ds_write_b64 v181, v[12:13] offset:1312
    v_mfma_f32_16x16x32_bf16 v[28:31], v[112:115], v[160:163], v[28:31]
    ds_read_b128 v[192:195], v182 offset:1280
    s_mov_b32 s57, 0
    s_waitcnt lgkmcnt(1)
    s_barrier
    v_mfma_f32_16x16x32_bf16 v[24:27], v[116:119], v[132:135], v[24:27]
    buffer_store_dwordx4 v[188:191], v183, s[20:23], s57 offen
    v_mfma_f32_16x16x32_bf16 v[28:31], v[120:123], v[132:135], v[28:31]
    v_mfma_f32_16x16x32_bf16 v[24:27], v[124:127], v[136:139], v[24:27]
    v_cvt_pk_bf16_f32 v16, v16, v17
    v_cvt_pk_bf16_f32 v17, v18, v19
    v_mfma_f32_16x16x32_bf16 v[28:31], v[128:131], v[136:139], v[28:31]
    ds_write_b64 v181, v[16:17] offset:2560
    v_cvt_pk_bf16_f32 v20, v20, v21
    v_mfma_f32_16x16x32_bf16 v[32:35], v[108:111], v[132:135], v[32:35]
    v_cvt_pk_bf16_f32 v21, v22, v23
    ds_write_b64 v181, v[20:21] offset:2592
    v_mfma_f32_16x16x32_bf16 v[36:39], v[112:115], v[132:135], v[36:39]
    ds_read_b128 v[196:199], v182 offset:2560
    s_mov_b32 s57, 86016
    v_mfma_f32_16x16x32_bf16 v[32:35], v[116:119], v[136:139], v[32:35]
    s_waitcnt lgkmcnt(3)
    buffer_store_dwordx4 v[192:195], v183, s[20:23], s57 offen
    v_mfma_f32_16x16x32_bf16 v[36:39], v[120:123], v[136:139], v[36:39]
    v_mfma_f32_16x16x32_bf16 v[32:35], v[124:127], v[148:151], v[32:35]
    v_cvt_pk_bf16_f32 v24, v24, v25
    v_cvt_pk_bf16_f32 v25, v26, v27
    v_mfma_f32_16x16x32_bf16 v[36:39], v[128:131], v[148:151], v[36:39]
    ds_write_b64 v181, v[24:25] offset:3840
    v_cvt_pk_bf16_f32 v28, v28, v29
    v_mfma_f32_16x16x32_bf16 v[40:43], v[108:111], v[136:139], v[40:43]
    v_cvt_pk_bf16_f32 v29, v30, v31
    ds_write_b64 v181, v[28:29] offset:3872
    v_mfma_f32_16x16x32_bf16 v[44:47], v[112:115], v[136:139], v[44:47]
    ds_read_b128 v[200:203], v182 offset:3840
    s_mov_b32 s57, 172032
    v_mfma_f32_16x16x32_bf16 v[40:43], v[116:119], v[148:151], v[40:43]
    s_waitcnt lgkmcnt(3)
    buffer_store_dwordx4 v[196:199], v183, s[20:23], s57 offen
    v_mfma_f32_16x16x32_bf16 v[44:47], v[120:123], v[148:151], v[44:47]
    v_mfma_f32_16x16x32_bf16 v[40:43], v[124:127], v[144:147], v[40:43]
    ds_read_b128 v[152:155], v164 offset:18304
    v_cvt_pk_bf16_f32 v32, v32, v33
    v_cvt_pk_bf16_f32 v33, v34, v35
    v_mfma_f32_16x16x32_bf16 v[44:47], v[128:131], v[144:147], v[44:47]
    ds_write_b64 v181, v[32:33] offset:5120
    v_cvt_pk_bf16_f32 v36, v36, v37
    v_mfma_f32_16x16x32_bf16 v[48:51], v[108:111], v[148:151], v[48:51]
    v_cvt_pk_bf16_f32 v37, v38, v39
    ds_write_b64 v181, v[36:37] offset:5152
    v_mfma_f32_16x16x32_bf16 v[52:55], v[112:115], v[148:151], v[52:55]
    ds_read_b128 v[188:191], v182 offset:5120
    s_mov_b32 s57, 258048
    v_mfma_f32_16x16x32_bf16 v[48:51], v[116:119], v[144:147], v[48:51]
    s_waitcnt lgkmcnt(4)
    buffer_store_dwordx4 v[200:203], v183, s[20:23], s57 offen
    v_mfma_f32_16x16x32_bf16 v[52:55], v[120:123], v[144:147], v[52:55]
    v_mfma_f32_16x16x32_bf16 v[48:51], v[124:127], v[140:143], v[48:51]
    ds_read_b128 v[156:159], v164 offset:19712
    v_cvt_pk_bf16_f32 v40, v40, v41
    v_cvt_pk_bf16_f32 v41, v42, v43
    v_mfma_f32_16x16x32_bf16 v[52:55], v[128:131], v[140:143], v[52:55]
    ds_write_b64 v181, v[40:41] offset:0
    v_cvt_pk_bf16_f32 v44, v44, v45
    v_mfma_f32_16x16x32_bf16 v[56:59], v[108:111], v[144:147], v[56:59]
    v_cvt_pk_bf16_f32 v45, v46, v47
    ds_write_b64 v181, v[44:45] offset:32
    v_mfma_f32_16x16x32_bf16 v[60:63], v[112:115], v[144:147], v[60:63]
    ds_read_b128 v[192:195], v182 offset:0
    s_mov_b32 s57, 344064
    v_mfma_f32_16x16x32_bf16 v[56:59], v[116:119], v[140:143], v[56:59]
    ds_read_b128 v[160:163], v164 offset:21120
    s_waitcnt lgkmcnt(5)
    buffer_store_dwordx4 v[188:191], v183, s[20:23], s57 offen
    v_mfma_f32_16x16x32_bf16 v[60:63], v[120:123], v[140:143], v[60:63]
    v_mfma_f32_16x16x32_bf16 v[56:59], v[124:127], v[152:155], v[56:59]
    v_cvt_pk_bf16_f32 v48, v48, v49
    v_cvt_pk_bf16_f32 v49, v50, v51
    v_mfma_f32_16x16x32_bf16 v[60:63], v[128:131], v[152:155], v[60:63]
    ds_write_b64 v181, v[48:49] offset:1280
    v_cvt_pk_bf16_f32 v52, v52, v53
    v_mfma_f32_16x16x32_bf16 v[64:67], v[108:111], v[140:143], v[64:67]
    v_cvt_pk_bf16_f32 v53, v54, v55
    ds_write_b64 v181, v[52:53] offset:1312
    v_mfma_f32_16x16x32_bf16 v[68:71], v[112:115], v[140:143], v[68:71]
    ds_read_b128 v[196:199], v182 offset:1280
    s_mov_b32 s57, 430080
    v_mfma_f32_16x16x32_bf16 v[64:67], v[116:119], v[152:155], v[64:67]
    s_waitcnt lgkmcnt(4)
    buffer_store_dwordx4 v[192:195], v183, s[20:23], s57 offen
    v_mfma_f32_16x16x32_bf16 v[68:71], v[120:123], v[152:155], v[68:71]
    v_mfma_f32_16x16x32_bf16 v[64:67], v[124:127], v[156:159], v[64:67]
    v_cvt_pk_bf16_f32 v56, v56, v57
    v_cvt_pk_bf16_f32 v57, v58, v59
    v_mfma_f32_16x16x32_bf16 v[68:71], v[128:131], v[156:159], v[68:71]
    ds_write_b64 v181, v[56:57] offset:2560
    v_cvt_pk_bf16_f32 v60, v60, v61
    v_mfma_f32_16x16x32_bf16 v[72:75], v[108:111], v[152:155], v[72:75]
    v_cvt_pk_bf16_f32 v61, v62, v63
    ds_write_b64 v181, v[60:61] offset:2592
    v_mfma_f32_16x16x32_bf16 v[72:75], v[116:119], v[156:159], v[72:75]
    ds_read_b128 v[200:203], v182 offset:2560
    s_mov_b32 s57, 516096
    s_waitcnt lgkmcnt(5)
    v_mfma_f32_16x16x32_bf16 v[72:75], v[124:127], v[160:163], v[72:75]
    s_waitcnt lgkmcnt(3)
    buffer_store_dwordx4 v[196:199], v183, s[20:23], s57 offen
    v_cvt_pk_bf16_f32 v64, v64, v65
    v_cvt_pk_bf16_f32 v65, v66, v67
    ds_write_b64 v181, v[64:65] offset:3840
    v_cvt_pk_bf16_f32 v68, v68, v69
    v_cvt_pk_bf16_f32 v69, v70, v71
    ds_write_b64 v181, v[68:69] offset:3872
    ds_read_b128 v[188:191], v182 offset:3840
    s_mov_b32 s57, 602112
    s_waitcnt lgkmcnt(3)
    buffer_store_dwordx4 v[200:203], v183, s[20:23], s57 offen
    v_cvt_pk_bf16_f32 v72, v72, v73
    v_cvt_pk_bf16_f32 v73, v74, v75
    s_mov_b32 s45, 774144
    buffer_store_dwordx2 v[72:73], v180, s[20:23], s45 offen offset:0
    s_mov_b32 s57, 688128
    s_waitcnt lgkmcnt(0)
    buffer_store_dwordx4 v[188:191], v183, s[20:23], s57 offen
    s_endpgm
.p2align 6
C_PB:
    s_barrier
    ds_read_b64_tr_b16 v[80:81], v166 offset:0
    ds_read_b64_tr_b16 v[82:83], v166 offset:1024
    ds_read_b128 v[132:135], v164 offset:0
    ds_read_b64_tr_b16 v[76:77], v165 offset:0
    ds_read_b64_tr_b16 v[78:79], v165 offset:1024
    ds_read_b128 v[136:139], v164 offset:1408
    ds_read_b64_tr_b16 v[88:89], v166 offset:2048
    ds_read_b64_tr_b16 v[90:91], v166 offset:3072
    s_waitcnt lgkmcnt(5)
    v_mfma_f32_16x16x32_bf16 v[0:3], v[80:83], v[132:135], 0
    ds_read_b64_tr_b16 v[84:85], v165 offset:2048
    ds_read_b64_tr_b16 v[86:87], v165 offset:3072
    s_waitcnt lgkmcnt(4)
    v_mfma_f32_16x16x32_bf16 v[4:7], v[76:79], v[136:139], 0
    s_barrier
    ds_read_b128 v[140:143], v164 offset:2816
    v_mfma_f32_16x16x32_bf16 v[8:11], v[80:83], v[136:139], 0
    ds_read_b64_tr_b16 v[96:97], v166 offset:4096
    ds_read_b64_tr_b16 v[98:99], v166 offset:5120
    s_waitcnt lgkmcnt(5)
    v_mfma_f32_16x16x32_bf16 v[0:3], v[88:91], v[136:139], v[0:3]
    ds_read_b128 v[144:147], v164 offset:4224
    ds_read_b64_tr_b16 v[92:93], v165 offset:4096
    s_waitcnt lgkmcnt(4)
    v_mfma_f32_16x16x32_bf16 v[12:15], v[76:79], v[140:143], 0
    ds_read_b64_tr_b16 v[94:95], v165 offset:5120
    ds_read_b64_tr_b16 v[104:105], v166 offset:6144
    v_mfma_f32_16x16x32_bf16 v[16:19], v[80:83], v[140:143], 0
    ds_read_b64_tr_b16 v[106:107], v166 offset:7168
    ds_read_b64_tr_b16 v[100:101], v165 offset:6144
    v_mfma_f32_16x16x32_bf16 v[4:7], v[84:87], v[140:143], v[4:7]
    ds_read_b64_tr_b16 v[102:103], v165 offset:7168
    v_mfma_f32_16x16x32_bf16 v[8:11], v[88:91], v[140:143], v[8:11]
    s_waitcnt lgkmcnt(7)
    v_mfma_f32_16x16x32_bf16 v[0:3], v[96:99], v[140:143], v[0:3]
    s_waitcnt lgkmcnt(6)
    v_mfma_f32_16x16x32_bf16 v[20:23], v[76:79], v[144:147], 0
    v_mfma_f32_16x16x32_bf16 v[24:27], v[80:83], v[144:147], 0
    v_mfma_f32_16x16x32_bf16 v[12:15], v[84:87], v[144:147], v[12:15]
    s_barrier
    ds_read_b128 v[148:151], v164 offset:5632
    v_mfma_f32_16x16x32_bf16 v[16:19], v[88:91], v[144:147], v[16:19]
    ds_read_b64_tr_b16 v[112:113], v166 offset:8192
    ds_read_b64_tr_b16 v[114:115], v166 offset:9216
    s_waitcnt lgkmcnt(6)
    v_mfma_f32_16x16x32_bf16 v[4:7], v[92:95], v[144:147], v[4:7]
    ds_read_b128 v[152:155], v164 offset:7040
    ds_read_b64_tr_b16 v[108:109], v165 offset:8192
    v_mfma_f32_16x16x32_bf16 v[8:11], v[96:99], v[144:147], v[8:11]
    ds_read_b64_tr_b16 v[110:111], v165 offset:9216
    ds_read_b64_tr_b16 v[120:121], v166 offset:10240
    s_waitcnt lgkmcnt(7)
    v_mfma_f32_16x16x32_bf16 v[0:3], v[104:107], v[144:147], v[0:3]
    ds_read_b64_tr_b16 v[122:123], v166 offset:11264
    ds_read_b64_tr_b16 v[116:117], v165 offset:10240
    s_waitcnt lgkmcnt(8)
    v_mfma_f32_16x16x32_bf16 v[28:31], v[76:79], v[148:151], 0
    ds_read_b64_tr_b16 v[118:119], v165 offset:11264
    v_mfma_f32_16x16x32_bf16 v[32:35], v[80:83], v[148:151], 0
    v_mfma_f32_16x16x32_bf16 v[20:23], v[84:87], v[148:151], v[20:23]
    v_mfma_f32_16x16x32_bf16 v[24:27], v[88:91], v[148:151], v[24:27]
    v_mfma_f32_16x16x32_bf16 v[12:15], v[92:95], v[148:151], v[12:15]
    v_mfma_f32_16x16x32_bf16 v[16:19], v[96:99], v[148:151], v[16:19]
    v_mfma_f32_16x16x32_bf16 v[4:7], v[100:103], v[148:151], v[4:7]
    v_mfma_f32_16x16x32_bf16 v[8:11], v[104:107], v[148:151], v[8:11]
    s_waitcnt lgkmcnt(1)
    v_mfma_f32_16x16x32_bf16 v[0:3], v[112:115], v[148:151], v[0:3]
    v_mfma_f32_16x16x32_bf16 v[36:39], v[76:79], v[152:155], 0
    v_mfma_f32_16x16x32_bf16 v[40:43], v[80:83], v[152:155], 0
    v_mfma_f32_16x16x32_bf16 v[28:31], v[84:87], v[152:155], v[28:31]
    v_mfma_f32_16x16x32_bf16 v[32:35], v[88:91], v[152:155], v[32:35]
    v_mfma_f32_16x16x32_bf16 v[20:23], v[92:95], v[152:155], v[20:23]
    v_mfma_f32_16x16x32_bf16 v[24:27], v[96:99], v[152:155], v[24:27]
    v_mfma_f32_16x16x32_bf16 v[12:15], v[100:103], v[152:155], v[12:15]
    s_barrier
    ds_read_b128 v[156:159], v164 offset:8448
    v_mfma_f32_16x16x32_bf16 v[16:19], v[104:107], v[152:155], v[16:19]
    ds_read_b64_tr_b16 v[128:129], v166 offset:12288
    ds_read_b64_tr_b16 v[130:131], v166 offset:13312
    v_mfma_f32_16x16x32_bf16 v[4:7], v[108:111], v[152:155], v[4:7]
    ds_read_b128 v[160:163], v164 offset:9856
    ds_read_b64_tr_b16 v[124:125], v165 offset:12288
    v_mfma_f32_16x16x32_bf16 v[8:11], v[112:115], v[152:155], v[8:11]
    ds_read_b64_tr_b16 v[126:127], v165 offset:13312
    v_mfma_f32_16x16x32_bf16 v[0:3], v[120:123], v[152:155], v[0:3]
    s_waitcnt lgkmcnt(5)
    v_mfma_f32_16x16x32_bf16 v[44:47], v[76:79], v[156:159], 0
    v_mfma_f32_16x16x32_bf16 v[48:51], v[80:83], v[156:159], 0
    v_mfma_f32_16x16x32_bf16 v[36:39], v[84:87], v[156:159], v[36:39]
    v_mfma_f32_16x16x32_bf16 v[40:43], v[88:91], v[156:159], v[40:43]
    v_mfma_f32_16x16x32_bf16 v[28:31], v[92:95], v[156:159], v[28:31]
    v_mfma_f32_16x16x32_bf16 v[32:35], v[96:99], v[156:159], v[32:35]
    v_mfma_f32_16x16x32_bf16 v[20:23], v[100:103], v[156:159], v[20:23]
    v_mfma_f32_16x16x32_bf16 v[24:27], v[104:107], v[156:159], v[24:27]
    v_mfma_f32_16x16x32_bf16 v[12:15], v[108:111], v[156:159], v[12:15]
    v_mfma_f32_16x16x32_bf16 v[16:19], v[112:115], v[156:159], v[16:19]
    v_mfma_f32_16x16x32_bf16 v[4:7], v[116:119], v[156:159], v[4:7]
    v_mfma_f32_16x16x32_bf16 v[8:11], v[120:123], v[156:159], v[8:11]
    s_waitcnt lgkmcnt(0)
    v_mfma_f32_16x16x32_bf16 v[0:3], v[128:131], v[156:159], v[0:3]
    v_mfma_f32_16x16x32_bf16 v[52:55], v[76:79], v[160:163], 0
    v_mfma_f32_16x16x32_bf16 v[56:59], v[80:83], v[160:163], 0
    v_mfma_f32_16x16x32_bf16 v[44:47], v[84:87], v[160:163], v[44:47]
    v_mfma_f32_16x16x32_bf16 v[48:51], v[88:91], v[160:163], v[48:51]
    v_mfma_f32_16x16x32_bf16 v[36:39], v[92:95], v[160:163], v[36:39]
    v_mfma_f32_16x16x32_bf16 v[40:43], v[96:99], v[160:163], v[40:43]
    v_mfma_f32_16x16x32_bf16 v[28:31], v[100:103], v[160:163], v[28:31]
    v_mfma_f32_16x16x32_bf16 v[32:35], v[104:107], v[160:163], v[32:35]
    v_mfma_f32_16x16x32_bf16 v[20:23], v[108:111], v[160:163], v[20:23]
    s_barrier
    ds_read_b128 v[132:135], v164 offset:11264
    v_mfma_f32_16x16x32_bf16 v[24:27], v[112:115], v[160:163], v[24:27]
    ds_read_b128 v[136:139], v164 offset:12672
    ds_read_b128 v[140:143], v164 offset:14080
    v_mfma_f32_16x16x32_bf16 v[12:15], v[116:119], v[160:163], v[12:15]
    v_mfma_f32_16x16x32_bf16 v[16:19], v[120:123], v[160:163], v[16:19]
    v_mfma_f32_16x16x32_bf16 v[4:7], v[124:127], v[160:163], v[4:7]
    v_mfma_f32_16x16x32_bf16 v[8:11], v[128:131], v[160:163], v[8:11]
    s_add_u32 s48, s48, 1
    s_waitcnt lgkmcnt(2)
    v_mfma_f32_16x16x32_bf16 v[60:63], v[76:79], v[132:135], 0
    ds_read_b128 v[144:147], v164 offset:15488
    v_mfma_f32_16x16x32_bf16 v[64:67], v[80:83], v[132:135], 0
    s_cmp_eq_u32 s48, 7
    v_mfma_f32_16x16x32_bf16 v[52:55], v[84:87], v[132:135], v[52:55]
    s_cselect_b32 s44, s51, 0
    v_mfma_f32_16x16x32_bf16 v[56:59], v[88:91], v[132:135], v[56:59]
    s_cselect_b32 s48, 0, s48
    v_mfma_f32_16x16x32_bf16 v[44:47], v[92:95], v[132:135], v[44:47]
    s_xor_b32 s50, s50, s44
    v_mfma_f32_16x16x32_bf16 v[48:51], v[96:99], v[132:135], v[48:51]
    v_add_u32 v172, s48, v167
    v_mfma_f32_16x16x32_bf16 v[36:39], v[100:103], v[132:135], v[36:39]
    v_and_b32 v173, 4, v172
    v_mfma_f32_16x16x32_bf16 v[40:43], v[104:107], v[132:135], v[40:43]
    v_lshlrev_b32 v173, 3, v173
    v_mfma_f32_16x16x32_bf16 v[28:31], v[108:111], v[132:135], v[28:31]
    v_xor_b32 v173, v173, v168
    v_mfma_f32_16x16x32_bf16 v[32:35], v[112:115], v[132:135], v[32:35]
    v_lshl_add_u32 v173, v172, 6, v173
    v_mfma_f32_16x16x32_bf16 v[20:23], v[116:119], v[132:135], v[20:23]
    ds_read_b128 v[148:151], v164 offset:16896
    v_mfma_f32_16x16x32_bf16 v[24:27], v[120:123], v[132:135], v[24:27]
    v_add_u32 v170, s50, v173
    v_mfma_f32_16x16x32_bf16 v[12:15], v[124:127], v[132:135], v[12:15]
    v_mfma_f32_16x16x32_bf16 v[16:19], v[128:131], v[132:135], v[16:19]
    s_waitcnt lgkmcnt(1)
    v_mfma_f32_16x16x32_bf16 v[68:71], v[76:79], v[136:139], 0
    v_mfma_f32_16x16x32_bf16 v[72:75], v[80:83], v[136:139], 0
    v_mfma_f32_16x16x32_bf16 v[60:63], v[84:87], v[136:139], v[60:63]
    v_mfma_f32_16x16x32_bf16 v[64:67], v[88:91], v[136:139], v[64:67]
    v_mfma_f32_16x16x32_bf16 v[52:55], v[92:95], v[136:139], v[52:55]
    ds_read_b128 v[152:155], v164 offset:18304
    v_mfma_f32_16x16x32_bf16 v[56:59], v[96:99], v[136:139], v[56:59]
    v_mfma_f32_16x16x32_bf16 v[44:47], v[100:103], v[136:139], v[44:47]
    s_barrier
    v_mfma_f32_16x16x32_bf16 v[48:51], v[104:107], v[136:139], v[48:51]
    s_xor_b32 s52, s52, s53
    v_mfma_f32_16x16x32_bf16 v[36:39], v[108:111], v[136:139], v[36:39]
    v_add_u32 v165, s52, v169
    v_mfma_f32_16x16x32_bf16 v[40:43], v[112:115], v[136:139], v[40:43]
    v_xor_b32 v166, 32, v165
    v_mfma_f32_16x16x32_bf16 v[28:31], v[116:119], v[136:139], v[28:31]
    ds_read_b128 v[156:159], v164 offset:19712
    v_mfma_f32_16x16x32_bf16 v[32:35], v[120:123], v[136:139], v[32:35]
    v_mfma_f32_16x16x32_bf16 v[20:23], v[124:127], v[136:139], v[20:23]
    v_mfma_f32_16x16x32_bf16 v[24:27], v[128:131], v[136:139], v[24:27]
    v_mfma_f32_16x16x32_bf16 v[68:71], v[84:87], v[140:143], v[68:71]
    ds_read_b128 v[160:163], v164 offset:21120
    v_mfma_f32_16x16x32_bf16 v[72:75], v[88:91], v[140:143], v[72:75]
    v_mfma_f32_16x16x32_bf16 v[60:63], v[92:95], v[140:143], v[60:63]
    v_mfma_f32_16x16x32_bf16 v[64:67], v[96:99], v[140:143], v[64:67]
    v_mfma_f32_16x16x32_bf16 v[52:55], v[100:103], v[140:143], v[52:55]
    v_mfma_f32_16x16x32_bf16 v[56:59], v[104:107], v[140:143], v[56:59]
    v_mfma_f32_16x16x32_bf16 v[44:47], v[108:111], v[140:143], v[44:47]
    v_mfma_f32_16x16x32_bf16 v[48:51], v[112:115], v[140:143], v[48:51]
    v_mfma_f32_16x16x32_bf16 v[36:39], v[116:119], v[140:143], v[36:39]
    v_mfma_f32_16x16x32_bf16 v[40:43], v[120:123], v[140:143], v[40:43]
    v_mov_b32 v164, v170
    v_mfma_f32_16x16x32_bf16 v[28:31], v[124:127], v[140:143], v[28:31]
    v_mfma_f32_16x16x32_bf16 v[32:35], v[128:131], v[140:143], v[32:35]
    v_mfma_f32_16x16x32_bf16 v[68:71], v[92:95], v[144:147], v[68:71]
    v_mfma_f32_16x16x32_bf16 v[72:75], v[96:99], v[144:147], v[72:75]
    v_mfma_f32_16x16x32_bf16 v[60:63], v[100:103], v[144:147], v[60:63]
    s_barrier
    v_mfma_f32_16x16x32_bf16 v[64:67], v[104:107], v[144:147], v[64:67]
    v_mfma_f32_16x16x32_bf16 v[52:55], v[108:111], v[144:147], v[52:55]
    v_mfma_f32_16x16x32_bf16 v[56:59], v[112:115], v[144:147], v[56:59]
    v_mfma_f32_16x16x32_bf16 v[44:47], v[116:119], v[144:147], v[44:47]
    v_mfma_f32_16x16x32_bf16 v[48:51], v[120:123], v[144:147], v[48:51]
    v_mfma_f32_16x16x32_bf16 v[36:39], v[124:127], v[144:147], v[36:39]
    v_mfma_f32_16x16x32_bf16 v[40:43], v[128:131], v[144:147], v[40:43]
    s_waitcnt lgkmcnt(0)
    v_mfma_f32_16x16x32_bf16 v[68:71], v[100:103], v[148:151], v[68:71]
    ds_read_b128 v[144:147], v170 offset:4224
    v_mfma_f32_16x16x32_bf16 v[72:75], v[104:107], v[148:151], v[72:75]
    ds_read_b64_tr_b16 v[98:99], v166 offset:5120
    v_mfma_f32_16x16x32_bf16 v[60:63], v[108:111], v[148:151], v[60:63]
    ds_read_b128 v[140:143], v170 offset:2816
    v_mfma_f32_16x16x32_bf16 v[64:67], v[112:115], v[148:151], v[64:67]
    ds_read_b128 v[136:139], v170 offset:1408
    v_mfma_f32_16x16x32_bf16 v[52:55], v[116:119], v[148:151], v[52:55]
    ds_read_b64_tr_b16 v[78:79], v165 offset:1024
    v_mfma_f32_16x16x32_bf16 v[56:59], v[120:123], v[148:151], v[56:59]
    ds_read_b64_tr_b16 v[76:77], v165 offset:0
    v_mfma_f32_16x16x32_bf16 v[44:47], v[124:127], v[148:151], v[44:47]
    ds_read_b128 v[132:135], v170 offset:0
    v_mfma_f32_16x16x32_bf16 v[48:51], v[128:131], v[148:151], v[48:51]
    ds_read_b64_tr_b16 v[82:83], v166 offset:1024
    v_mfma_f32_16x16x32_bf16 v[68:71], v[108:111], v[152:155], v[68:71]
    ds_read_b64_tr_b16 v[80:81], v166 offset:0
    v_mfma_f32_16x16x32_bf16 v[72:75], v[112:115], v[152:155], v[72:75]
    v_mfma_f32_16x16x32_bf16 v[60:63], v[116:119], v[152:155], v[60:63]
    ds_read_b64_tr_b16 v[90:91], v166 offset:3072
    v_mfma_f32_16x16x32_bf16 v[64:67], v[120:123], v[152:155], v[64:67]
    ds_read_b64_tr_b16 v[88:89], v166 offset:2048
    v_mfma_f32_16x16x32_bf16 v[52:55], v[124:127], v[152:155], v[52:55]
    v_mfma_f32_16x16x32_bf16 v[56:59], v[128:131], v[152:155], v[56:59]
    ds_read_b64_tr_b16 v[86:87], v165 offset:3072
    v_mfma_f32_16x16x32_bf16 v[68:71], v[116:119], v[156:159], v[68:71]
    ds_read_b64_tr_b16 v[84:85], v165 offset:2048
    v_mfma_f32_16x16x32_bf16 v[72:75], v[120:123], v[156:159], v[72:75]
    v_mfma_f32_16x16x32_bf16 v[60:63], v[124:127], v[156:159], v[60:63]
    ds_read_b64_tr_b16 v[96:97], v166 offset:4096
    v_mfma_f32_16x16x32_bf16 v[64:67], v[128:131], v[156:159], v[64:67]
    v_mfma_f32_16x16x32_bf16 v[68:71], v[124:127], v[160:163], v[68:71]
    ds_read_b64_tr_b16 v[94:95], v165 offset:5120
    v_mfma_f32_16x16x32_bf16 v[72:75], v[128:131], v[160:163], v[72:75]
    s_waitcnt lgkmcnt(4)
    s_barrier
C_PB_LOOP:
    v_mfma_f32_16x16x32_bf16 v[0:3], v[80:83], v[132:135], v[0:3]
    v_mfma_f32_16x16x32_bf16 v[4:7], v[76:79], v[136:139], v[4:7]
    ds_read_b64_tr_b16 v[92:93], v165 offset:4096
    v_mfma_f32_16x16x32_bf16 v[8:11], v[80:83], v[136:139], v[8:11]
    ds_read_b64_tr_b16 v[106:107], v166 offset:7168
    v_mfma_f32_16x16x32_bf16 v[0:3], v[88:91], v[136:139], v[0:3]
    ds_read_b64_tr_b16 v[104:105], v166 offset:6144
    v_mfma_f32_16x16x32_bf16 v[12:15], v[76:79], v[140:143], v[12:15]
    ds_read_b128 v[148:151], v164 offset:5632
    v_mfma_f32_16x16x32_bf16 v[16:19], v[80:83], v[140:143], v[16:19]
    s_waitcnt lgkmcnt(5)
    v_mfma_f32_16x16x32_bf16 v[4:7], v[84:87], v[140:143], v[4:7]
    v_mfma_f32_16x16x32_bf16 v[8:11], v[88:91], v[140:143], v[8:11]
    ds_read_b128 v[152:155], v164 offset:7040
    v_mfma_f32_16x16x32_bf16 v[0:3], v[96:99], v[140:143], v[0:3]
    ds_read_b64_tr_b16 v[114:115], v166 offset:9216
    v_mfma_f32_16x16x32_bf16 v[20:23], v[76:79], v[144:147], v[20:23]
    ds_read_b64_tr_b16 v[102:103], v165 offset:7168
    v_mfma_f32_16x16x32_bf16 v[24:27], v[80:83], v[144:147], v[24:27]
    ds_read_b64_tr_b16 v[100:101], v165 offset:6144
    v_mfma_f32_16x16x32_bf16 v[12:15], v[84:87], v[144:147], v[12:15]
    v_mfma_f32_16x16x32_bf16 v[16:19], v[88:91], v[144:147], v[16:19]
    ds_read_b64_tr_b16 v[112:113], v166 offset:8192
    s_waitcnt lgkmcnt(5)
    v_mfma_f32_16x16x32_bf16 v[4:7], v[92:95], v[144:147], v[4:7]
    v_mfma_f32_16x16x32_bf16 v[8:11], v[96:99], v[144:147], v[8:11]
    v_mfma_f32_16x16x32_bf16 v[0:3], v[104:107], v[144:147], v[0:3]
    v_mfma_f32_16x16x32_bf16 v[28:31], v[76:79], v[148:151], v[28:31]
    v_mfma_f32_16x16x32_bf16 v[32:35], v[80:83], v[148:151], v[32:35]
    v_mfma_f32_16x16x32_bf16 v[20:23], v[84:87], v[148:151], v[20:23]
    ds_read_b128 v[156:159], v164 offset:8448
    v_mfma_f32_16x16x32_bf16 v[24:27], v[88:91], v[148:151], v[24:27]
    ds_read_b64_tr_b16 v[122:123], v166 offset:11264
    v_mfma_f32_16x16x32_bf16 v[12:15], v[92:95], v[148:151], v[12:15]
    ds_read_b64_tr_b16 v[110:111], v165 offset:9216
    v_mfma_f32_16x16x32_bf16 v[16:19], v[96:99], v[148:151], v[16:19]
    ds_read_b64_tr_b16 v[108:109], v165 offset:8192
    s_waitcnt lgkmcnt(4)
    v_mfma_f32_16x16x32_bf16 v[4:7], v[100:103], v[148:151], v[4:7]
    v_mfma_f32_16x16x32_bf16 v[8:11], v[104:107], v[148:151], v[8:11]
    ds_read_b64_tr_b16 v[120:121], v166 offset:10240
    v_mfma_f32_16x16x32_bf16 v[0:3], v[112:115], v[148:151], v[0:3]
    v_mfma_f32_16x16x32_bf16 v[36:39], v[76:79], v[152:155], v[36:39]
    v_mfma_f32_16x16x32_bf16 v[40:43], v[80:83], v[152:155], v[40:43]
    v_mfma_f32_16x16x32_bf16 v[28:31], v[84:87], v[152:155], v[28:31]
    v_mfma_f32_16x16x32_bf16 v[32:35], v[88:91], v[152:155], v[32:35]
    v_mfma_f32_16x16x32_bf16 v[20:23], v[92:95], v[152:155], v[20:23]
    v_mfma_f32_16x16x32_bf16 v[24:27], v[96:99], v[152:155], v[24:27]
    v_mfma_f32_16x16x32_bf16 v[12:15], v[100:103], v[152:155], v[12:15]
    ds_read_b128 v[160:163], v164 offset:9856
    v_mfma_f32_16x16x32_bf16 v[16:19], v[104:107], v[152:155], v[16:19]
    ds_read_b64_tr_b16 v[130:131], v166 offset:13312
    s_waitcnt lgkmcnt(2)
    v_mfma_f32_16x16x32_bf16 v[4:7], v[108:111], v[152:155], v[4:7]
    ds_read_b64_tr_b16 v[118:119], v165 offset:11264
    v_mfma_f32_16x16x32_bf16 v[8:11], v[112:115], v[152:155], v[8:11]
    ds_read_b64_tr_b16 v[116:117], v165 offset:10240
    v_mfma_f32_16x16x32_bf16 v[0:3], v[120:123], v[152:155], v[0:3]
    v_mfma_f32_16x16x32_bf16 v[44:47], v[76:79], v[156:159], v[44:47]
    ds_read_b64_tr_b16 v[128:129], v166 offset:12288
    v_mfma_f32_16x16x32_bf16 v[48:51], v[80:83], v[156:159], v[48:51]
    v_mfma_f32_16x16x32_bf16 v[36:39], v[84:87], v[156:159], v[36:39]
    v_mfma_f32_16x16x32_bf16 v[40:43], v[88:91], v[156:159], v[40:43]
    v_mfma_f32_16x16x32_bf16 v[28:31], v[92:95], v[156:159], v[28:31]
    v_mfma_f32_16x16x32_bf16 v[32:35], v[96:99], v[156:159], v[32:35]
    v_mfma_f32_16x16x32_bf16 v[20:23], v[100:103], v[156:159], v[20:23]
    v_mfma_f32_16x16x32_bf16 v[24:27], v[104:107], v[156:159], v[24:27]
    v_mfma_f32_16x16x32_bf16 v[12:15], v[108:111], v[156:159], v[12:15]
    v_mfma_f32_16x16x32_bf16 v[16:19], v[112:115], v[156:159], v[16:19]
    s_waitcnt lgkmcnt(0)
    v_mfma_f32_16x16x32_bf16 v[4:7], v[116:119], v[156:159], v[4:7]
    v_mfma_f32_16x16x32_bf16 v[8:11], v[120:123], v[156:159], v[8:11]
    ds_read_b64_tr_b16 v[126:127], v165 offset:13312
    v_mfma_f32_16x16x32_bf16 v[0:3], v[128:131], v[156:159], v[0:3]
    ds_read_b64_tr_b16 v[124:125], v165 offset:12288
    v_mfma_f32_16x16x32_bf16 v[52:55], v[76:79], v[160:163], v[52:55]
    v_mfma_f32_16x16x32_bf16 v[56:59], v[80:83], v[160:163], v[56:59]
    v_mfma_f32_16x16x32_bf16 v[44:47], v[84:87], v[160:163], v[44:47]
    ds_read_b128 v[132:135], v164 offset:11264
    v_mfma_f32_16x16x32_bf16 v[48:51], v[88:91], v[160:163], v[48:51]
    v_mfma_f32_16x16x32_bf16 v[36:39], v[92:95], v[160:163], v[36:39]
    v_mfma_f32_16x16x32_bf16 v[40:43], v[96:99], v[160:163], v[40:43]
    v_mfma_f32_16x16x32_bf16 v[28:31], v[100:103], v[160:163], v[28:31]
    v_mfma_f32_16x16x32_bf16 v[32:35], v[104:107], v[160:163], v[32:35]
    v_mfma_f32_16x16x32_bf16 v[20:23], v[108:111], v[160:163], v[20:23]
    v_mfma_f32_16x16x32_bf16 v[24:27], v[112:115], v[160:163], v[24:27]
    v_mfma_f32_16x16x32_bf16 v[12:15], v[116:119], v[160:163], v[12:15]
    s_waitcnt lgkmcnt(1)
    s_barrier
    v_mfma_f32_16x16x32_bf16 v[16:19], v[120:123], v[160:163], v[16:19]
    s_xor_b32 s52, s52, s53
    v_mfma_f32_16x16x32_bf16 v[4:7], v[124:127], v[160:163], v[4:7]
    v_add_u32 v165, s52, v169
    v_mfma_f32_16x16x32_bf16 v[8:11], v[128:131], v[160:163], v[8:11]
    v_xor_b32 v166, 32, v165
    s_waitcnt lgkmcnt(0)
    v_mfma_f32_16x16x32_bf16 v[60:63], v[76:79], v[132:135], v[60:63]
    v_mfma_f32_16x16x32_bf16 v[64:67], v[80:83], v[132:135], v[64:67]
    s_add_u32 s48, s48, 1
    v_mfma_f32_16x16x32_bf16 v[52:55], v[84:87], v[132:135], v[52:55]
    ds_read_b128 v[136:139], v164 offset:12672
    v_mfma_f32_16x16x32_bf16 v[56:59], v[88:91], v[132:135], v[56:59]
    s_cmp_eq_u32 s48, 7
    v_mfma_f32_16x16x32_bf16 v[44:47], v[92:95], v[132:135], v[44:47]
    s_cselect_b32 s44, s51, 0
    v_mfma_f32_16x16x32_bf16 v[48:51], v[96:99], v[132:135], v[48:51]
    s_cselect_b32 s48, 0, s48
    v_mfma_f32_16x16x32_bf16 v[36:39], v[100:103], v[132:135], v[36:39]
    s_xor_b32 s50, s50, s44
    v_mfma_f32_16x16x32_bf16 v[40:43], v[104:107], v[132:135], v[40:43]
    v_add_u32 v172, s48, v167
    v_mfma_f32_16x16x32_bf16 v[28:31], v[108:111], v[132:135], v[28:31]
    v_and_b32 v173, 4, v172
    v_mfma_f32_16x16x32_bf16 v[32:35], v[112:115], v[132:135], v[32:35]
    v_lshlrev_b32 v173, 3, v173
    v_mfma_f32_16x16x32_bf16 v[20:23], v[116:119], v[132:135], v[20:23]
    v_xor_b32 v173, v173, v168
    v_mfma_f32_16x16x32_bf16 v[24:27], v[120:123], v[132:135], v[24:27]
    v_lshl_add_u32 v173, v172, 6, v173
    v_mfma_f32_16x16x32_bf16 v[12:15], v[124:127], v[132:135], v[12:15]
    v_add_u32 v170, s50, v173
    v_mfma_f32_16x16x32_bf16 v[16:19], v[128:131], v[132:135], v[16:19]
    s_waitcnt lgkmcnt(0)
    v_mfma_f32_16x16x32_bf16 v[68:71], v[76:79], v[136:139], v[68:71]
    v_mfma_f32_16x16x32_bf16 v[72:75], v[80:83], v[136:139], v[72:75]
    v_mfma_f32_16x16x32_bf16 v[60:63], v[84:87], v[136:139], v[60:63]
    ds_read_b128 v[140:143], v164 offset:14080
    v_mfma_f32_16x16x32_bf16 v[64:67], v[88:91], v[136:139], v[64:67]
    v_mfma_f32_16x16x32_bf16 v[52:55], v[92:95], v[136:139], v[52:55]
    v_mfma_f32_16x16x32_bf16 v[56:59], v[96:99], v[136:139], v[56:59]
    v_mfma_f32_16x16x32_bf16 v[44:47], v[100:103], v[136:139], v[44:47]
    v_mfma_f32_16x16x32_bf16 v[48:51], v[104:107], v[136:139], v[48:51]
    v_mfma_f32_16x16x32_bf16 v[36:39], v[108:111], v[136:139], v[36:39]
    v_mfma_f32_16x16x32_bf16 v[40:43], v[112:115], v[136:139], v[40:43]
    v_mfma_f32_16x16x32_bf16 v[28:31], v[116:119], v[136:139], v[28:31]
    v_mfma_f32_16x16x32_bf16 v[32:35], v[120:123], v[136:139], v[32:35]
    v_mfma_f32_16x16x32_bf16 v[20:23], v[124:127], v[136:139], v[20:23]
    v_mfma_f32_16x16x32_bf16 v[24:27], v[128:131], v[136:139], v[24:27]
    s_waitcnt lgkmcnt(0)
    v_mfma_f32_16x16x32_bf16 v[68:71], v[84:87], v[140:143], v[68:71]
    ds_read_b128 v[144:147], v164 offset:15488
    v_mfma_f32_16x16x32_bf16 v[72:75], v[88:91], v[140:143], v[72:75]
    v_mfma_f32_16x16x32_bf16 v[60:63], v[92:95], v[140:143], v[60:63]
    v_mfma_f32_16x16x32_bf16 v[64:67], v[96:99], v[140:143], v[64:67]
    v_mfma_f32_16x16x32_bf16 v[52:55], v[100:103], v[140:143], v[52:55]
    v_mfma_f32_16x16x32_bf16 v[56:59], v[104:107], v[140:143], v[56:59]
    v_mfma_f32_16x16x32_bf16 v[44:47], v[108:111], v[140:143], v[44:47]
    v_mfma_f32_16x16x32_bf16 v[48:51], v[112:115], v[140:143], v[48:51]
    v_mfma_f32_16x16x32_bf16 v[36:39], v[116:119], v[140:143], v[36:39]
    v_mfma_f32_16x16x32_bf16 v[40:43], v[120:123], v[140:143], v[40:43]
    v_mfma_f32_16x16x32_bf16 v[28:31], v[124:127], v[140:143], v[28:31]
    ds_read_b128 v[148:151], v164 offset:16896
    v_mfma_f32_16x16x32_bf16 v[32:35], v[128:131], v[140:143], v[32:35]
    s_waitcnt lgkmcnt(1)
    v_mfma_f32_16x16x32_bf16 v[68:71], v[92:95], v[144:147], v[68:71]
    v_mfma_f32_16x16x32_bf16 v[72:75], v[96:99], v[144:147], v[72:75]
    v_mfma_f32_16x16x32_bf16 v[60:63], v[100:103], v[144:147], v[60:63]
    v_mfma_f32_16x16x32_bf16 v[64:67], v[104:107], v[144:147], v[64:67]
    v_mfma_f32_16x16x32_bf16 v[52:55], v[108:111], v[144:147], v[52:55]
    v_mfma_f32_16x16x32_bf16 v[56:59], v[112:115], v[144:147], v[56:59]
    v_mfma_f32_16x16x32_bf16 v[44:47], v[116:119], v[144:147], v[44:47]
    ds_read_b128 v[152:155], v164 offset:18304
    v_mfma_f32_16x16x32_bf16 v[48:51], v[120:123], v[144:147], v[48:51]
    v_mfma_f32_16x16x32_bf16 v[36:39], v[124:127], v[144:147], v[36:39]
    ds_read_b128 v[160:163], v164 offset:21120
    v_mfma_f32_16x16x32_bf16 v[40:43], v[128:131], v[144:147], v[40:43]
    ds_read_b128 v[156:159], v164 offset:19712
    s_waitcnt lgkmcnt(3)
    v_mfma_f32_16x16x32_bf16 v[68:71], v[100:103], v[148:151], v[68:71]
    ds_read_b128 v[144:147], v170 offset:4224
    v_mfma_f32_16x16x32_bf16 v[72:75], v[104:107], v[148:151], v[72:75]
    ds_read_b64_tr_b16 v[98:99], v166 offset:5120
    v_mfma_f32_16x16x32_bf16 v[60:63], v[108:111], v[148:151], v[60:63]
    ds_read_b128 v[140:143], v170 offset:2816
    v_mfma_f32_16x16x32_bf16 v[64:67], v[112:115], v[148:151], v[64:67]
    ds_read_b128 v[136:139], v170 offset:1408
    v_mfma_f32_16x16x32_bf16 v[52:55], v[116:119], v[148:151], v[52:55]
    ds_read_b64_tr_b16 v[78:79], v165 offset:1024
    v_mfma_f32_16x16x32_bf16 v[56:59], v[120:123], v[148:151], v[56:59]
    ds_read_b64_tr_b16 v[76:77], v165 offset:0
    v_mfma_f32_16x16x32_bf16 v[44:47], v[124:127], v[148:151], v[44:47]
    ds_read_b128 v[132:135], v170 offset:0
    v_mfma_f32_16x16x32_bf16 v[48:51], v[128:131], v[148:151], v[48:51]
    ds_read_b64_tr_b16 v[82:83], v166 offset:1024
    s_waitcnt lgkmcnt(8)
    v_mfma_f32_16x16x32_bf16 v[68:71], v[108:111], v[152:155], v[68:71]
    ds_read_b64_tr_b16 v[80:81], v166 offset:0
    v_mfma_f32_16x16x32_bf16 v[72:75], v[112:115], v[152:155], v[72:75]
    v_mov_b32 v164, v170
    v_mfma_f32_16x16x32_bf16 v[60:63], v[116:119], v[152:155], v[60:63]
    ds_read_b64_tr_b16 v[90:91], v166 offset:3072
    v_mfma_f32_16x16x32_bf16 v[64:67], v[120:123], v[152:155], v[64:67]
    ds_read_b64_tr_b16 v[88:89], v166 offset:2048
    v_mfma_f32_16x16x32_bf16 v[52:55], v[124:127], v[152:155], v[52:55]
    s_add_u32 s49, s49, 1
    v_mfma_f32_16x16x32_bf16 v[56:59], v[128:131], v[152:155], v[56:59]
    ds_read_b64_tr_b16 v[86:87], v165 offset:3072
    v_mfma_f32_16x16x32_bf16 v[68:71], v[116:119], v[156:159], v[68:71]
    ds_read_b64_tr_b16 v[84:85], v165 offset:2048
    v_mfma_f32_16x16x32_bf16 v[72:75], v[120:123], v[156:159], v[72:75]
    s_cmp_lt_u32 s49, 20
    v_mfma_f32_16x16x32_bf16 v[60:63], v[124:127], v[156:159], v[60:63]
    ds_read_b64_tr_b16 v[96:97], v166 offset:4096
    v_mfma_f32_16x16x32_bf16 v[64:67], v[128:131], v[156:159], v[64:67]
    v_mfma_f32_16x16x32_bf16 v[68:71], v[124:127], v[160:163], v[68:71]
    ds_read_b64_tr_b16 v[94:95], v165 offset:5120
    s_waitcnt lgkmcnt(4)
    v_mfma_f32_16x16x32_bf16 v[72:75], v[128:131], v[160:163], v[72:75]
    s_cbranch_scc1 C_PB_LOOP
    v_mfma_f32_16x16x32_bf16 v[0:3], v[80:83], v[132:135], v[0:3]
    v_mfma_f32_16x16x32_bf16 v[4:7], v[76:79], v[136:139], v[4:7]
    ds_read_b64_tr_b16 v[92:93], v165 offset:4096
    v_mfma_f32_16x16x32_bf16 v[8:11], v[80:83], v[136:139], v[8:11]
    ds_read_b64_tr_b16 v[106:107], v166 offset:7168
    v_mfma_f32_16x16x32_bf16 v[0:3], v[88:91], v[136:139], v[0:3]
    ds_read_b64_tr_b16 v[104:105], v166 offset:6144
    v_mfma_f32_16x16x32_bf16 v[12:15], v[76:79], v[140:143], v[12:15]
    ds_read_b128 v[148:151], v164 offset:5632
    v_mfma_f32_16x16x32_bf16 v[16:19], v[80:83], v[140:143], v[16:19]
    s_waitcnt lgkmcnt(5)
    v_mfma_f32_16x16x32_bf16 v[4:7], v[84:87], v[140:143], v[4:7]
    v_mfma_f32_16x16x32_bf16 v[8:11], v[88:91], v[140:143], v[8:11]
    v_mfma_f32_16x16x32_bf16 v[0:3], v[96:99], v[140:143], v[0:3]
    v_mfma_f32_16x16x32_bf16 v[20:23], v[76:79], v[144:147], v[20:23]
    ds_read_b64_tr_b16 v[102:103], v165 offset:7168
    v_mfma_f32_16x16x32_bf16 v[24:27], v[80:83], v[144:147], v[24:27]
    ds_read_b64_tr_b16 v[100:101], v165 offset:6144
    v_mfma_f32_16x16x32_bf16 v[12:15], v[84:87], v[144:147], v[12:15]
    v_mfma_f32_16x16x32_bf16 v[16:19], v[88:91], v[144:147], v[16:19]
    ds_read_b128 v[152:155], v164 offset:7040
    s_waitcnt lgkmcnt(3)
    v_mfma_f32_16x16x32_bf16 v[4:7], v[92:95], v[144:147], v[4:7]
    v_mfma_f32_16x16x32_bf16 v[8:11], v[96:99], v[144:147], v[8:11]
    v_mfma_f32_16x16x32_bf16 v[0:3], v[104:107], v[144:147], v[0:3]
    v_mfma_f32_16x16x32_bf16 v[28:31], v[76:79], v[148:151], v[28:31]
    v_mfma_f32_16x16x32_bf16 v[32:35], v[80:83], v[148:151], v[32:35]
    v_mfma_f32_16x16x32_bf16 v[20:23], v[84:87], v[148:151], v[20:23]
    v_mfma_f32_16x16x32_bf16 v[24:27], v[88:91], v[148:151], v[24:27]
    v_mfma_f32_16x16x32_bf16 v[12:15], v[92:95], v[148:151], v[12:15]
    ds_read_b128 v[156:159], v164 offset:8448
    v_mfma_f32_16x16x32_bf16 v[16:19], v[96:99], v[148:151], v[16:19]
    s_waitcnt lgkmcnt(1)
    v_mfma_f32_16x16x32_bf16 v[4:7], v[100:103], v[148:151], v[4:7]
    v_mfma_f32_16x16x32_bf16 v[8:11], v[104:107], v[148:151], v[8:11]
    v_mfma_f32_16x16x32_bf16 v[36:39], v[76:79], v[152:155], v[36:39]
    v_mfma_f32_16x16x32_bf16 v[40:43], v[80:83], v[152:155], v[40:43]
    v_mfma_f32_16x16x32_bf16 v[28:31], v[84:87], v[152:155], v[28:31]
    v_mfma_f32_16x16x32_bf16 v[32:35], v[88:91], v[152:155], v[32:35]
    v_mfma_f32_16x16x32_bf16 v[20:23], v[92:95], v[152:155], v[20:23]
    ds_read_b128 v[160:163], v164 offset:9856
    v_mfma_f32_16x16x32_bf16 v[24:27], v[96:99], v[152:155], v[24:27]
    v_mfma_f32_16x16x32_bf16 v[12:15], v[100:103], v[152:155], v[12:15]
    v_mfma_f32_16x16x32_bf16 v[16:19], v[104:107], v[152:155], v[16:19]
    ds_read_b128 v[136:139], v164 offset:12672
    s_waitcnt lgkmcnt(2)
    v_mfma_f32_16x16x32_bf16 v[44:47], v[76:79], v[156:159], v[44:47]
    ds_read_b64_tr_b16 v[126:127], v165 offset:13312
    v_mfma_f32_16x16x32_bf16 v[48:51], v[80:83], v[156:159], v[48:51]
    ds_read_b64_tr_b16 v[124:125], v165 offset:12288
    v_mfma_f32_16x16x32_bf16 v[36:39], v[84:87], v[156:159], v[36:39]
    ds_read_b64_tr_b16 v[130:131], v166 offset:13312
    v_mfma_f32_16x16x32_bf16 v[40:43], v[88:91], v[156:159], v[40:43]
    ds_read_b64_tr_b16 v[128:129], v166 offset:12288
    v_mfma_f32_16x16x32_bf16 v[28:31], v[92:95], v[156:159], v[28:31]
    ds_read_b128 v[132:135], v164 offset:11264
    v_mfma_f32_16x16x32_bf16 v[32:35], v[96:99], v[156:159], v[32:35]
    ds_read_b64_tr_b16 v[118:119], v165 offset:11264
    v_mfma_f32_16x16x32_bf16 v[20:23], v[100:103], v[156:159], v[20:23]
    ds_read_b64_tr_b16 v[116:117], v165 offset:10240
    v_mfma_f32_16x16x32_bf16 v[24:27], v[104:107], v[156:159], v[24:27]
    ds_read_b64_tr_b16 v[122:123], v166 offset:11264
    s_waitcnt lgkmcnt(8)
    v_mfma_f32_16x16x32_bf16 v[52:55], v[76:79], v[160:163], v[52:55]
    ds_read_b64_tr_b16 v[120:121], v166 offset:10240
    v_mfma_f32_16x16x32_bf16 v[56:59], v[80:83], v[160:163], v[56:59]
    ds_read_b64_tr_b16 v[110:111], v165 offset:9216
    v_mfma_f32_16x16x32_bf16 v[44:47], v[84:87], v[160:163], v[44:47]
    ds_read_b64_tr_b16 v[108:109], v165 offset:8192
    v_mfma_f32_16x16x32_bf16 v[48:51], v[88:91], v[160:163], v[48:51]
    ds_read_b64_tr_b16 v[114:115], v166 offset:9216
    v_mfma_f32_16x16x32_bf16 v[36:39], v[92:95], v[160:163], v[36:39]
    ds_read_b64_tr_b16 v[112:113], v166 offset:8192
    v_mfma_f32_16x16x32_bf16 v[40:43], v[96:99], v[160:163], v[40:43]
    v_mfma_f32_16x16x32_bf16 v[28:31], v[100:103], v[160:163], v[28:31]
    v_mfma_f32_16x16x32_bf16 v[32:35], v[104:107], v[160:163], v[32:35]
    s_waitcnt lgkmcnt(5)
    v_mfma_f32_16x16x32_bf16 v[60:63], v[76:79], v[132:135], v[60:63]
    v_mfma_f32_16x16x32_bf16 v[64:67], v[80:83], v[132:135], v[64:67]
    v_mfma_f32_16x16x32_bf16 v[52:55], v[84:87], v[132:135], v[52:55]
    v_mfma_f32_16x16x32_bf16 v[56:59], v[88:91], v[132:135], v[56:59]
    v_mfma_f32_16x16x32_bf16 v[44:47], v[92:95], v[132:135], v[44:47]
    ds_read_b128 v[140:143], v164 offset:14080
    v_mfma_f32_16x16x32_bf16 v[48:51], v[96:99], v[132:135], v[48:51]
    v_mfma_f32_16x16x32_bf16 v[36:39], v[100:103], v[132:135], v[36:39]
    v_mfma_f32_16x16x32_bf16 v[40:43], v[104:107], v[132:135], v[40:43]
    v_mfma_f32_16x16x32_bf16 v[68:71], v[76:79], v[136:139], v[68:71]
    v_mfma_f32_16x16x32_bf16 v[72:75], v[80:83], v[136:139], v[72:75]
    v_mfma_f32_16x16x32_bf16 v[60:63], v[84:87], v[136:139], v[60:63]
    ds_read_b128 v[144:147], v164 offset:15488
    v_mfma_f32_16x16x32_bf16 v[64:67], v[88:91], v[136:139], v[64:67]
    s_waitcnt lgkmcnt(2)
    s_barrier
    v_mfma_f32_16x16x32_bf16 v[52:55], v[92:95], v[136:139], v[52:55]
    v_mfma_f32_16x16x32_bf16 v[56:59], v[96:99], v[136:139], v[56:59]
    v_mfma_f32_16x16x32_bf16 v[44:47], v[100:103], v[136:139], v[44:47]
    v_mfma_f32_16x16x32_bf16 v[48:51], v[104:107], v[136:139], v[48:51]
    s_waitcnt lgkmcnt(1)
    v_mfma_f32_16x16x32_bf16 v[68:71], v[84:87], v[140:143], v[68:71]
    v_mfma_f32_16x16x32_bf16 v[72:75], v[88:91], v[140:143], v[72:75]
    v_mfma_f32_16x16x32_bf16 v[60:63], v[92:95], v[140:143], v[60:63]
    v_mfma_f32_16x16x32_bf16 v[64:67], v[96:99], v[140:143], v[64:67]
    v_mfma_f32_16x16x32_bf16 v[52:55], v[100:103], v[140:143], v[52:55]
    v_mfma_f32_16x16x32_bf16 v[56:59], v[104:107], v[140:143], v[56:59]
    s_waitcnt lgkmcnt(0)
    v_mfma_f32_16x16x32_bf16 v[68:71], v[92:95], v[144:147], v[68:71]
    ds_read_b128 v[140:143], v164 offset:16896
    v_mfma_f32_16x16x32_bf16 v[72:75], v[96:99], v[144:147], v[72:75]
    v_mfma_f32_16x16x32_bf16 v[60:63], v[100:103], v[144:147], v[60:63]
    v_mfma_f32_16x16x32_bf16 v[64:67], v[104:107], v[144:147], v[64:67]
    s_waitcnt lgkmcnt(0)
    v_mfma_f32_16x16x32_bf16 v[68:71], v[100:103], v[140:143], v[68:71]
    v_mfma_f32_16x16x32_bf16 v[72:75], v[104:107], v[140:143], v[72:75]
    v_mfma_f32_16x16x32_bf16 v[0:3], v[112:115], v[148:151], v[0:3]
    v_mfma_f32_16x16x32_bf16 v[0:3], v[120:123], v[152:155], v[0:3]
    v_mfma_f32_16x16x32_bf16 v[0:3], v[128:131], v[156:159], v[0:3]
    v_mfma_f32_16x16x32_bf16 v[4:7], v[108:111], v[152:155], v[4:7]
    v_mfma_f32_16x16x32_bf16 v[8:11], v[112:115], v[152:155], v[8:11]
    v_mfma_f32_16x16x32_bf16 v[4:7], v[116:119], v[156:159], v[4:7]
    v_mfma_f32_16x16x32_bf16 v[8:11], v[120:123], v[156:159], v[8:11]
    v_mfma_f32_16x16x32_bf16 v[4:7], v[124:127], v[160:163], v[4:7]
    s_nop 2
    v_cvt_pk_bf16_f32 v0, v0, v1
    s_nop 0
    v_cvt_pk_bf16_f32 v1, v2, v3
    v_mfma_f32_16x16x32_bf16 v[8:11], v[128:131], v[160:163], v[8:11]
    s_mov_b32 s45, 0
    buffer_store_dwordx2 v[0:1], v180, s[20:23], s45 offen offset:32
    v_mfma_f32_16x16x32_bf16 v[12:15], v[108:111], v[156:159], v[12:15]
    v_mfma_f32_16x16x32_bf16 v[16:19], v[112:115], v[156:159], v[16:19]
    v_mfma_f32_16x16x32_bf16 v[12:15], v[116:119], v[160:163], v[12:15]
    v_mfma_f32_16x16x32_bf16 v[16:19], v[120:123], v[160:163], v[16:19]
    v_mfma_f32_16x16x32_bf16 v[12:15], v[124:127], v[132:135], v[12:15]
    ds_read_b128 v[148:151], v164 offset:14080
    v_cvt_pk_bf16_f32 v4, v4, v5
    v_cvt_pk_bf16_f32 v5, v6, v7
    v_mfma_f32_16x16x32_bf16 v[16:19], v[128:131], v[132:135], v[16:19]
    ds_write_b64 v181, v[4:5] offset:1280
    v_cvt_pk_bf16_f32 v8, v8, v9
    v_mfma_f32_16x16x32_bf16 v[20:23], v[108:111], v[160:163], v[20:23]
    v_cvt_pk_bf16_f32 v9, v10, v11
    ds_write_b64 v181, v[8:9] offset:1312
    v_mfma_f32_16x16x32_bf16 v[24:27], v[112:115], v[160:163], v[24:27]
    ds_read_b128 v[188:191], v182 offset:1280
    v_mfma_f32_16x16x32_bf16 v[20:23], v[116:119], v[132:135], v[20:23]
    v_mfma_f32_16x16x32_bf16 v[24:27], v[120:123], v[132:135], v[24:27]
    v_mfma_f32_16x16x32_bf16 v[20:23], v[124:127], v[136:139], v[20:23]
    v_cvt_pk_bf16_f32 v12, v12, v13
    v_cvt_pk_bf16_f32 v13, v14, v15
    s_waitcnt lgkmcnt(1)
    s_barrier
    v_mfma_f32_16x16x32_bf16 v[24:27], v[128:131], v[136:139], v[24:27]
    ds_write_b64 v181, v[12:13] offset:2560
    v_cvt_pk_bf16_f32 v16, v16, v17
    v_mfma_f32_16x16x32_bf16 v[28:31], v[108:111], v[132:135], v[28:31]
    v_cvt_pk_bf16_f32 v17, v18, v19
    ds_write_b64 v181, v[16:17] offset:2592
    v_mfma_f32_16x16x32_bf16 v[32:35], v[112:115], v[132:135], v[32:35]
    ds_read_b128 v[192:195], v182 offset:2560
    s_mov_b32 s57, 86016
    v_mfma_f32_16x16x32_bf16 v[28:31], v[116:119], v[136:139], v[28:31]
    s_waitcnt lgkmcnt(3)
    buffer_store_dwordx4 v[188:191], v183, s[20:23], s57 offen
    v_mfma_f32_16x16x32_bf16 v[32:35], v[120:123], v[136:139], v[32:35]
    v_mfma_f32_16x16x32_bf16 v[28:31], v[124:127], v[148:151], v[28:31]
    v_cvt_pk_bf16_f32 v20, v20, v21
    v_cvt_pk_bf16_f32 v21, v22, v23
    v_mfma_f32_16x16x32_bf16 v[32:35], v[128:131], v[148:151], v[32:35]
    ds_write_b64 v181, v[20:21] offset:3840
    v_cvt_pk_bf16_f32 v24, v24, v25
    v_mfma_f32_16x16x32_bf16 v[36:39], v[108:111], v[136:139], v[36:39]
    v_cvt_pk_bf16_f32 v25, v26, v27
    ds_write_b64 v181, v[24:25] offset:3872
    v_mfma_f32_16x16x32_bf16 v[40:43], v[112:115], v[136:139], v[40:43]
    ds_read_b128 v[196:199], v182 offset:3840
    s_mov_b32 s57, 172032
    v_mfma_f32_16x16x32_bf16 v[36:39], v[116:119], v[148:151], v[36:39]
    s_waitcnt lgkmcnt(3)
    buffer_store_dwordx4 v[192:195], v183, s[20:23], s57 offen
    v_mfma_f32_16x16x32_bf16 v[40:43], v[120:123], v[148:151], v[40:43]
    v_mfma_f32_16x16x32_bf16 v[36:39], v[124:127], v[144:147], v[36:39]
    ds_read_b128 v[152:155], v164 offset:18304
    v_cvt_pk_bf16_f32 v28, v28, v29
    v_cvt_pk_bf16_f32 v29, v30, v31
    v_mfma_f32_16x16x32_bf16 v[40:43], v[128:131], v[144:147], v[40:43]
    ds_write_b64 v181, v[28:29] offset:5120
    v_cvt_pk_bf16_f32 v32, v32, v33
    v_mfma_f32_16x16x32_bf16 v[44:47], v[108:111], v[148:151], v[44:47]
    v_cvt_pk_bf16_f32 v33, v34, v35
    ds_write_b64 v181, v[32:33] offset:5152
    v_mfma_f32_16x16x32_bf16 v[48:51], v[112:115], v[148:151], v[48:51]
    ds_read_b128 v[200:203], v182 offset:5120
    s_mov_b32 s57, 258048
    v_mfma_f32_16x16x32_bf16 v[44:47], v[116:119], v[144:147], v[44:47]
    s_waitcnt lgkmcnt(4)
    buffer_store_dwordx4 v[196:199], v183, s[20:23], s57 offen
    v_mfma_f32_16x16x32_bf16 v[48:51], v[120:123], v[144:147], v[48:51]
    v_mfma_f32_16x16x32_bf16 v[44:47], v[124:127], v[140:143], v[44:47]
    ds_read_b128 v[156:159], v164 offset:19712
    v_cvt_pk_bf16_f32 v36, v36, v37
    v_cvt_pk_bf16_f32 v37, v38, v39
    v_mfma_f32_16x16x32_bf16 v[48:51], v[128:131], v[140:143], v[48:51]
    ds_write_b64 v181, v[36:37] offset:0
    v_cvt_pk_bf16_f32 v40, v40, v41
    v_mfma_f32_16x16x32_bf16 v[52:55], v[108:111], v[144:147], v[52:55]
    v_cvt_pk_bf16_f32 v41, v42, v43
    ds_write_b64 v181, v[40:41] offset:32
    v_mfma_f32_16x16x32_bf16 v[56:59], v[112:115], v[144:147], v[56:59]
    ds_read_b128 v[188:191], v182 offset:0
    s_mov_b32 s57, 344064
    v_mfma_f32_16x16x32_bf16 v[52:55], v[116:119], v[140:143], v[52:55]
    s_waitcnt lgkmcnt(4)
    buffer_store_dwordx4 v[200:203], v183, s[20:23], s57 offen
    v_mfma_f32_16x16x32_bf16 v[56:59], v[120:123], v[140:143], v[56:59]
    v_mfma_f32_16x16x32_bf16 v[52:55], v[124:127], v[152:155], v[52:55]
    ds_read_b128 v[160:163], v164 offset:21120
    v_cvt_pk_bf16_f32 v44, v44, v45
    v_cvt_pk_bf16_f32 v45, v46, v47
    v_mfma_f32_16x16x32_bf16 v[56:59], v[128:131], v[152:155], v[56:59]
    ds_write_b64 v181, v[44:45] offset:1280
    v_cvt_pk_bf16_f32 v48, v48, v49
    v_mfma_f32_16x16x32_bf16 v[60:63], v[108:111], v[140:143], v[60:63]
    v_cvt_pk_bf16_f32 v49, v50, v51
    ds_write_b64 v181, v[48:49] offset:1312
    v_mfma_f32_16x16x32_bf16 v[64:67], v[112:115], v[140:143], v[64:67]
    ds_read_b128 v[192:195], v182 offset:1280
    s_mov_b32 s57, 430080
    v_mfma_f32_16x16x32_bf16 v[60:63], v[116:119], v[152:155], v[60:63]
    s_waitcnt lgkmcnt(4)
    buffer_store_dwordx4 v[188:191], v183, s[20:23], s57 offen
    v_mfma_f32_16x16x32_bf16 v[64:67], v[120:123], v[152:155], v[64:67]
    v_mfma_f32_16x16x32_bf16 v[60:63], v[124:127], v[156:159], v[60:63]
    v_cvt_pk_bf16_f32 v52, v52, v53
    v_cvt_pk_bf16_f32 v53, v54, v55
    v_mfma_f32_16x16x32_bf16 v[64:67], v[128:131], v[156:159], v[64:67]
    ds_write_b64 v181, v[52:53] offset:2560
    v_cvt_pk_bf16_f32 v56, v56, v57
    v_mfma_f32_16x16x32_bf16 v[68:71], v[108:111], v[152:155], v[68:71]
    v_cvt_pk_bf16_f32 v57, v58, v59
    ds_write_b64 v181, v[56:57] offset:2592
    v_mfma_f32_16x16x32_bf16 v[72:75], v[112:115], v[152:155], v[72:75]
    ds_read_b128 v[196:199], v182 offset:2560
    s_mov_b32 s57, 516096
    v_mfma_f32_16x16x32_bf16 v[68:71], v[116:119], v[156:159], v[68:71]
    s_waitcnt lgkmcnt(3)
    buffer_store_dwordx4 v[192:195], v183, s[20:23], s57 offen
    v_mfma_f32_16x16x32_bf16 v[72:75], v[120:123], v[156:159], v[72:75]
    v_mfma_f32_16x16x32_bf16 v[68:71], v[124:127], v[160:163], v[68:71]
    v_cvt_pk_bf16_f32 v60, v60, v61
    v_cvt_pk_bf16_f32 v61, v62, v63
    v_mfma_f32_16x16x32_bf16 v[72:75], v[128:131], v[160:163], v[72:75]
    ds_write_b64 v181, v[60:61] offset:3840
    v_cvt_pk_bf16_f32 v64, v64, v65
    v_cvt_pk_bf16_f32 v65, v66, v67
    ds_write_b64 v181, v[64:65] offset:3872
    ds_read_b128 v[200:203], v182 offset:3840
    s_mov_b32 s57, 602112
    s_waitcnt lgkmcnt(3)
    buffer_store_dwordx4 v[196:199], v183, s[20:23], s57 offen
    v_cvt_pk_bf16_f32 v68, v68, v69
    v_cvt_pk_bf16_f32 v69, v70, v71
    ds_write_b64 v181, v[68:69] offset:5120
    v_cvt_pk_bf16_f32 v72, v72, v73
    v_cvt_pk_bf16_f32 v73, v74, v75
    ds_write_b64 v181, v[72:73] offset:5152
    ds_read_b128 v[188:191], v182 offset:5120
    s_mov_b32 s57, 688128
    s_waitcnt lgkmcnt(3)
    buffer_store_dwordx4 v[200:203], v183, s[20:23], s57 offen
    s_mov_b32 s57, 774144
    s_waitcnt lgkmcnt(0)
    buffer_store_dwordx4 v[188:191], v183, s[20:23], s57 offen
    s_endpgm
.p2align 6
C_PC:
    s_barrier
    ds_read_b64_tr_b16 v[76:77], v165 offset:0
    ds_read_b64_tr_b16 v[78:79], v165 offset:1024
    ds_read_b128 v[132:135], v164 offset:0
    ds_read_b64_tr_b16 v[80:81], v166 offset:0
    ds_read_b64_tr_b16 v[82:83], v166 offset:1024
    ds_read_b128 v[136:139], v164 offset:1408
    ds_read_b64_tr_b16 v[84:85], v165 offset:2048
    ds_read_b64_tr_b16 v[86:87], v165 offset:3072
    ds_read_b64_tr_b16 v[88:89], v166 offset:2048
    ds_read_b64_tr_b16 v[90:91], v166 offset:3072
    s_waitcnt lgkmcnt(7)
    v_mfma_f32_16x16x32_bf16 v[0:3], v[76:79], v[132:135], 0
    s_waitcnt lgkmcnt(5)
    v_mfma_f32_16x16x32_bf16 v[4:7], v[80:83], v[132:135], 0
    s_barrier
    ds_read_b128 v[140:143], v164 offset:2816
    s_waitcnt lgkmcnt(5)
    v_mfma_f32_16x16x32_bf16 v[8:11], v[76:79], v[136:139], 0
    ds_read_b64_tr_b16 v[92:93], v165 offset:4096
    ds_read_b64_tr_b16 v[94:95], v165 offset:5120
    v_mfma_f32_16x16x32_bf16 v[12:15], v[80:83], v[136:139], 0
    ds_read_b64_tr_b16 v[96:97], v166 offset:4096
    ds_read_b64_tr_b16 v[98:99], v166 offset:5120
    s_waitcnt lgkmcnt(7)
    v_mfma_f32_16x16x32_bf16 v[0:3], v[84:87], v[136:139], v[0:3]
    ds_read_b128 v[144:147], v164 offset:4224
    ds_read_b64_tr_b16 v[100:101], v165 offset:6144
    s_waitcnt lgkmcnt(7)
    v_mfma_f32_16x16x32_bf16 v[4:7], v[88:91], v[136:139], v[4:7]
    ds_read_b64_tr_b16 v[102:103], v165 offset:7168
    ds_read_b64_tr_b16 v[104:105], v166 offset:6144
    s_waitcnt lgkmcnt(8)
    v_mfma_f32_16x16x32_bf16 v[16:19], v[76:79], v[140:143], 0
    ds_read_b64_tr_b16 v[106:107], v166 offset:7168
    v_mfma_f32_16x16x32_bf16 v[20:23], v[80:83], v[140:143], 0
    v_mfma_f32_16x16x32_bf16 v[8:11], v[84:87], v[140:143], v[8:11]
    v_mfma_f32_16x16x32_bf16 v[12:15], v[88:91], v[140:143], v[12:15]
    s_waitcnt lgkmcnt(7)
    v_mfma_f32_16x16x32_bf16 v[0:3], v[92:95], v[140:143], v[0:3]
    s_waitcnt lgkmcnt(5)
    v_mfma_f32_16x16x32_bf16 v[4:7], v[96:99], v[140:143], v[4:7]
    s_barrier
    s_waitcnt lgkmcnt(4)
    v_mfma_f32_16x16x32_bf16 v[24:27], v[76:79], v[144:147], 0
    ds_read_b128 v[148:151], v164 offset:5632
    ds_read_b64_tr_b16 v[108:109], v165 offset:8192
    v_mfma_f32_16x16x32_bf16 v[28:31], v[80:83], v[144:147], 0
    ds_read_b64_tr_b16 v[110:111], v165 offset:9216
    ds_read_b64_tr_b16 v[112:113], v166 offset:8192
    v_mfma_f32_16x16x32_bf16 v[16:19], v[84:87], v[144:147], v[16:19]
    ds_read_b64_tr_b16 v[114:115], v166 offset:9216
    ds_read_b128 v[132:135], v164 offset:7040
    v_mfma_f32_16x16x32_bf16 v[20:23], v[88:91], v[144:147], v[20:23]
    ds_read_b64_tr_b16 v[116:117], v165 offset:10240
    ds_read_b64_tr_b16 v[118:119], v165 offset:11264
    v_mfma_f32_16x16x32_bf16 v[8:11], v[92:95], v[144:147], v[8:11]
    ds_read_b64_tr_b16 v[120:121], v166 offset:10240
    ds_read_b64_tr_b16 v[122:123], v166 offset:11264
    v_mfma_f32_16x16x32_bf16 v[12:15], v[96:99], v[144:147], v[12:15]
    s_waitcnt lgkmcnt(10)
    v_mfma_f32_16x16x32_bf16 v[0:3], v[100:103], v[144:147], v[0:3]
    v_mfma_f32_16x16x32_bf16 v[4:7], v[104:107], v[144:147], v[4:7]
    s_waitcnt lgkmcnt(9)
    v_mfma_f32_16x16x32_bf16 v[32:35], v[76:79], v[148:151], 0
    v_mfma_f32_16x16x32_bf16 v[36:39], v[80:83], v[148:151], 0
    v_mfma_f32_16x16x32_bf16 v[24:27], v[84:87], v[148:151], v[24:27]
    v_mfma_f32_16x16x32_bf16 v[28:31], v[88:91], v[148:151], v[28:31]
    v_mfma_f32_16x16x32_bf16 v[16:19], v[92:95], v[148:151], v[16:19]
    v_mfma_f32_16x16x32_bf16 v[20:23], v[96:99], v[148:151], v[20:23]
    v_mfma_f32_16x16x32_bf16 v[8:11], v[100:103], v[148:151], v[8:11]
    v_mfma_f32_16x16x32_bf16 v[12:15], v[104:107], v[148:151], v[12:15]
    s_waitcnt lgkmcnt(0)
    v_mfma_f32_16x16x32_bf16 v[0:3], v[108:111], v[148:151], v[0:3]
    v_mfma_f32_16x16x32_bf16 v[4:7], v[112:115], v[148:151], v[4:7]
    v_mfma_f32_16x16x32_bf16 v[40:43], v[76:79], v[132:135], 0
    v_mfma_f32_16x16x32_bf16 v[44:47], v[80:83], v[132:135], 0
    s_barrier
    v_mfma_f32_16x16x32_bf16 v[32:35], v[84:87], v[132:135], v[32:35]
    ds_read_b128 v[136:139], v164 offset:8448
    ds_read_b64_tr_b16 v[124:125], v165 offset:12288
    v_mfma_f32_16x16x32_bf16 v[36:39], v[88:91], v[132:135], v[36:39]
    ds_read_b64_tr_b16 v[126:127], v165 offset:13312
    ds_read_b64_tr_b16 v[128:129], v166 offset:12288
    v_mfma_f32_16x16x32_bf16 v[24:27], v[92:95], v[132:135], v[24:27]
    ds_read_b64_tr_b16 v[130:131], v166 offset:13312
    ds_read_b128 v[140:143], v164 offset:9856
    v_mfma_f32_16x16x32_bf16 v[28:31], v[96:99], v[132:135], v[28:31]
    v_mfma_f32_16x16x32_bf16 v[16:19], v[100:103], v[132:135], v[16:19]
    v_mfma_f32_16x16x32_bf16 v[20:23], v[104:107], v[132:135], v[20:23]
    v_mfma_f32_16x16x32_bf16 v[8:11], v[108:111], v[132:135], v[8:11]
    v_mfma_f32_16x16x32_bf16 v[12:15], v[112:115], v[132:135], v[12:15]
    v_mfma_f32_16x16x32_bf16 v[0:3], v[116:119], v[132:135], v[0:3]
    v_mfma_f32_16x16x32_bf16 v[4:7], v[120:123], v[132:135], v[4:7]
    s_waitcnt lgkmcnt(2)
    v_mfma_f32_16x16x32_bf16 v[48:51], v[76:79], v[136:139], 0
    v_mfma_f32_16x16x32_bf16 v[52:55], v[80:83], v[136:139], 0
    v_mfma_f32_16x16x32_bf16 v[40:43], v[84:87], v[136:139], v[40:43]
    v_mfma_f32_16x16x32_bf16 v[44:47], v[88:91], v[136:139], v[44:47]
    v_mfma_f32_16x16x32_bf16 v[32:35], v[92:95], v[136:139], v[32:35]
    v_mfma_f32_16x16x32_bf16 v[36:39], v[96:99], v[136:139], v[36:39]
    v_mfma_f32_16x16x32_bf16 v[24:27], v[100:103], v[136:139], v[24:27]
    v_mfma_f32_16x16x32_bf16 v[28:31], v[104:107], v[136:139], v[28:31]
    v_mfma_f32_16x16x32_bf16 v[16:19], v[108:111], v[136:139], v[16:19]
    v_mfma_f32_16x16x32_bf16 v[20:23], v[112:115], v[136:139], v[20:23]
    v_mfma_f32_16x16x32_bf16 v[8:11], v[116:119], v[136:139], v[8:11]
    v_mfma_f32_16x16x32_bf16 v[12:15], v[120:123], v[136:139], v[12:15]
    v_mfma_f32_16x16x32_bf16 v[0:3], v[124:127], v[136:139], v[0:3]
    s_waitcnt lgkmcnt(0)
    v_mfma_f32_16x16x32_bf16 v[4:7], v[128:131], v[136:139], v[4:7]
    v_mfma_f32_16x16x32_bf16 v[56:59], v[76:79], v[140:143], 0
    v_mfma_f32_16x16x32_bf16 v[60:63], v[80:83], v[140:143], 0
    s_barrier
    v_mfma_f32_16x16x32_bf16 v[48:51], v[84:87], v[140:143], v[48:51]
    ds_read_b128 v[144:147], v164 offset:11264
    ds_read_b128 v[148:151], v164 offset:12672
    v_mfma_f32_16x16x32_bf16 v[52:55], v[88:91], v[140:143], v[52:55]
    ds_read_b128 v[132:135], v164 offset:14080
    v_mfma_f32_16x16x32_bf16 v[40:43], v[92:95], v[140:143], v[40:43]
    v_mfma_f32_16x16x32_bf16 v[44:47], v[96:99], v[140:143], v[44:47]
    v_mfma_f32_16x16x32_bf16 v[32:35], v[100:103], v[140:143], v[32:35]
    s_add_u32 s48, s48, 1
    v_mfma_f32_16x16x32_bf16 v[36:39], v[104:107], v[140:143], v[36:39]
    s_cmp_eq_u32 s48, 7
    v_mfma_f32_16x16x32_bf16 v[24:27], v[108:111], v[140:143], v[24:27]
    s_cselect_b32 s44, s51, 0
    v_mfma_f32_16x16x32_bf16 v[28:31], v[112:115], v[140:143], v[28:31]
    s_cselect_b32 s48, 0, s48
    v_mfma_f32_16x16x32_bf16 v[16:19], v[116:119], v[140:143], v[16:19]
    ds_read_b128 v[136:139], v164 offset:15488
    v_mfma_f32_16x16x32_bf16 v[20:23], v[120:123], v[140:143], v[20:23]
    s_xor_b32 s50, s50, s44
    v_mfma_f32_16x16x32_bf16 v[8:11], v[124:127], v[140:143], v[8:11]
    v_add_u32 v172, s48, v167
    v_mfma_f32_16x16x32_bf16 v[12:15], v[128:131], v[140:143], v[12:15]
    v_and_b32 v173, 4, v172
    s_waitcnt lgkmcnt(1)
    v_mfma_f32_16x16x32_bf16 v[64:67], v[76:79], v[144:147], 0
    v_lshlrev_b32 v173, 3, v173
    v_mfma_f32_16x16x32_bf16 v[68:71], v[80:83], v[144:147], 0
    v_xor_b32 v173, v173, v168
    v_mfma_f32_16x16x32_bf16 v[56:59], v[84:87], v[144:147], v[56:59]
    v_lshl_add_u32 v173, v172, 6, v173
    v_mfma_f32_16x16x32_bf16 v[60:63], v[88:91], v[144:147], v[60:63]
    v_add_u32 v170, s50, v173
    v_mfma_f32_16x16x32_bf16 v[48:51], v[92:95], v[144:147], v[48:51]
    ds_read_b128 v[140:143], v164 offset:16896
    v_mfma_f32_16x16x32_bf16 v[52:55], v[96:99], v[144:147], v[52:55]
    v_mfma_f32_16x16x32_bf16 v[40:43], v[100:103], v[144:147], v[40:43]
    v_mfma_f32_16x16x32_bf16 v[44:47], v[104:107], v[144:147], v[44:47]
    v_mfma_f32_16x16x32_bf16 v[32:35], v[108:111], v[144:147], v[32:35]
    v_mfma_f32_16x16x32_bf16 v[36:39], v[112:115], v[144:147], v[36:39]
    v_mfma_f32_16x16x32_bf16 v[24:27], v[116:119], v[144:147], v[24:27]
    v_mfma_f32_16x16x32_bf16 v[28:31], v[120:123], v[144:147], v[28:31]
    v_mfma_f32_16x16x32_bf16 v[16:19], v[124:127], v[144:147], v[16:19]
    v_mfma_f32_16x16x32_bf16 v[20:23], v[128:131], v[144:147], v[20:23]
    s_barrier
    v_mfma_f32_16x16x32_bf16 v[64:67], v[84:87], v[148:151], v[64:67]
    ds_read_b128 v[144:147], v164 offset:18304
    v_mfma_f32_16x16x32_bf16 v[68:71], v[88:91], v[148:151], v[68:71]
    s_xor_b32 s52, s52, s53
    v_mfma_f32_16x16x32_bf16 v[56:59], v[92:95], v[148:151], v[56:59]
    v_add_u32 v165, s52, v169
    v_mfma_f32_16x16x32_bf16 v[60:63], v[96:99], v[148:151], v[60:63]
    v_xor_b32 v166, 32, v165
    v_mfma_f32_16x16x32_bf16 v[48:51], v[100:103], v[148:151], v[48:51]
    v_mfma_f32_16x16x32_bf16 v[52:55], v[104:107], v[148:151], v[52:55]
    v_mfma_f32_16x16x32_bf16 v[40:43], v[108:111], v[148:151], v[40:43]
    v_mfma_f32_16x16x32_bf16 v[44:47], v[112:115], v[148:151], v[44:47]
    v_mfma_f32_16x16x32_bf16 v[32:35], v[116:119], v[148:151], v[32:35]
    v_mfma_f32_16x16x32_bf16 v[36:39], v[120:123], v[148:151], v[36:39]
    v_mfma_f32_16x16x32_bf16 v[24:27], v[124:127], v[148:151], v[24:27]
    v_mfma_f32_16x16x32_bf16 v[28:31], v[128:131], v[148:151], v[28:31]
    v_mfma_f32_16x16x32_bf16 v[64:67], v[92:95], v[132:135], v[64:67]
    ds_read_b128 v[148:151], v164 offset:19712
    v_mfma_f32_16x16x32_bf16 v[68:71], v[96:99], v[132:135], v[68:71]
    v_mfma_f32_16x16x32_bf16 v[56:59], v[100:103], v[132:135], v[56:59]
    v_mfma_f32_16x16x32_bf16 v[60:63], v[104:107], v[132:135], v[60:63]
    v_mfma_f32_16x16x32_bf16 v[48:51], v[108:111], v[132:135], v[48:51]
    v_mov_b32 v164, v170
    v_mfma_f32_16x16x32_bf16 v[52:55], v[112:115], v[132:135], v[52:55]
    v_mfma_f32_16x16x32_bf16 v[40:43], v[116:119], v[132:135], v[40:43]
    v_mfma_f32_16x16x32_bf16 v[44:47], v[120:123], v[132:135], v[44:47]
    v_mfma_f32_16x16x32_bf16 v[32:35], v[124:127], v[132:135], v[32:35]
    v_mfma_f32_16x16x32_bf16 v[36:39], v[128:131], v[132:135], v[36:39]
    s_barrier
    s_waitcnt lgkmcnt(0)
    v_mfma_f32_16x16x32_bf16 v[64:67], v[100:103], v[136:139], v[64:67]
    ds_read_b64_tr_b16 v[98:99], v166 offset:5120
    v_mfma_f32_16x16x32_bf16 v[68:71], v[104:107], v[136:139], v[68:71]
    ds_read_b64_tr_b16 v[90:91], v166 offset:3072
    v_mfma_f32_16x16x32_bf16 v[56:59], v[108:111], v[136:139], v[56:59]
    ds_read_b64_tr_b16 v[88:89], v166 offset:2048
    v_mfma_f32_16x16x32_bf16 v[60:63], v[112:115], v[136:139], v[60:63]
    ds_read_b64_tr_b16 v[86:87], v165 offset:3072
    v_mfma_f32_16x16x32_bf16 v[48:51], v[116:119], v[136:139], v[48:51]
    ds_read_b64_tr_b16 v[82:83], v166 offset:1024
    v_mfma_f32_16x16x32_bf16 v[52:55], v[120:123], v[136:139], v[52:55]
    ds_read_b64_tr_b16 v[80:81], v166 offset:0
    v_mfma_f32_16x16x32_bf16 v[40:43], v[124:127], v[136:139], v[40:43]
    ds_read_b128 v[132:135], v170 offset:0
    v_mfma_f32_16x16x32_bf16 v[44:47], v[128:131], v[136:139], v[44:47]
    ds_read_b64_tr_b16 v[78:79], v165 offset:1024
    v_mfma_f32_16x16x32_bf16 v[64:67], v[108:111], v[140:143], v[64:67]
    ds_read_b64_tr_b16 v[76:77], v165 offset:0
    v_mfma_f32_16x16x32_bf16 v[68:71], v[112:115], v[140:143], v[68:71]
    v_mfma_f32_16x16x32_bf16 v[56:59], v[116:119], v[140:143], v[56:59]
    ds_read_b128 v[136:139], v170 offset:1408
    v_mfma_f32_16x16x32_bf16 v[60:63], v[120:123], v[140:143], v[60:63]
    v_mfma_f32_16x16x32_bf16 v[48:51], v[124:127], v[140:143], v[48:51]
    ds_read_b64_tr_b16 v[84:85], v165 offset:2048
    v_mfma_f32_16x16x32_bf16 v[52:55], v[128:131], v[140:143], v[52:55]
    v_mfma_f32_16x16x32_bf16 v[64:67], v[116:119], v[144:147], v[64:67]
    ds_read_b128 v[140:143], v170 offset:2816
    v_mfma_f32_16x16x32_bf16 v[68:71], v[120:123], v[144:147], v[68:71]
    v_mfma_f32_16x16x32_bf16 v[56:59], v[124:127], v[144:147], v[56:59]
    ds_read_b64_tr_b16 v[96:97], v166 offset:4096
    v_mfma_f32_16x16x32_bf16 v[60:63], v[128:131], v[144:147], v[60:63]
    ds_read_b64_tr_b16 v[94:95], v165 offset:5120
    v_mfma_f32_16x16x32_bf16 v[64:67], v[124:127], v[148:151], v[64:67]
    ds_read_b64_tr_b16 v[92:93], v165 offset:4096
    v_mfma_f32_16x16x32_bf16 v[68:71], v[128:131], v[148:151], v[68:71]
    s_waitcnt lgkmcnt(5)
    s_barrier
C_PC_LOOP:
    v_mfma_f32_16x16x32_bf16 v[0:3], v[76:79], v[132:135], v[0:3]
    ds_read_b128 v[144:147], v164 offset:4224
    v_mfma_f32_16x16x32_bf16 v[4:7], v[80:83], v[132:135], v[4:7]
    v_mfma_f32_16x16x32_bf16 v[8:11], v[76:79], v[136:139], v[8:11]
    v_mfma_f32_16x16x32_bf16 v[12:15], v[80:83], v[136:139], v[12:15]
    ds_read_b64_tr_b16 v[106:107], v166 offset:7168
    s_waitcnt lgkmcnt(5)
    v_mfma_f32_16x16x32_bf16 v[0:3], v[84:87], v[136:139], v[0:3]
    ds_read_b64_tr_b16 v[104:105], v166 offset:6144
    v_mfma_f32_16x16x32_bf16 v[4:7], v[88:91], v[136:139], v[4:7]
    ds_read_b64_tr_b16 v[102:103], v165 offset:7168
    v_mfma_f32_16x16x32_bf16 v[16:19], v[76:79], v[140:143], v[16:19]
    ds_read_b64_tr_b16 v[100:101], v165 offset:6144
    v_mfma_f32_16x16x32_bf16 v[20:23], v[80:83], v[140:143], v[20:23]
    v_mfma_f32_16x16x32_bf16 v[8:11], v[84:87], v[140:143], v[8:11]
    ds_read_b128 v[148:151], v164 offset:5632
    v_mfma_f32_16x16x32_bf16 v[12:15], v[88:91], v[140:143], v[12:15]
    s_waitcnt lgkmcnt(5)
    v_mfma_f32_16x16x32_bf16 v[0:3], v[92:95], v[140:143], v[0:3]
    v_mfma_f32_16x16x32_bf16 v[4:7], v[96:99], v[140:143], v[4:7]
    v_mfma_f32_16x16x32_bf16 v[24:27], v[76:79], v[144:147], v[24:27]
    v_mfma_f32_16x16x32_bf16 v[28:31], v[80:83], v[144:147], v[28:31]
    ds_read_b64_tr_b16 v[114:115], v166 offset:9216
    v_mfma_f32_16x16x32_bf16 v[16:19], v[84:87], v[144:147], v[16:19]
    ds_read_b64_tr_b16 v[112:113], v166 offset:8192
    v_mfma_f32_16x16x32_bf16 v[20:23], v[88:91], v[144:147], v[20:23]
    ds_read_b64_tr_b16 v[110:111], v165 offset:9216
    v_mfma_f32_16x16x32_bf16 v[8:11], v[92:95], v[144:147], v[8:11]
    ds_read_b64_tr_b16 v[108:109], v165 offset:8192
    v_mfma_f32_16x16x32_bf16 v[12:15], v[96:99], v[144:147], v[12:15]
    s_waitcnt lgkmcnt(4)
    v_mfma_f32_16x16x32_bf16 v[0:3], v[100:103], v[144:147], v[0:3]
    ds_read_b128 v[132:135], v164 offset:7040
    v_mfma_f32_16x16x32_bf16 v[4:7], v[104:107], v[144:147], v[4:7]
    v_mfma_f32_16x16x32_bf16 v[32:35], v[76:79], v[148:151], v[32:35]
    v_mfma_f32_16x16x32_bf16 v[36:39], v[80:83], v[148:151], v[36:39]
    v_mfma_f32_16x16x32_bf16 v[24:27], v[84:87], v[148:151], v[24:27]
    v_mfma_f32_16x16x32_bf16 v[28:31], v[88:91], v[148:151], v[28:31]
    v_mfma_f32_16x16x32_bf16 v[16:19], v[92:95], v[148:151], v[16:19]
    v_mfma_f32_16x16x32_bf16 v[20:23], v[96:99], v[148:151], v[20:23]
    ds_read_b64_tr_b16 v[122:123], v166 offset:11264
    v_mfma_f32_16x16x32_bf16 v[8:11], v[100:103], v[148:151], v[8:11]
    ds_read_b64_tr_b16 v[120:121], v166 offset:10240
    v_mfma_f32_16x16x32_bf16 v[12:15], v[104:107], v[148:151], v[12:15]
    ds_read_b64_tr_b16 v[118:119], v165 offset:11264
    s_waitcnt lgkmcnt(3)
    v_mfma_f32_16x16x32_bf16 v[0:3], v[108:111], v[148:151], v[0:3]
    ds_read_b64_tr_b16 v[116:117], v165 offset:10240
    v_mfma_f32_16x16x32_bf16 v[4:7], v[112:115], v[148:151], v[4:7]
    v_mfma_f32_16x16x32_bf16 v[40:43], v[76:79], v[132:135], v[40:43]
    ds_read_b128 v[136:139], v164 offset:8448
    v_mfma_f32_16x16x32_bf16 v[44:47], v[80:83], v[132:135], v[44:47]
    v_mfma_f32_16x16x32_bf16 v[32:35], v[84:87], v[132:135], v[32:35]
    v_mfma_f32_16x16x32_bf16 v[36:39], v[88:91], v[132:135], v[36:39]
    v_mfma_f32_16x16x32_bf16 v[24:27], v[92:95], v[132:135], v[24:27]
    v_mfma_f32_16x16x32_bf16 v[28:31], v[96:99], v[132:135], v[28:31]
    v_mfma_f32_16x16x32_bf16 v[16:19], v[100:103], v[132:135], v[16:19]
    v_mfma_f32_16x16x32_bf16 v[20:23], v[104:107], v[132:135], v[20:23]
    v_mfma_f32_16x16x32_bf16 v[8:11], v[108:111], v[132:135], v[8:11]
    v_mfma_f32_16x16x32_bf16 v[12:15], v[112:115], v[132:135], v[12:15]
    ds_read_b64_tr_b16 v[130:131], v166 offset:13312
    s_waitcnt lgkmcnt(1)
    v_mfma_f32_16x16x32_bf16 v[0:3], v[116:119], v[132:135], v[0:3]
    ds_read_b64_tr_b16 v[128:129], v166 offset:12288
    v_mfma_f32_16x16x32_bf16 v[4:7], v[120:123], v[132:135], v[4:7]
    ds_read_b64_tr_b16 v[126:127], v165 offset:13312
    v_mfma_f32_16x16x32_bf16 v[48:51], v[76:79], v[136:139], v[48:51]
    ds_read_b64_tr_b16 v[124:125], v165 offset:12288
    v_mfma_f32_16x16x32_bf16 v[52:55], v[80:83], v[136:139], v[52:55]
    v_mfma_f32_16x16x32_bf16 v[40:43], v[84:87], v[136:139], v[40:43]
    ds_read_b128 v[140:143], v164 offset:9856
    v_mfma_f32_16x16x32_bf16 v[44:47], v[88:91], v[136:139], v[44:47]
    v_mfma_f32_16x16x32_bf16 v[32:35], v[92:95], v[136:139], v[32:35]
    v_mfma_f32_16x16x32_bf16 v[36:39], v[96:99], v[136:139], v[36:39]
    v_mfma_f32_16x16x32_bf16 v[24:27], v[100:103], v[136:139], v[24:27]
    v_mfma_f32_16x16x32_bf16 v[28:31], v[104:107], v[136:139], v[28:31]
    v_mfma_f32_16x16x32_bf16 v[16:19], v[108:111], v[136:139], v[16:19]
    v_mfma_f32_16x16x32_bf16 v[20:23], v[112:115], v[136:139], v[20:23]
    v_mfma_f32_16x16x32_bf16 v[8:11], v[116:119], v[136:139], v[8:11]
    v_mfma_f32_16x16x32_bf16 v[12:15], v[120:123], v[136:139], v[12:15]
    s_waitcnt lgkmcnt(0)
    v_mfma_f32_16x16x32_bf16 v[0:3], v[124:127], v[136:139], v[0:3]
    v_mfma_f32_16x16x32_bf16 v[4:7], v[128:131], v[136:139], v[4:7]
    v_mfma_f32_16x16x32_bf16 v[56:59], v[76:79], v[140:143], v[56:59]
    v_mfma_f32_16x16x32_bf16 v[60:63], v[80:83], v[140:143], v[60:63]
    v_mfma_f32_16x16x32_bf16 v[48:51], v[84:87], v[140:143], v[48:51]
    ds_read_b128 v[144:147], v164 offset:11264
    v_mfma_f32_16x16x32_bf16 v[52:55], v[88:91], v[140:143], v[52:55]
    s_barrier
    v_mfma_f32_16x16x32_bf16 v[40:43], v[92:95], v[140:143], v[40:43]
    s_xor_b32 s52, s52, s53
    v_mfma_f32_16x16x32_bf16 v[44:47], v[96:99], v[140:143], v[44:47]
    v_add_u32 v165, s52, v169
    v_mfma_f32_16x16x32_bf16 v[32:35], v[100:103], v[140:143], v[32:35]
    v_xor_b32 v166, 32, v165
    v_mfma_f32_16x16x32_bf16 v[36:39], v[104:107], v[140:143], v[36:39]
    v_mfma_f32_16x16x32_bf16 v[24:27], v[108:111], v[140:143], v[24:27]
    s_add_u32 s48, s48, 1
    v_mfma_f32_16x16x32_bf16 v[28:31], v[112:115], v[140:143], v[28:31]
    s_cmp_eq_u32 s48, 7
    v_mfma_f32_16x16x32_bf16 v[16:19], v[116:119], v[140:143], v[16:19]
    s_cselect_b32 s44, s51, 0
    v_mfma_f32_16x16x32_bf16 v[20:23], v[120:123], v[140:143], v[20:23]
    s_cselect_b32 s48, 0, s48
    v_mfma_f32_16x16x32_bf16 v[8:11], v[124:127], v[140:143], v[8:11]
    s_xor_b32 s50, s50, s44
    v_mfma_f32_16x16x32_bf16 v[12:15], v[128:131], v[140:143], v[12:15]
    v_add_u32 v172, s48, v167
    s_waitcnt lgkmcnt(0)
    v_mfma_f32_16x16x32_bf16 v[64:67], v[76:79], v[144:147], v[64:67]
    v_and_b32 v173, 4, v172
    v_mfma_f32_16x16x32_bf16 v[68:71], v[80:83], v[144:147], v[68:71]
    v_lshlrev_b32 v173, 3, v173
    v_mfma_f32_16x16x32_bf16 v[56:59], v[84:87], v[144:147], v[56:59]
    ds_read_b128 v[148:151], v164 offset:12672
    v_mfma_f32_16x16x32_bf16 v[60:63], v[88:91], v[144:147], v[60:63]
    v_xor_b32 v173, v173, v168
    v_mfma_f32_16x16x32_bf16 v[48:51], v[92:95], v[144:147], v[48:51]
    v_lshl_add_u32 v173, v172, 6, v173
    v_mfma_f32_16x16x32_bf16 v[52:55], v[96:99], v[144:147], v[52:55]
    v_add_u32 v170, s50, v173
    v_mfma_f32_16x16x32_bf16 v[40:43], v[100:103], v[144:147], v[40:43]
    v_mfma_f32_16x16x32_bf16 v[44:47], v[104:107], v[144:147], v[44:47]
    v_mfma_f32_16x16x32_bf16 v[32:35], v[108:111], v[144:147], v[32:35]
    v_mfma_f32_16x16x32_bf16 v[36:39], v[112:115], v[144:147], v[36:39]
    v_mfma_f32_16x16x32_bf16 v[24:27], v[116:119], v[144:147], v[24:27]
    v_mfma_f32_16x16x32_bf16 v[28:31], v[120:123], v[144:147], v[28:31]
    v_mfma_f32_16x16x32_bf16 v[16:19], v[124:127], v[144:147], v[16:19]
    v_mfma_f32_16x16x32_bf16 v[20:23], v[128:131], v[144:147], v[20:23]
    s_waitcnt lgkmcnt(0)
    v_mfma_f32_16x16x32_bf16 v[64:67], v[84:87], v[148:151], v[64:67]
    ds_read_b128 v[132:135], v164 offset:14080
    v_mfma_f32_16x16x32_bf16 v[68:71], v[88:91], v[148:151], v[68:71]
    v_mfma_f32_16x16x32_bf16 v[56:59], v[92:95], v[148:151], v[56:59]
    v_mfma_f32_16x16x32_bf16 v[60:63], v[96:99], v[148:151], v[60:63]
    v_mfma_f32_16x16x32_bf16 v[48:51], v[100:103], v[148:151], v[48:51]
    v_mfma_f32_16x16x32_bf16 v[52:55], v[104:107], v[148:151], v[52:55]
    v_mfma_f32_16x16x32_bf16 v[40:43], v[108:111], v[148:151], v[40:43]
    v_mfma_f32_16x16x32_bf16 v[44:47], v[112:115], v[148:151], v[44:47]
    v_mfma_f32_16x16x32_bf16 v[32:35], v[116:119], v[148:151], v[32:35]
    v_mfma_f32_16x16x32_bf16 v[36:39], v[120:123], v[148:151], v[36:39]
    v_mfma_f32_16x16x32_bf16 v[24:27], v[124:127], v[148:151], v[24:27]
    ds_read_b128 v[136:139], v164 offset:15488
    v_mfma_f32_16x16x32_bf16 v[28:31], v[128:131], v[148:151], v[28:31]
    s_waitcnt lgkmcnt(1)
    v_mfma_f32_16x16x32_bf16 v[64:67], v[92:95], v[132:135], v[64:67]
    v_mfma_f32_16x16x32_bf16 v[68:71], v[96:99], v[132:135], v[68:71]
    v_mfma_f32_16x16x32_bf16 v[56:59], v[100:103], v[132:135], v[56:59]
    v_mfma_f32_16x16x32_bf16 v[60:63], v[104:107], v[132:135], v[60:63]
    v_mfma_f32_16x16x32_bf16 v[48:51], v[108:111], v[132:135], v[48:51]
    v_mfma_f32_16x16x32_bf16 v[52:55], v[112:115], v[132:135], v[52:55]
    v_mfma_f32_16x16x32_bf16 v[40:43], v[116:119], v[132:135], v[40:43]
    ds_read_b128 v[140:143], v164 offset:16896
    v_mfma_f32_16x16x32_bf16 v[44:47], v[120:123], v[132:135], v[44:47]
    v_mfma_f32_16x16x32_bf16 v[32:35], v[124:127], v[132:135], v[32:35]
    ds_read_b128 v[148:151], v164 offset:19712
    v_mfma_f32_16x16x32_bf16 v[36:39], v[128:131], v[132:135], v[36:39]
    ds_read_b128 v[144:147], v164 offset:18304
    s_waitcnt lgkmcnt(3)
    v_mfma_f32_16x16x32_bf16 v[64:67], v[100:103], v[136:139], v[64:67]
    ds_read_b64_tr_b16 v[98:99], v166 offset:5120
    v_mfma_f32_16x16x32_bf16 v[68:71], v[104:107], v[136:139], v[68:71]
    ds_read_b64_tr_b16 v[90:91], v166 offset:3072
    v_mfma_f32_16x16x32_bf16 v[56:59], v[108:111], v[136:139], v[56:59]
    ds_read_b64_tr_b16 v[88:89], v166 offset:2048
    v_mfma_f32_16x16x32_bf16 v[60:63], v[112:115], v[136:139], v[60:63]
    ds_read_b64_tr_b16 v[86:87], v165 offset:3072
    v_mfma_f32_16x16x32_bf16 v[48:51], v[116:119], v[136:139], v[48:51]
    ds_read_b64_tr_b16 v[82:83], v166 offset:1024
    v_mfma_f32_16x16x32_bf16 v[52:55], v[120:123], v[136:139], v[52:55]
    ds_read_b64_tr_b16 v[80:81], v166 offset:0
    v_mfma_f32_16x16x32_bf16 v[40:43], v[124:127], v[136:139], v[40:43]
    ds_read_b128 v[132:135], v170 offset:0
    v_mfma_f32_16x16x32_bf16 v[44:47], v[128:131], v[136:139], v[44:47]
    ds_read_b64_tr_b16 v[78:79], v165 offset:1024
    s_waitcnt lgkmcnt(8)
    v_mfma_f32_16x16x32_bf16 v[64:67], v[108:111], v[140:143], v[64:67]
    ds_read_b64_tr_b16 v[76:77], v165 offset:0
    v_mfma_f32_16x16x32_bf16 v[68:71], v[112:115], v[140:143], v[68:71]
    v_mov_b32 v164, v170
    v_mfma_f32_16x16x32_bf16 v[56:59], v[116:119], v[140:143], v[56:59]
    ds_read_b128 v[136:139], v170 offset:1408
    v_mfma_f32_16x16x32_bf16 v[60:63], v[120:123], v[140:143], v[60:63]
    s_add_u32 s49, s49, 1
    v_mfma_f32_16x16x32_bf16 v[48:51], v[124:127], v[140:143], v[48:51]
    ds_read_b64_tr_b16 v[84:85], v165 offset:2048
    v_mfma_f32_16x16x32_bf16 v[52:55], v[128:131], v[140:143], v[52:55]
    s_cmp_lt_u32 s49, 20
    v_mfma_f32_16x16x32_bf16 v[64:67], v[116:119], v[144:147], v[64:67]
    ds_read_b128 v[140:143], v170 offset:2816
    v_mfma_f32_16x16x32_bf16 v[68:71], v[120:123], v[144:147], v[68:71]
    v_mfma_f32_16x16x32_bf16 v[56:59], v[124:127], v[144:147], v[56:59]
    ds_read_b64_tr_b16 v[96:97], v166 offset:4096
    v_mfma_f32_16x16x32_bf16 v[60:63], v[128:131], v[144:147], v[60:63]
    ds_read_b64_tr_b16 v[94:95], v165 offset:5120
    v_mfma_f32_16x16x32_bf16 v[64:67], v[124:127], v[148:151], v[64:67]
    ds_read_b64_tr_b16 v[92:93], v165 offset:4096
    s_waitcnt lgkmcnt(5)
    v_mfma_f32_16x16x32_bf16 v[68:71], v[128:131], v[148:151], v[68:71]
    s_cbranch_scc1 C_PC_LOOP
    v_mfma_f32_16x16x32_bf16 v[0:3], v[76:79], v[132:135], v[0:3]
    ds_read_b128 v[144:147], v164 offset:4224
    v_mfma_f32_16x16x32_bf16 v[4:7], v[80:83], v[132:135], v[4:7]
    v_mfma_f32_16x16x32_bf16 v[8:11], v[76:79], v[136:139], v[8:11]
    v_mfma_f32_16x16x32_bf16 v[12:15], v[80:83], v[136:139], v[12:15]
    s_waitcnt lgkmcnt(4)
    v_mfma_f32_16x16x32_bf16 v[0:3], v[84:87], v[136:139], v[0:3]
    ds_read_b64_tr_b16 v[106:107], v166 offset:7168
    v_mfma_f32_16x16x32_bf16 v[4:7], v[88:91], v[136:139], v[4:7]
    ds_read_b64_tr_b16 v[102:103], v165 offset:7168
    v_mfma_f32_16x16x32_bf16 v[16:19], v[76:79], v[140:143], v[16:19]
    ds_read_b64_tr_b16 v[100:101], v165 offset:6144
    v_mfma_f32_16x16x32_bf16 v[20:23], v[80:83], v[140:143], v[20:23]
    ds_read_b64_tr_b16 v[104:105], v166 offset:6144
    v_mfma_f32_16x16x32_bf16 v[8:11], v[84:87], v[140:143], v[8:11]
    ds_read_b128 v[148:151], v164 offset:5632
    v_mfma_f32_16x16x32_bf16 v[12:15], v[88:91], v[140:143], v[12:15]
    s_waitcnt lgkmcnt(5)
    v_mfma_f32_16x16x32_bf16 v[0:3], v[92:95], v[140:143], v[0:3]
    v_mfma_f32_16x16x32_bf16 v[4:7], v[96:99], v[140:143], v[4:7]
    v_mfma_f32_16x16x32_bf16 v[24:27], v[76:79], v[144:147], v[24:27]
    v_mfma_f32_16x16x32_bf16 v[28:31], v[80:83], v[144:147], v[28:31]
    v_mfma_f32_16x16x32_bf16 v[16:19], v[84:87], v[144:147], v[16:19]
    v_mfma_f32_16x16x32_bf16 v[20:23], v[88:91], v[144:147], v[20:23]
    v_mfma_f32_16x16x32_bf16 v[8:11], v[92:95], v[144:147], v[8:11]
    ds_read_b128 v[152:155], v164 offset:7040
    v_mfma_f32_16x16x32_bf16 v[12:15], v[96:99], v[144:147], v[12:15]
    s_waitcnt lgkmcnt(1)
    v_mfma_f32_16x16x32_bf16 v[0:3], v[100:103], v[144:147], v[0:3]
    v_mfma_f32_16x16x32_bf16 v[4:7], v[104:107], v[144:147], v[4:7]
    v_mfma_f32_16x16x32_bf16 v[32:35], v[76:79], v[148:151], v[32:35]
    v_mfma_f32_16x16x32_bf16 v[36:39], v[80:83], v[148:151], v[36:39]
    v_mfma_f32_16x16x32_bf16 v[24:27], v[84:87], v[148:151], v[24:27]
    v_mfma_f32_16x16x32_bf16 v[28:31], v[88:91], v[148:151], v[28:31]
    v_mfma_f32_16x16x32_bf16 v[16:19], v[92:95], v[148:151], v[16:19]
    ds_read_b128 v[156:159], v164 offset:8448
    v_mfma_f32_16x16x32_bf16 v[20:23], v[96:99], v[148:151], v[20:23]
    v_mfma_f32_16x16x32_bf16 v[8:11], v[100:103], v[148:151], v[8:11]
    v_mfma_f32_16x16x32_bf16 v[12:15], v[104:107], v[148:151], v[12:15]
    s_waitcnt lgkmcnt(1)
    v_mfma_f32_16x16x32_bf16 v[40:43], v[76:79], v[152:155], v[40:43]
    v_mfma_f32_16x16x32_bf16 v[44:47], v[80:83], v[152:155], v[44:47]
    v_mfma_f32_16x16x32_bf16 v[32:35], v[84:87], v[152:155], v[32:35]
    v_mfma_f32_16x16x32_bf16 v[36:39], v[88:91], v[152:155], v[36:39]
    ds_read_b64_tr_b16 v[130:131], v166 offset:13312
    v_mfma_f32_16x16x32_bf16 v[24:27], v[92:95], v[152:155], v[24:27]
    ds_read_b128 v[160:163], v164 offset:9856
    v_mfma_f32_16x16x32_bf16 v[28:31], v[96:99], v[152:155], v[28:31]
    ds_read_b64_tr_b16 v[128:129], v166 offset:12288
    v_mfma_f32_16x16x32_bf16 v[16:19], v[100:103], v[152:155], v[16:19]
    ds_read_b64_tr_b16 v[126:127], v165 offset:13312
    v_mfma_f32_16x16x32_bf16 v[20:23], v[104:107], v[152:155], v[20:23]
    ds_read_b64_tr_b16 v[124:125], v165 offset:12288
    s_waitcnt lgkmcnt(5)
    v_mfma_f32_16x16x32_bf16 v[48:51], v[76:79], v[156:159], v[48:51]
    ds_read_b64_tr_b16 v[122:123], v166 offset:11264
    v_mfma_f32_16x16x32_bf16 v[52:55], v[80:83], v[156:159], v[52:55]
    ds_read_b64_tr_b16 v[120:121], v166 offset:10240
    v_mfma_f32_16x16x32_bf16 v[40:43], v[84:87], v[156:159], v[40:43]
    ds_read_b64_tr_b16 v[118:119], v165 offset:11264
    v_mfma_f32_16x16x32_bf16 v[44:47], v[88:91], v[156:159], v[44:47]
    ds_read_b64_tr_b16 v[116:117], v165 offset:10240
    v_mfma_f32_16x16x32_bf16 v[32:35], v[92:95], v[156:159], v[32:35]
    ds_read_b128 v[132:135], v164 offset:11264
    v_mfma_f32_16x16x32_bf16 v[36:39], v[96:99], v[156:159], v[36:39]
    ds_read_b64_tr_b16 v[114:115], v166 offset:9216
    v_mfma_f32_16x16x32_bf16 v[24:27], v[100:103], v[156:159], v[24:27]
    ds_read_b64_tr_b16 v[112:113], v166 offset:8192
    v_mfma_f32_16x16x32_bf16 v[28:31], v[104:107], v[156:159], v[28:31]
    ds_read_b64_tr_b16 v[110:111], v165 offset:9216
    s_waitcnt lgkmcnt(8)
    v_mfma_f32_16x16x32_bf16 v[56:59], v[76:79], v[160:163], v[56:59]
    ds_read_b64_tr_b16 v[108:109], v165 offset:8192
    v_mfma_f32_16x16x32_bf16 v[60:63], v[80:83], v[160:163], v[60:63]
    v_mfma_f32_16x16x32_bf16 v[48:51], v[84:87], v[160:163], v[48:51]
    v_mfma_f32_16x16x32_bf16 v[52:55], v[88:91], v[160:163], v[52:55]
    v_mfma_f32_16x16x32_bf16 v[40:43], v[92:95], v[160:163], v[40:43]
    ds_read_b128 v[136:139], v164 offset:12672
    v_mfma_f32_16x16x32_bf16 v[44:47], v[96:99], v[160:163], v[44:47]
    v_mfma_f32_16x16x32_bf16 v[32:35], v[100:103], v[160:163], v[32:35]
    v_mfma_f32_16x16x32_bf16 v[36:39], v[104:107], v[160:163], v[36:39]
    s_waitcnt lgkmcnt(2)
    v_mfma_f32_16x16x32_bf16 v[64:67], v[76:79], v[132:135], v[64:67]
    v_mfma_f32_16x16x32_bf16 v[68:71], v[80:83], v[132:135], v[68:71]
    v_mfma_f32_16x16x32_bf16 v[56:59], v[84:87], v[132:135], v[56:59]
    ds_read_b128 v[140:143], v164 offset:14080
    v_mfma_f32_16x16x32_bf16 v[60:63], v[88:91], v[132:135], v[60:63]
    v_mfma_f32_16x16x32_bf16 v[48:51], v[92:95], v[132:135], v[48:51]
    v_mfma_f32_16x16x32_bf16 v[52:55], v[96:99], v[132:135], v[52:55]
    v_mfma_f32_16x16x32_bf16 v[40:43], v[100:103], v[132:135], v[40:43]
    ds_read_b128 v[144:147], v164 offset:15488
    v_mfma_f32_16x16x32_bf16 v[44:47], v[104:107], v[132:135], v[44:47]
    s_waitcnt lgkmcnt(3)
    s_barrier
    s_waitcnt lgkmcnt(2)
    v_mfma_f32_16x16x32_bf16 v[64:67], v[84:87], v[136:139], v[64:67]
    v_mfma_f32_16x16x32_bf16 v[68:71], v[88:91], v[136:139], v[68:71]
    v_mfma_f32_16x16x32_bf16 v[56:59], v[92:95], v[136:139], v[56:59]
    v_mfma_f32_16x16x32_bf16 v[60:63], v[96:99], v[136:139], v[60:63]
    v_mfma_f32_16x16x32_bf16 v[48:51], v[100:103], v[136:139], v[48:51]
    v_mfma_f32_16x16x32_bf16 v[52:55], v[104:107], v[136:139], v[52:55]
    s_waitcnt lgkmcnt(1)
    v_mfma_f32_16x16x32_bf16 v[64:67], v[92:95], v[140:143], v[64:67]
    v_mfma_f32_16x16x32_bf16 v[68:71], v[96:99], v[140:143], v[68:71]
    v_mfma_f32_16x16x32_bf16 v[56:59], v[100:103], v[140:143], v[56:59]
    v_mfma_f32_16x16x32_bf16 v[60:63], v[104:107], v[140:143], v[60:63]
    s_waitcnt lgkmcnt(0)
    v_mfma_f32_16x16x32_bf16 v[64:67], v[100:103], v[144:147], v[64:67]
    v_mfma_f32_16x16x32_bf16 v[68:71], v[104:107], v[144:147], v[68:71]
    v_mfma_f32_16x16x32_bf16 v[0:3], v[108:111], v[148:151], v[0:3]
    v_mfma_f32_16x16x32_bf16 v[4:7], v[112:115], v[148:151], v[4:7]
    v_mfma_f32_16x16x32_bf16 v[0:3], v[116:119], v[152:155], v[0:3]
    v_mfma_f32_16x16x32_bf16 v[4:7], v[120:123], v[152:155], v[4:7]
    v_mfma_f32_16x16x32_bf16 v[0:3], v[124:127], v[156:159], v[0:3]
    v_mfma_f32_16x16x32_bf16 v[4:7], v[128:131], v[156:159], v[4:7]
    v_mfma_f32_16x16x32_bf16 v[8:11], v[108:111], v[152:155], v[8:11]
    v_mfma_f32_16x16x32_bf16 v[12:15], v[112:115], v[152:155], v[12:15]
    v_mfma_f32_16x16x32_bf16 v[8:11], v[116:119], v[156:159], v[8:11]
    v_mfma_f32_16x16x32_bf16 v[12:15], v[120:123], v[156:159], v[12:15]
    v_mfma_f32_16x16x32_bf16 v[8:11], v[124:127], v[160:163], v[8:11]
    s_nop 1
    v_cvt_pk_bf16_f32 v0, v0, v1
    v_cvt_pk_bf16_f32 v1, v2, v3
    v_mfma_f32_16x16x32_bf16 v[12:15], v[128:131], v[160:163], v[12:15]
    ds_write_b64 v181, v[0:1] offset:0
    v_cvt_pk_bf16_f32 v4, v4, v5
    v_mfma_f32_16x16x32_bf16 v[16:19], v[108:111], v[156:159], v[16:19]
    v_cvt_pk_bf16_f32 v5, v6, v7
    ds_write_b64 v181, v[4:5] offset:32
    v_mfma_f32_16x16x32_bf16 v[20:23], v[112:115], v[156:159], v[20:23]
    ds_read_b128 v[188:191], v182 offset:0
    v_mfma_f32_16x16x32_bf16 v[16:19], v[116:119], v[160:163], v[16:19]
    v_mfma_f32_16x16x32_bf16 v[20:23], v[120:123], v[160:163], v[20:23]
    v_mfma_f32_16x16x32_bf16 v[16:19], v[124:127], v[132:135], v[16:19]
    v_cvt_pk_bf16_f32 v8, v8, v9
    v_cvt_pk_bf16_f32 v9, v10, v11
    v_mfma_f32_16x16x32_bf16 v[20:23], v[128:131], v[132:135], v[20:23]
    ds_write_b64 v181, v[8:9] offset:1280
    v_cvt_pk_bf16_f32 v12, v12, v13
    v_mfma_f32_16x16x32_bf16 v[24:27], v[108:111], v[160:163], v[24:27]
    v_cvt_pk_bf16_f32 v13, v14, v15
    ds_write_b64 v181, v[12:13] offset:1312
    v_mfma_f32_16x16x32_bf16 v[28:31], v[112:115], v[160:163], v[28:31]
    ds_read_b128 v[192:195], v182 offset:1280
    s_mov_b32 s57, 0
    v_mfma_f32_16x16x32_bf16 v[24:27], v[116:119], v[132:135], v[24:27]
    s_waitcnt lgkmcnt(3)
    buffer_store_dwordx4 v[188:191], v183, s[20:23], s57 offen
    v_mfma_f32_16x16x32_bf16 v[28:31], v[120:123], v[132:135], v[28:31]
    v_mfma_f32_16x16x32_bf16 v[24:27], v[124:127], v[136:139], v[24:27]
    v_cvt_pk_bf16_f32 v16, v16, v17
    v_cvt_pk_bf16_f32 v17, v18, v19
    v_mfma_f32_16x16x32_bf16 v[28:31], v[128:131], v[136:139], v[28:31]
    ds_write_b64 v181, v[16:17] offset:2560
    v_cvt_pk_bf16_f32 v20, v20, v21
    s_waitcnt lgkmcnt(0)
    s_barrier
    v_mfma_f32_16x16x32_bf16 v[32:35], v[108:111], v[132:135], v[32:35]
    v_cvt_pk_bf16_f32 v21, v22, v23
    ds_write_b64 v181, v[20:21] offset:2592
    v_mfma_f32_16x16x32_bf16 v[36:39], v[112:115], v[132:135], v[36:39]
    ds_read_b128 v[196:199], v182 offset:2560
    s_mov_b32 s57, 86016
    v_mfma_f32_16x16x32_bf16 v[32:35], v[116:119], v[136:139], v[32:35]
    buffer_store_dwordx4 v[192:195], v183, s[20:23], s57 offen
    v_mfma_f32_16x16x32_bf16 v[36:39], v[120:123], v[136:139], v[36:39]
    v_mfma_f32_16x16x32_bf16 v[32:35], v[124:127], v[140:143], v[32:35]
    ds_read_b128 v[148:151], v164 offset:16896
    v_cvt_pk_bf16_f32 v24, v24, v25
    v_cvt_pk_bf16_f32 v25, v26, v27
    v_mfma_f32_16x16x32_bf16 v[36:39], v[128:131], v[140:143], v[36:39]
    ds_write_b64 v181, v[24:25] offset:3840
    v_cvt_pk_bf16_f32 v28, v28, v29
    v_mfma_f32_16x16x32_bf16 v[40:43], v[108:111], v[136:139], v[40:43]
    v_cvt_pk_bf16_f32 v29, v30, v31
    ds_write_b64 v181, v[28:29] offset:3872
    v_mfma_f32_16x16x32_bf16 v[44:47], v[112:115], v[136:139], v[44:47]
    ds_read_b128 v[200:203], v182 offset:3840
    s_mov_b32 s57, 172032
    v_mfma_f32_16x16x32_bf16 v[40:43], v[116:119], v[140:143], v[40:43]
    s_waitcnt lgkmcnt(4)
    buffer_store_dwordx4 v[196:199], v183, s[20:23], s57 offen
    v_mfma_f32_16x16x32_bf16 v[44:47], v[120:123], v[140:143], v[44:47]
    v_mfma_f32_16x16x32_bf16 v[40:43], v[124:127], v[144:147], v[40:43]
    ds_read_b128 v[152:155], v164 offset:18304
    v_cvt_pk_bf16_f32 v32, v32, v33
    v_cvt_pk_bf16_f32 v33, v34, v35
    v_mfma_f32_16x16x32_bf16 v[44:47], v[128:131], v[144:147], v[44:47]
    ds_write_b64 v181, v[32:33] offset:5120
    v_cvt_pk_bf16_f32 v36, v36, v37
    v_mfma_f32_16x16x32_bf16 v[48:51], v[108:111], v[140:143], v[48:51]
    v_cvt_pk_bf16_f32 v37, v38, v39
    ds_write_b64 v181, v[36:37] offset:5152
    v_mfma_f32_16x16x32_bf16 v[52:55], v[112:115], v[140:143], v[52:55]
    ds_read_b128 v[188:191], v182 offset:5120
    s_mov_b32 s57, 258048
    v_mfma_f32_16x16x32_bf16 v[48:51], v[116:119], v[144:147], v[48:51]
    s_waitcnt lgkmcnt(4)
    buffer_store_dwordx4 v[200:203], v183, s[20:23], s57 offen
    v_mfma_f32_16x16x32_bf16 v[52:55], v[120:123], v[144:147], v[52:55]
    v_mfma_f32_16x16x32_bf16 v[48:51], v[124:127], v[148:151], v[48:51]
    ds_read_b128 v[156:159], v164 offset:19712
    v_cvt_pk_bf16_f32 v40, v40, v41
    v_cvt_pk_bf16_f32 v41, v42, v43
    v_mfma_f32_16x16x32_bf16 v[52:55], v[128:131], v[148:151], v[52:55]
    ds_write_b64 v181, v[40:41] offset:0
    v_cvt_pk_bf16_f32 v44, v44, v45
    v_mfma_f32_16x16x32_bf16 v[56:59], v[108:111], v[144:147], v[56:59]
    v_cvt_pk_bf16_f32 v45, v46, v47
    ds_write_b64 v181, v[44:45] offset:32
    v_mfma_f32_16x16x32_bf16 v[60:63], v[112:115], v[144:147], v[60:63]
    ds_read_b128 v[192:195], v182 offset:0
    s_mov_b32 s57, 344064
    v_mfma_f32_16x16x32_bf16 v[56:59], v[116:119], v[148:151], v[56:59]
    s_waitcnt lgkmcnt(4)
    buffer_store_dwordx4 v[188:191], v183, s[20:23], s57 offen
    v_mfma_f32_16x16x32_bf16 v[60:63], v[120:123], v[148:151], v[60:63]
    v_mfma_f32_16x16x32_bf16 v[56:59], v[124:127], v[152:155], v[56:59]
    v_cvt_pk_bf16_f32 v48, v48, v49
    v_cvt_pk_bf16_f32 v49, v50, v51
    v_mfma_f32_16x16x32_bf16 v[60:63], v[128:131], v[152:155], v[60:63]
    ds_write_b64 v181, v[48:49] offset:1280
    v_cvt_pk_bf16_f32 v52, v52, v53
    v_mfma_f32_16x16x32_bf16 v[64:67], v[108:111], v[148:151], v[64:67]
    v_cvt_pk_bf16_f32 v53, v54, v55
    ds_write_b64 v181, v[52:53] offset:1312
    v_mfma_f32_16x16x32_bf16 v[68:71], v[112:115], v[148:151], v[68:71]
    ds_read_b128 v[196:199], v182 offset:1280
    s_mov_b32 s57, 430080
    v_mfma_f32_16x16x32_bf16 v[64:67], v[116:119], v[152:155], v[64:67]
    s_waitcnt lgkmcnt(3)
    buffer_store_dwordx4 v[192:195], v183, s[20:23], s57 offen
    v_mfma_f32_16x16x32_bf16 v[68:71], v[120:123], v[152:155], v[68:71]
    v_mfma_f32_16x16x32_bf16 v[64:67], v[124:127], v[156:159], v[64:67]
    v_cvt_pk_bf16_f32 v56, v56, v57
    v_cvt_pk_bf16_f32 v57, v58, v59
    v_mfma_f32_16x16x32_bf16 v[68:71], v[128:131], v[156:159], v[68:71]
    ds_write_b64 v181, v[56:57] offset:2560
    v_cvt_pk_bf16_f32 v60, v60, v61
    v_cvt_pk_bf16_f32 v61, v62, v63
    ds_write_b64 v181, v[60:61] offset:2592
    ds_read_b128 v[200:203], v182 offset:2560
    s_mov_b32 s57, 516096
    s_waitcnt lgkmcnt(3)
    buffer_store_dwordx4 v[196:199], v183, s[20:23], s57 offen
    v_cvt_pk_bf16_f32 v64, v64, v65
    v_cvt_pk_bf16_f32 v65, v66, v67
    ds_write_b64 v181, v[64:65] offset:3840
    v_cvt_pk_bf16_f32 v68, v68, v69
    v_cvt_pk_bf16_f32 v69, v70, v71
    ds_write_b64 v181, v[68:69] offset:3872
    ds_read_b128 v[188:191], v182 offset:3840
    s_mov_b32 s57, 602112
    s_waitcnt lgkmcnt(3)
    buffer_store_dwordx4 v[200:203], v183, s[20:23], s57 offen
    s_mov_b32 s57, 688128
    s_waitcnt lgkmcnt(0)
    buffer_store_dwordx4 v[188:191], v183, s[20:23], s57 offen
    s_endpgm
.p2align 6
C_Q0:
    s_barrier
    ds_read_b64_tr_b16 v[76:77], v165 offset:0
    ds_read_b64_tr_b16 v[78:79], v165 offset:1024
    ds_read_b128 v[132:135], v164 offset:0
    ds_read_b64_tr_b16 v[80:81], v166 offset:0
    ds_read_b64_tr_b16 v[82:83], v166 offset:1024
    ds_read_b128 v[136:139], v164 offset:1408
    ds_read_b64_tr_b16 v[84:85], v165 offset:2048
    ds_read_b64_tr_b16 v[86:87], v165 offset:3072
    ds_read_b64_tr_b16 v[88:89], v166 offset:2048
    ds_read_b64_tr_b16 v[90:91], v166 offset:3072
    s_waitcnt lgkmcnt(7)
    v_mfma_f32_16x16x32_bf16 v[0:3], v[76:79], v[132:135], 0
    s_waitcnt lgkmcnt(5)
    v_mfma_f32_16x16x32_bf16 v[4:7], v[80:83], v[132:135], 0
    s_barrier
    ds_read_b128 v[140:143], v164 offset:2816
    s_waitcnt lgkmcnt(5)
    v_mfma_f32_16x16x32_bf16 v[8:11], v[76:79], v[136:139], 0
    ds_read_b64_tr_b16 v[92:93], v165 offset:4096
    ds_read_b64_tr_b16 v[94:95], v165 offset:5120
    v_mfma_f32_16x16x32_bf16 v[12:15], v[80:83], v[136:139], 0
    ds_read_b64_tr_b16 v[96:97], v166 offset:4096
    ds_read_b64_tr_b16 v[98:99], v166 offset:5120
    s_waitcnt lgkmcnt(7)
    v_mfma_f32_16x16x32_bf16 v[0:3], v[84:87], v[136:139], v[0:3]
    ds_read_b128 v[144:147], v164 offset:4224
    ds_read_b64_tr_b16 v[100:101], v165 offset:6144
    s_waitcnt lgkmcnt(7)
    v_mfma_f32_16x16x32_bf16 v[4:7], v[88:91], v[136:139], v[4:7]
    ds_read_b64_tr_b16 v[102:103], v165 offset:7168
    ds_read_b64_tr_b16 v[104:105], v166 offset:6144
    s_waitcnt lgkmcnt(8)
    v_mfma_f32_16x16x32_bf16 v[16:19], v[76:79], v[140:143], 0
    ds_read_b64_tr_b16 v[106:107], v166 offset:7168
    v_mfma_f32_16x16x32_bf16 v[20:23], v[80:83], v[140:143], 0
    v_mfma_f32_16x16x32_bf16 v[8:11], v[84:87], v[140:143], v[8:11]
    v_mfma_f32_16x16x32_bf16 v[12:15], v[88:91], v[140:143], v[12:15]
    s_waitcnt lgkmcnt(7)
    v_mfma_f32_16x16x32_bf16 v[0:3], v[92:95], v[140:143], v[0:3]
    s_waitcnt lgkmcnt(5)
    v_mfma_f32_16x16x32_bf16 v[4:7], v[96:99], v[140:143], v[4:7]
    s_barrier
    s_waitcnt lgkmcnt(4)
    v_mfma_f32_16x16x32_bf16 v[24:27], v[76:79], v[144:147], 0
    ds_read_b128 v[148:151], v164 offset:5632
    ds_read_b64_tr_b16 v[108:109], v165 offset:8192
    v_mfma_f32_16x16x32_bf16 v[28:31], v[80:83], v[144:147], 0
    ds_read_b64_tr_b16 v[110:111], v165 offset:9216
    ds_read_b64_tr_b16 v[112:113], v166 offset:8192
    v_mfma_f32_16x16x32_bf16 v[16:19], v[84:87], v[144:147], v[16:19]
    ds_read_b64_tr_b16 v[114:115], v166 offset:9216
    ds_read_b128 v[132:135], v164 offset:7040
    v_mfma_f32_16x16x32_bf16 v[20:23], v[88:91], v[144:147], v[20:23]
    ds_read_b64_tr_b16 v[116:117], v165 offset:10240
    ds_read_b64_tr_b16 v[118:119], v165 offset:11264
    v_mfma_f32_16x16x32_bf16 v[8:11], v[92:95], v[144:147], v[8:11]
    ds_read_b64_tr_b16 v[120:121], v166 offset:10240
    ds_read_b64_tr_b16 v[122:123], v166 offset:11264
    v_mfma_f32_16x16x32_bf16 v[12:15], v[96:99], v[144:147], v[12:15]
    s_waitcnt lgkmcnt(10)
    v_mfma_f32_16x16x32_bf16 v[0:3], v[100:103], v[144:147], v[0:3]
    v_mfma_f32_16x16x32_bf16 v[4:7], v[104:107], v[144:147], v[4:7]
    s_waitcnt lgkmcnt(9)
    v_mfma_f32_16x16x32_bf16 v[32:35], v[76:79], v[148:151], 0
    v_mfma_f32_16x16x32_bf16 v[36:39], v[80:83], v[148:151], 0
    v_mfma_f32_16x16x32_bf16 v[24:27], v[84:87], v[148:151], v[24:27]
    v_mfma_f32_16x16x32_bf16 v[28:31], v[88:91], v[148:151], v[28:31]
    v_mfma_f32_16x16x32_bf16 v[16:19], v[92:95], v[148:151], v[16:19]
    v_mfma_f32_16x16x32_bf16 v[20:23], v[96:99], v[148:151], v[20:23]
    v_mfma_f32_16x16x32_bf16 v[8:11], v[100:103], v[148:151], v[8:11]
    v_mfma_f32_16x16x32_bf16 v[12:15], v[104:107], v[148:151], v[12:15]
    s_waitcnt lgkmcnt(0)
    v_mfma_f32_16x16x32_bf16 v[0:3], v[108:111], v[148:151], v[0:3]
    v_mfma_f32_16x16x32_bf16 v[4:7], v[112:115], v[148:151], v[4:7]
    v_mfma_f32_16x16x32_bf16 v[40:43], v[76:79], v[132:135], 0
    v_mfma_f32_16x16x32_bf16 v[44:47], v[80:83], v[132:135], 0
    s_barrier
    v_mfma_f32_16x16x32_bf16 v[32:35], v[84:87], v[132:135], v[32:35]
    ds_read_b128 v[136:139], v164 offset:8448
    ds_read_b64_tr_b16 v[124:125], v165 offset:12288
    v_mfma_f32_16x16x32_bf16 v[36:39], v[88:91], v[132:135], v[36:39]
    ds_read_b64_tr_b16 v[126:127], v165 offset:13312
    ds_read_b64_tr_b16 v[128:129], v166 offset:12288
    v_mfma_f32_16x16x32_bf16 v[24:27], v[92:95], v[132:135], v[24:27]
    ds_read_b64_tr_b16 v[130:131], v166 offset:13312
    ds_read_b128 v[140:143], v164 offset:9856
    v_mfma_f32_16x16x32_bf16 v[28:31], v[96:99], v[132:135], v[28:31]
    v_mfma_f32_16x16x32_bf16 v[16:19], v[100:103], v[132:135], v[16:19]
    v_mfma_f32_16x16x32_bf16 v[20:23], v[104:107], v[132:135], v[20:23]
    v_mfma_f32_16x16x32_bf16 v[8:11], v[108:111], v[132:135], v[8:11]
    v_mfma_f32_16x16x32_bf16 v[12:15], v[112:115], v[132:135], v[12:15]
    v_mfma_f32_16x16x32_bf16 v[0:3], v[116:119], v[132:135], v[0:3]
    v_mfma_f32_16x16x32_bf16 v[4:7], v[120:123], v[132:135], v[4:7]
    s_waitcnt lgkmcnt(2)
    v_mfma_f32_16x16x32_bf16 v[48:51], v[76:79], v[136:139], 0
    v_mfma_f32_16x16x32_bf16 v[52:55], v[80:83], v[136:139], 0
    v_mfma_f32_16x16x32_bf16 v[40:43], v[84:87], v[136:139], v[40:43]
    ds_read_b128 v[148:151], v164 offset:12672
    v_mfma_f32_16x16x32_bf16 v[44:47], v[88:91], v[136:139], v[44:47]
    v_mfma_f32_16x16x32_bf16 v[32:35], v[92:95], v[136:139], v[32:35]
    v_mfma_f32_16x16x32_bf16 v[36:39], v[96:99], v[136:139], v[36:39]
    v_mfma_f32_16x16x32_bf16 v[24:27], v[100:103], v[136:139], v[24:27]
    v_mfma_f32_16x16x32_bf16 v[28:31], v[104:107], v[136:139], v[28:31]
    v_mfma_f32_16x16x32_bf16 v[16:19], v[108:111], v[136:139], v[16:19]
    v_mfma_f32_16x16x32_bf16 v[20:23], v[112:115], v[136:139], v[20:23]
    v_mfma_f32_16x16x32_bf16 v[8:11], v[116:119], v[136:139], v[8:11]
    v_mfma_f32_16x16x32_bf16 v[12:15], v[120:123], v[136:139], v[12:15]
    v_mfma_f32_16x16x32_bf16 v[0:3], v[124:127], v[136:139], v[0:3]
    s_waitcnt lgkmcnt(0)
    v_mfma_f32_16x16x32_bf16 v[4:7], v[128:131], v[136:139], v[4:7]
    v_mfma_f32_16x16x32_bf16 v[56:59], v[76:79], v[140:143], 0
    v_mfma_f32_16x16x32_bf16 v[60:63], v[80:83], v[140:143], 0
    ds_read_b128 v[132:135], v164 offset:14080
    s_barrier
    v_mfma_f32_16x16x32_bf16 v[48:51], v[84:87], v[140:143], v[48:51]
    ds_read_b128 v[144:147], v164 offset:11264
    v_mfma_f32_16x16x32_bf16 v[52:55], v[88:91], v[140:143], v[52:55]
    v_mfma_f32_16x16x32_bf16 v[40:43], v[92:95], v[140:143], v[40:43]
    v_mfma_f32_16x16x32_bf16 v[44:47], v[96:99], v[140:143], v[44:47]
    v_mfma_f32_16x16x32_bf16 v[32:35], v[100:103], v[140:143], v[32:35]
    s_add_u32 s48, s48, 1
    v_mfma_f32_16x16x32_bf16 v[36:39], v[104:107], v[140:143], v[36:39]
    s_cmp_eq_u32 s48, 7
    v_mfma_f32_16x16x32_bf16 v[24:27], v[108:111], v[140:143], v[24:27]
    s_cselect_b32 s44, s51, 0
    v_mfma_f32_16x16x32_bf16 v[28:31], v[112:115], v[140:143], v[28:31]
    s_cselect_b32 s48, 0, s48
    v_mfma_f32_16x16x32_bf16 v[16:19], v[116:119], v[140:143], v[16:19]
    s_xor_b32 s50, s50, s44
    v_mfma_f32_16x16x32_bf16 v[20:23], v[120:123], v[140:143], v[20:23]
    v_add_u32 v172, s48, v167
    v_mfma_f32_16x16x32_bf16 v[8:11], v[124:127], v[140:143], v[8:11]
    ds_read_b128 v[136:139], v164 offset:15488
    v_mfma_f32_16x16x32_bf16 v[12:15], v[128:131], v[140:143], v[12:15]
    v_and_b32 v173, 4, v172
    s_waitcnt lgkmcnt(1)
    v_mfma_f32_16x16x32_bf16 v[64:67], v[76:79], v[144:147], 0
    v_lshlrev_b32 v173, 3, v173
    v_mfma_f32_16x16x32_bf16 v[68:71], v[80:83], v[144:147], 0
    v_xor_b32 v173, v173, v168
    v_mfma_f32_16x16x32_bf16 v[56:59], v[84:87], v[144:147], v[56:59]
    v_lshl_add_u32 v173, v172, 6, v173
    v_mfma_f32_16x16x32_bf16 v[60:63], v[88:91], v[144:147], v[60:63]
    v_add_u32 v170, s50, v173
    v_mfma_f32_16x16x32_bf16 v[48:51], v[92:95], v[144:147], v[48:51]
    v_mfma_f32_16x16x32_bf16 v[52:55], v[96:99], v[144:147], v[52:55]
    v_mfma_f32_16x16x32_bf16 v[40:43], v[100:103], v[144:147], v[40:43]
    v_mfma_f32_16x16x32_bf16 v[44:47], v[104:107], v[144:147], v[44:47]
    ds_read_b128 v[140:143], v164 offset:16896
    v_mfma_f32_16x16x32_bf16 v[32:35], v[108:111], v[144:147], v[32:35]
    v_mfma_f32_16x16x32_bf16 v[36:39], v[112:115], v[144:147], v[36:39]
    v_mfma_f32_16x16x32_bf16 v[24:27], v[116:119], v[144:147], v[24:27]
    v_mfma_f32_16x16x32_bf16 v[28:31], v[120:123], v[144:147], v[28:31]
    v_mfma_f32_16x16x32_bf16 v[16:19], v[124:127], v[144:147], v[16:19]
    v_mfma_f32_16x16x32_bf16 v[20:23], v[128:131], v[144:147], v[20:23]
    s_barrier
    v_mfma_f32_16x16x32_bf16 v[72:75], v[76:79], v[148:151], 0
    ds_read_b128 v[144:147], v164 offset:18304
    v_mfma_f32_16x16x32_bf16 v[64:67], v[84:87], v[148:151], v[64:67]
    s_xor_b32 s52, s52, s53
    v_mfma_f32_16x16x32_bf16 v[68:71], v[88:91], v[148:151], v[68:71]
    v_add_u32 v165, s52, v169
    v_mfma_f32_16x16x32_bf16 v[56:59], v[92:95], v[148:151], v[56:59]
    v_xor_b32 v166, 32, v165
    v_mfma_f32_16x16x32_bf16 v[60:63], v[96:99], v[148:151], v[60:63]
    v_mfma_f32_16x16x32_bf16 v[48:51], v[100:103], v[148:151], v[48:51]
    v_mfma_f32_16x16x32_bf16 v[52:55], v[104:107], v[148:151], v[52:55]
    v_mfma_f32_16x16x32_bf16 v[40:43], v[108:111], v[148:151], v[40:43]
    v_mfma_f32_16x16x32_bf16 v[44:47], v[112:115], v[148:151], v[44:47]
    v_mfma_f32_16x16x32_bf16 v[32:35], v[116:119], v[148:151], v[32:35]
    v_mfma_f32_16x16x32_bf16 v[36:39], v[120:123], v[148:151], v[36:39]
    v_mfma_f32_16x16x32_bf16 v[24:27], v[124:127], v[148:151], v[24:27]
    v_mfma_f32_16x16x32_bf16 v[28:31], v[128:131], v[148:151], v[28:31]
    v_mfma_f32_16x16x32_bf16 v[72:75], v[84:87], v[132:135], v[72:75]
    ds_read_b128 v[148:151], v164 offset:19712
    v_mfma_f32_16x16x32_bf16 v[64:67], v[92:95], v[132:135], v[64:67]
    v_mfma_f32_16x16x32_bf16 v[68:71], v[96:99], v[132:135], v[68:71]
    v_mfma_f32_16x16x32_bf16 v[56:59], v[100:103], v[132:135], v[56:59]
    v_mov_b32 v164, v170
    v_mfma_f32_16x16x32_bf16 v[60:63], v[104:107], v[132:135], v[60:63]
    v_mfma_f32_16x16x32_bf16 v[48:51], v[108:111], v[132:135], v[48:51]
    v_mfma_f32_16x16x32_bf16 v[52:55], v[112:115], v[132:135], v[52:55]
    v_mfma_f32_16x16x32_bf16 v[40:43], v[116:119], v[132:135], v[40:43]
    v_mfma_f32_16x16x32_bf16 v[44:47], v[120:123], v[132:135], v[44:47]
    s_barrier
    v_mfma_f32_16x16x32_bf16 v[32:35], v[124:127], v[132:135], v[32:35]
    v_mfma_f32_16x16x32_bf16 v[36:39], v[128:131], v[132:135], v[36:39]
    s_waitcnt lgkmcnt(0)
    v_mfma_f32_16x16x32_bf16 v[72:75], v[92:95], v[136:139], v[72:75]
    v_mfma_f32_16x16x32_bf16 v[64:67], v[100:103], v[136:139], v[64:67]
    v_mfma_f32_16x16x32_bf16 v[68:71], v[104:107], v[136:139], v[68:71]
    ds_read_b64_tr_b16 v[98:99], v166 offset:5120
    v_mfma_f32_16x16x32_bf16 v[56:59], v[108:111], v[136:139], v[56:59]
    ds_read_b64_tr_b16 v[90:91], v166 offset:3072
    v_mfma_f32_16x16x32_bf16 v[60:63], v[112:115], v[136:139], v[60:63]
    ds_read_b64_tr_b16 v[88:89], v166 offset:2048
    v_mfma_f32_16x16x32_bf16 v[48:51], v[116:119], v[136:139], v[48:51]
    ds_read_b64_tr_b16 v[86:87], v165 offset:3072
    v_mfma_f32_16x16x32_bf16 v[52:55], v[120:123], v[136:139], v[52:55]
    ds_read_b64_tr_b16 v[82:83], v166 offset:1024
    v_mfma_f32_16x16x32_bf16 v[40:43], v[124:127], v[136:139], v[40:43]
    ds_read_b64_tr_b16 v[80:81], v166 offset:0
    v_mfma_f32_16x16x32_bf16 v[44:47], v[128:131], v[136:139], v[44:47]
    ds_read_b128 v[132:135], v170 offset:0
    v_mfma_f32_16x16x32_bf16 v[72:75], v[100:103], v[140:143], v[72:75]
    ds_read_b64_tr_b16 v[78:79], v165 offset:1024
    v_mfma_f32_16x16x32_bf16 v[64:67], v[108:111], v[140:143], v[64:67]
    ds_read_b64_tr_b16 v[76:77], v165 offset:0
    v_mfma_f32_16x16x32_bf16 v[68:71], v[112:115], v[140:143], v[68:71]
    v_mfma_f32_16x16x32_bf16 v[56:59], v[116:119], v[140:143], v[56:59]
    ds_read_b128 v[136:139], v170 offset:1408
    v_mfma_f32_16x16x32_bf16 v[60:63], v[120:123], v[140:143], v[60:63]
    v_mfma_f32_16x16x32_bf16 v[48:51], v[124:127], v[140:143], v[48:51]
    ds_read_b64_tr_b16 v[84:85], v165 offset:2048
    v_mfma_f32_16x16x32_bf16 v[52:55], v[128:131], v[140:143], v[52:55]
    v_mfma_f32_16x16x32_bf16 v[64:67], v[116:119], v[144:147], v[64:67]
    ds_read_b128 v[140:143], v170 offset:2816
    v_mfma_f32_16x16x32_bf16 v[68:71], v[120:123], v[144:147], v[68:71]
    v_mfma_f32_16x16x32_bf16 v[56:59], v[124:127], v[144:147], v[56:59]
    ds_read_b64_tr_b16 v[96:97], v166 offset:4096
    v_mfma_f32_16x16x32_bf16 v[60:63], v[128:131], v[144:147], v[60:63]
    ds_read_b64_tr_b16 v[94:95], v165 offset:5120
    v_mfma_f32_16x16x32_bf16 v[64:67], v[124:127], v[148:151], v[64:67]
    ds_read_b64_tr_b16 v[92:93], v165 offset:4096
    v_mfma_f32_16x16x32_bf16 v[68:71], v[128:131], v[148:151], v[68:71]
    s_waitcnt lgkmcnt(5)
    s_barrier
C_Q0_LOOP:
    v_mfma_f32_16x16x32_bf16 v[0:3], v[76:79], v[132:135], v[0:3]
    ds_read_b128 v[144:147], v164 offset:4224
    v_mfma_f32_16x16x32_bf16 v[4:7], v[80:83], v[132:135], v[4:7]
    v_mfma_f32_16x16x32_bf16 v[8:11], v[76:79], v[136:139], v[8:11]
    v_mfma_f32_16x16x32_bf16 v[12:15], v[80:83], v[136:139], v[12:15]
    ds_read_b64_tr_b16 v[106:107], v166 offset:7168
    s_waitcnt lgkmcnt(5)
    v_mfma_f32_16x16x32_bf16 v[0:3], v[84:87], v[136:139], v[0:3]
    ds_read_b64_tr_b16 v[104:105], v166 offset:6144
    v_mfma_f32_16x16x32_bf16 v[4:7], v[88:91], v[136:139], v[4:7]
    ds_read_b64_tr_b16 v[102:103], v165 offset:7168
    v_mfma_f32_16x16x32_bf16 v[16:19], v[76:79], v[140:143], v[16:19]
    ds_read_b64_tr_b16 v[100:101], v165 offset:6144
    v_mfma_f32_16x16x32_bf16 v[20:23], v[80:83], v[140:143], v[20:23]
    v_mfma_f32_16x16x32_bf16 v[8:11], v[84:87], v[140:143], v[8:11]
    ds_read_b128 v[148:151], v164 offset:5632
    v_mfma_f32_16x16x32_bf16 v[12:15], v[88:91], v[140:143], v[12:15]
    s_waitcnt lgkmcnt(5)
    v_mfma_f32_16x16x32_bf16 v[0:3], v[92:95], v[140:143], v[0:3]
    v_mfma_f32_16x16x32_bf16 v[4:7], v[96:99], v[140:143], v[4:7]
    v_mfma_f32_16x16x32_bf16 v[24:27], v[76:79], v[144:147], v[24:27]
    v_mfma_f32_16x16x32_bf16 v[28:31], v[80:83], v[144:147], v[28:31]
    ds_read_b64_tr_b16 v[114:115], v166 offset:9216
    v_mfma_f32_16x16x32_bf16 v[16:19], v[84:87], v[144:147], v[16:19]
    ds_read_b64_tr_b16 v[112:113], v166 offset:8192
    v_mfma_f32_16x16x32_bf16 v[20:23], v[88:91], v[144:147], v[20:23]
    ds_read_b64_tr_b16 v[110:111], v165 offset:9216
    v_mfma_f32_16x16x32_bf16 v[8:11], v[92:95], v[144:147], v[8:11]
    ds_read_b64_tr_b16 v[108:109], v165 offset:8192
    v_mfma_f32_16x16x32_bf16 v[12:15], v[96:99], v[144:147], v[12:15]
    s_waitcnt lgkmcnt(4)
    v_mfma_f32_16x16x32_bf16 v[0:3], v[100:103], v[144:147], v[0:3]
    ds_read_b128 v[132:135], v164 offset:7040
    v_mfma_f32_16x16x32_bf16 v[4:7], v[104:107], v[144:147], v[4:7]
    v_mfma_f32_16x16x32_bf16 v[32:35], v[76:79], v[148:151], v[32:35]
    v_mfma_f32_16x16x32_bf16 v[36:39], v[80:83], v[148:151], v[36:39]
    v_mfma_f32_16x16x32_bf16 v[24:27], v[84:87], v[148:151], v[24:27]
    v_mfma_f32_16x16x32_bf16 v[28:31], v[88:91], v[148:151], v[28:31]
    v_mfma_f32_16x16x32_bf16 v[16:19], v[92:95], v[148:151], v[16:19]
    v_mfma_f32_16x16x32_bf16 v[20:23], v[96:99], v[148:151], v[20:23]
    ds_read_b64_tr_b16 v[122:123], v166 offset:11264
    v_mfma_f32_16x16x32_bf16 v[8:11], v[100:103], v[148:151], v[8:11]
    ds_read_b64_tr_b16 v[120:121], v166 offset:10240
    v_mfma_f32_16x16x32_bf16 v[12:15], v[104:107], v[148:151], v[12:15]
    ds_read_b64_tr_b16 v[118:119], v165 offset:11264
    s_waitcnt lgkmcnt(3)
    v_mfma_f32_16x16x32_bf16 v[0:3], v[108:111], v[148:151], v[0:3]
    ds_read_b64_tr_b16 v[116:117], v165 offset:10240
    v_mfma_f32_16x16x32_bf16 v[4:7], v[112:115], v[148:151], v[4:7]
    v_mfma_f32_16x16x32_bf16 v[40:43], v[76:79], v[132:135], v[40:43]
    ds_read_b128 v[136:139], v164 offset:8448
    v_mfma_f32_16x16x32_bf16 v[44:47], v[80:83], v[132:135], v[44:47]
    v_mfma_f32_16x16x32_bf16 v[32:35], v[84:87], v[132:135], v[32:35]
    v_mfma_f32_16x16x32_bf16 v[36:39], v[88:91], v[132:135], v[36:39]
    v_mfma_f32_16x16x32_bf16 v[24:27], v[92:95], v[132:135], v[24:27]
    v_mfma_f32_16x16x32_bf16 v[28:31], v[96:99], v[132:135], v[28:31]
    v_mfma_f32_16x16x32_bf16 v[16:19], v[100:103], v[132:135], v[16:19]
    v_mfma_f32_16x16x32_bf16 v[20:23], v[104:107], v[132:135], v[20:23]
    v_mfma_f32_16x16x32_bf16 v[8:11], v[108:111], v[132:135], v[8:11]
    v_mfma_f32_16x16x32_bf16 v[12:15], v[112:115], v[132:135], v[12:15]
    ds_read_b64_tr_b16 v[130:131], v166 offset:13312
    s_waitcnt lgkmcnt(1)
    v_mfma_f32_16x16x32_bf16 v[0:3], v[116:119], v[132:135], v[0:3]
    ds_read_b64_tr_b16 v[128:129], v166 offset:12288
    v_mfma_f32_16x16x32_bf16 v[4:7], v[120:123], v[132:135], v[4:7]
    ds_read_b64_tr_b16 v[126:127], v165 offset:13312
    v_mfma_f32_16x16x32_bf16 v[48:51], v[76:79], v[136:139], v[48:51]
    ds_read_b64_tr_b16 v[124:125], v165 offset:12288
    v_mfma_f32_16x16x32_bf16 v[52:55], v[80:83], v[136:139], v[52:55]
    v_mfma_f32_16x16x32_bf16 v[40:43], v[84:87], v[136:139], v[40:43]
    ds_read_b128 v[140:143], v164 offset:9856
    v_mfma_f32_16x16x32_bf16 v[44:47], v[88:91], v[136:139], v[44:47]
    v_mfma_f32_16x16x32_bf16 v[32:35], v[92:95], v[136:139], v[32:35]
    v_mfma_f32_16x16x32_bf16 v[36:39], v[96:99], v[136:139], v[36:39]
    v_mfma_f32_16x16x32_bf16 v[24:27], v[100:103], v[136:139], v[24:27]
    v_mfma_f32_16x16x32_bf16 v[28:31], v[104:107], v[136:139], v[28:31]
    v_mfma_f32_16x16x32_bf16 v[16:19], v[108:111], v[136:139], v[16:19]
    v_mfma_f32_16x16x32_bf16 v[20:23], v[112:115], v[136:139], v[20:23]
    v_mfma_f32_16x16x32_bf16 v[8:11], v[116:119], v[136:139], v[8:11]
    v_mfma_f32_16x16x32_bf16 v[12:15], v[120:123], v[136:139], v[12:15]
    s_waitcnt lgkmcnt(0)
    v_mfma_f32_16x16x32_bf16 v[0:3], v[124:127], v[136:139], v[0:3]
    v_mfma_f32_16x16x32_bf16 v[4:7], v[128:131], v[136:139], v[4:7]
    v_mfma_f32_16x16x32_bf16 v[56:59], v[76:79], v[140:143], v[56:59]
    v_mfma_f32_16x16x32_bf16 v[60:63], v[80:83], v[140:143], v[60:63]
    v_mfma_f32_16x16x32_bf16 v[48:51], v[84:87], v[140:143], v[48:51]
    ds_read_b128 v[144:147], v164 offset:11264
    v_mfma_f32_16x16x32_bf16 v[52:55], v[88:91], v[140:143], v[52:55]
    s_barrier
    v_mfma_f32_16x16x32_bf16 v[40:43], v[92:95], v[140:143], v[40:43]
    s_xor_b32 s52, s52, s53
    v_mfma_f32_16x16x32_bf16 v[44:47], v[96:99], v[140:143], v[44:47]
    v_add_u32 v165, s52, v169
    v_mfma_f32_16x16x32_bf16 v[32:35], v[100:103], v[140:143], v[32:35]
    v_xor_b32 v166, 32, v165
    v_mfma_f32_16x16x32_bf16 v[36:39], v[104:107], v[140:143], v[36:39]
    v_mfma_f32_16x16x32_bf16 v[24:27], v[108:111], v[140:143], v[24:27]
    s_add_u32 s48, s48, 1
    v_mfma_f32_16x16x32_bf16 v[28:31], v[112:115], v[140:143], v[28:31]
    s_cmp_eq_u32 s48, 7
    v_mfma_f32_16x16x32_bf16 v[16:19], v[116:119], v[140:143], v[16:19]
    s_cselect_b32 s44, s51, 0
    v_mfma_f32_16x16x32_bf16 v[20:23], v[120:123], v[140:143], v[20:23]
    s_cselect_b32 s48, 0, s48
    v_mfma_f32_16x16x32_bf16 v[8:11], v[124:127], v[140:143], v[8:11]
    s_xor_b32 s50, s50, s44
    v_mfma_f32_16x16x32_bf16 v[12:15], v[128:131], v[140:143], v[12:15]
    v_add_u32 v172, s48, v167
    s_waitcnt lgkmcnt(0)
    v_mfma_f32_16x16x32_bf16 v[64:67], v[76:79], v[144:147], v[64:67]
    v_and_b32 v173, 4, v172
    v_mfma_f32_16x16x32_bf16 v[68:71], v[80:83], v[144:147], v[68:71]
    v_lshlrev_b32 v173, 3, v173
    v_mfma_f32_16x16x32_bf16 v[56:59], v[84:87], v[144:147], v[56:59]
    ds_read_b128 v[148:151], v164 offset:12672
    v_mfma_f32_16x16x32_bf16 v[60:63], v[88:91], v[144:147], v[60:63]
    v_xor_b32 v173, v173, v168
    v_mfma_f32_16x16x32_bf16 v[48:51], v[92:95], v[144:147], v[48:51]
    v_lshl_add_u32 v173, v172, 6, v173
    v_mfma_f32_16x16x32_bf16 v[52:55], v[96:99], v[144:147], v[52:55]
    v_add_u32 v170, s50, v173
    v_mfma_f32_16x16x32_bf16 v[40:43], v[100:103], v[144:147], v[40:43]
    v_mfma_f32_16x16x32_bf16 v[44:47], v[104:107], v[144:147], v[44:47]
    v_mfma_f32_16x16x32_bf16 v[32:35], v[108:111], v[144:147], v[32:35]
    v_mfma_f32_16x16x32_bf16 v[36:39], v[112:115], v[144:147], v[36:39]
    v_mfma_f32_16x16x32_bf16 v[24:27], v[116:119], v[144:147], v[24:27]
    v_mfma_f32_16x16x32_bf16 v[28:31], v[120:123], v[144:147], v[28:31]
    v_mfma_f32_16x16x32_bf16 v[16:19], v[124:127], v[144:147], v[16:19]
    v_mfma_f32_16x16x32_bf16 v[20:23], v[128:131], v[144:147], v[20:23]
    s_waitcnt lgkmcnt(0)
    v_mfma_f32_16x16x32_bf16 v[72:75], v[76:79], v[148:151], v[72:75]
    v_mfma_f32_16x16x32_bf16 v[64:67], v[84:87], v[148:151], v[64:67]
    ds_read_b128 v[132:135], v164 offset:14080
    v_mfma_f32_16x16x32_bf16 v[68:71], v[88:91], v[148:151], v[68:71]
    v_mfma_f32_16x16x32_bf16 v[56:59], v[92:95], v[148:151], v[56:59]
    v_mfma_f32_16x16x32_bf16 v[60:63], v[96:99], v[148:151], v[60:63]
    v_mfma_f32_16x16x32_bf16 v[48:51], v[100:103], v[148:151], v[48:51]
    v_mfma_f32_16x16x32_bf16 v[52:55], v[104:107], v[148:151], v[52:55]
    v_mfma_f32_16x16x32_bf16 v[40:43], v[108:111], v[148:151], v[40:43]
    v_mfma_f32_16x16x32_bf16 v[44:47], v[112:115], v[148:151], v[44:47]
    v_mfma_f32_16x16x32_bf16 v[32:35], v[116:119], v[148:151], v[32:35]
    v_mfma_f32_16x16x32_bf16 v[36:39], v[120:123], v[148:151], v[36:39]
    v_mfma_f32_16x16x32_bf16 v[24:27], v[124:127], v[148:151], v[24:27]
    v_mfma_f32_16x16x32_bf16 v[28:31], v[128:131], v[148:151], v[28:31]
    ds_read_b128 v[136:139], v164 offset:15488
    s_waitcnt lgkmcnt(1)
    v_mfma_f32_16x16x32_bf16 v[72:75], v[84:87], v[132:135], v[72:75]
    v_mfma_f32_16x16x32_bf16 v[64:67], v[92:95], v[132:135], v[64:67]
    v_mfma_f32_16x16x32_bf16 v[68:71], v[96:99], v[132:135], v[68:71]
    v_mfma_f32_16x16x32_bf16 v[56:59], v[100:103], v[132:135], v[56:59]
    v_mfma_f32_16x16x32_bf16 v[60:63], v[104:107], v[132:135], v[60:63]
    v_mfma_f32_16x16x32_bf16 v[48:51], v[108:111], v[132:135], v[48:51]
    v_mfma_f32_16x16x32_bf16 v[52:55], v[112:115], v[132:135], v[52:55]
    v_mfma_f32_16x16x32_bf16 v[40:43], v[116:119], v[132:135], v[40:43]
    v_mfma_f32_16x16x32_bf16 v[44:47], v[120:123], v[132:135], v[44:47]
    ds_read_b128 v[140:143], v164 offset:16896
    v_mfma_f32_16x16x32_bf16 v[32:35], v[124:127], v[132:135], v[32:35]
    v_mfma_f32_16x16x32_bf16 v[36:39], v[128:131], v[132:135], v[36:39]
    s_waitcnt lgkmcnt(1)
    v_mfma_f32_16x16x32_bf16 v[72:75], v[92:95], v[136:139], v[72:75]
    ds_read_b128 v[148:151], v164 offset:19712
    v_mfma_f32_16x16x32_bf16 v[64:67], v[100:103], v[136:139], v[64:67]
    ds_read_b128 v[144:147], v164 offset:18304
    v_mfma_f32_16x16x32_bf16 v[68:71], v[104:107], v[136:139], v[68:71]
    ds_read_b64_tr_b16 v[98:99], v166 offset:5120
    v_mfma_f32_16x16x32_bf16 v[56:59], v[108:111], v[136:139], v[56:59]
    ds_read_b64_tr_b16 v[90:91], v166 offset:3072
    v_mfma_f32_16x16x32_bf16 v[60:63], v[112:115], v[136:139], v[60:63]
    ds_read_b64_tr_b16 v[88:89], v166 offset:2048
    v_mfma_f32_16x16x32_bf16 v[48:51], v[116:119], v[136:139], v[48:51]
    ds_read_b64_tr_b16 v[86:87], v165 offset:3072
    v_mfma_f32_16x16x32_bf16 v[52:55], v[120:123], v[136:139], v[52:55]
    ds_read_b64_tr_b16 v[82:83], v166 offset:1024
    v_mfma_f32_16x16x32_bf16 v[40:43], v[124:127], v[136:139], v[40:43]
    ds_read_b64_tr_b16 v[80:81], v166 offset:0
    v_mfma_f32_16x16x32_bf16 v[44:47], v[128:131], v[136:139], v[44:47]
    ds_read_b128 v[132:135], v170 offset:0
    s_waitcnt lgkmcnt(8)
    v_mfma_f32_16x16x32_bf16 v[72:75], v[100:103], v[140:143], v[72:75]
    ds_read_b64_tr_b16 v[78:79], v165 offset:1024
    v_mfma_f32_16x16x32_bf16 v[64:67], v[108:111], v[140:143], v[64:67]
    ds_read_b64_tr_b16 v[76:77], v165 offset:0
    v_mfma_f32_16x16x32_bf16 v[68:71], v[112:115], v[140:143], v[68:71]
    v_mov_b32 v164, v170
    v_mfma_f32_16x16x32_bf16 v[56:59], v[116:119], v[140:143], v[56:59]
    ds_read_b128 v[136:139], v170 offset:1408
    v_mfma_f32_16x16x32_bf16 v[60:63], v[120:123], v[140:143], v[60:63]
    s_add_u32 s49, s49, 1
    v_mfma_f32_16x16x32_bf16 v[48:51], v[124:127], v[140:143], v[48:51]
    ds_read_b64_tr_b16 v[84:85], v165 offset:2048
    v_mfma_f32_16x16x32_bf16 v[52:55], v[128:131], v[140:143], v[52:55]
    s_cmp_lt_u32 s49, 20
    s_waitcnt lgkmcnt(5)
    v_mfma_f32_16x16x32_bf16 v[64:67], v[116:119], v[144:147], v[64:67]
    ds_read_b128 v[140:143], v170 offset:2816
    v_mfma_f32_16x16x32_bf16 v[68:71], v[120:123], v[144:147], v[68:71]
    v_mfma_f32_16x16x32_bf16 v[56:59], v[124:127], v[144:147], v[56:59]
    ds_read_b64_tr_b16 v[96:97], v166 offset:4096
    v_mfma_f32_16x16x32_bf16 v[60:63], v[128:131], v[144:147], v[60:63]
    ds_read_b64_tr_b16 v[94:95], v165 offset:5120
    v_mfma_f32_16x16x32_bf16 v[64:67], v[124:127], v[148:151], v[64:67]
    ds_read_b64_tr_b16 v[92:93], v165 offset:4096
    s_waitcnt lgkmcnt(5)
    v_mfma_f32_16x16x32_bf16 v[68:71], v[128:131], v[148:151], v[68:71]
    s_cbranch_scc1 C_Q0_LOOP
    v_mfma_f32_16x16x32_bf16 v[0:3], v[76:79], v[132:135], v[0:3]
    ds_read_b128 v[144:147], v164 offset:4224
    v_mfma_f32_16x16x32_bf16 v[4:7], v[80:83], v[132:135], v[4:7]
    v_mfma_f32_16x16x32_bf16 v[8:11], v[76:79], v[136:139], v[8:11]
    v_mfma_f32_16x16x32_bf16 v[12:15], v[80:83], v[136:139], v[12:15]
    s_waitcnt lgkmcnt(4)
    v_mfma_f32_16x16x32_bf16 v[0:3], v[84:87], v[136:139], v[0:3]
    ds_read_b64_tr_b16 v[106:107], v166 offset:7168
    v_mfma_f32_16x16x32_bf16 v[4:7], v[88:91], v[136:139], v[4:7]
    ds_read_b64_tr_b16 v[102:103], v165 offset:7168
    v_mfma_f32_16x16x32_bf16 v[16:19], v[76:79], v[140:143], v[16:19]
    ds_read_b64_tr_b16 v[100:101], v165 offset:6144
    v_mfma_f32_16x16x32_bf16 v[20:23], v[80:83], v[140:143], v[20:23]
    ds_read_b64_tr_b16 v[104:105], v166 offset:6144
    v_mfma_f32_16x16x32_bf16 v[8:11], v[84:87], v[140:143], v[8:11]
    ds_read_b128 v[148:151], v164 offset:5632
    v_mfma_f32_16x16x32_bf16 v[12:15], v[88:91], v[140:143], v[12:15]
    s_waitcnt lgkmcnt(5)
    v_mfma_f32_16x16x32_bf16 v[0:3], v[92:95], v[140:143], v[0:3]
    v_mfma_f32_16x16x32_bf16 v[4:7], v[96:99], v[140:143], v[4:7]
    v_mfma_f32_16x16x32_bf16 v[24:27], v[76:79], v[144:147], v[24:27]
    v_mfma_f32_16x16x32_bf16 v[28:31], v[80:83], v[144:147], v[28:31]
    v_mfma_f32_16x16x32_bf16 v[16:19], v[84:87], v[144:147], v[16:19]
    v_mfma_f32_16x16x32_bf16 v[20:23], v[88:91], v[144:147], v[20:23]
    v_mfma_f32_16x16x32_bf16 v[8:11], v[92:95], v[144:147], v[8:11]
    ds_read_b128 v[152:155], v164 offset:7040
    v_mfma_f32_16x16x32_bf16 v[12:15], v[96:99], v[144:147], v[12:15]
    s_waitcnt lgkmcnt(1)
    v_mfma_f32_16x16x32_bf16 v[0:3], v[100:103], v[144:147], v[0:3]
    v_mfma_f32_16x16x32_bf16 v[4:7], v[104:107], v[144:147], v[4:7]
    v_mfma_f32_16x16x32_bf16 v[32:35], v[76:79], v[148:151], v[32:35]
    v_mfma_f32_16x16x32_bf16 v[36:39], v[80:83], v[148:151], v[36:39]
    v_mfma_f32_16x16x32_bf16 v[24:27], v[84:87], v[148:151], v[24:27]
    v_mfma_f32_16x16x32_bf16 v[28:31], v[88:91], v[148:151], v[28:31]
    v_mfma_f32_16x16x32_bf16 v[16:19], v[92:95], v[148:151], v[16:19]
    ds_read_b128 v[156:159], v164 offset:8448
    v_mfma_f32_16x16x32_bf16 v[20:23], v[96:99], v[148:151], v[20:23]
    v_mfma_f32_16x16x32_bf16 v[8:11], v[100:103], v[148:151], v[8:11]
    v_mfma_f32_16x16x32_bf16 v[12:15], v[104:107], v[148:151], v[12:15]
    s_waitcnt lgkmcnt(1)
    v_mfma_f32_16x16x32_bf16 v[40:43], v[76:79], v[152:155], v[40:43]
    v_mfma_f32_16x16x32_bf16 v[44:47], v[80:83], v[152:155], v[44:47]
    v_mfma_f32_16x16x32_bf16 v[32:35], v[84:87], v[152:155], v[32:35]
    v_mfma_f32_16x16x32_bf16 v[36:39], v[88:91], v[152:155], v[36:39]
    ds_read_b64_tr_b16 v[130:131], v166 offset:13312
    v_mfma_f32_16x16x32_bf16 v[24:27], v[92:95], v[152:155], v[24:27]
    ds_read_b128 v[160:163], v164 offset:9856
    v_mfma_f32_16x16x32_bf16 v[28:31], v[96:99], v[152:155], v[28:31]
    ds_read_b64_tr_b16 v[128:129], v166 offset:12288
    v_mfma_f32_16x16x32_bf16 v[16:19], v[100:103], v[152:155], v[16:19]
    ds_read_b64_tr_b16 v[126:127], v165 offset:13312
    v_mfma_f32_16x16x32_bf16 v[20:23], v[104:107], v[152:155], v[20:23]
    ds_read_b64_tr_b16 v[124:125], v165 offset:12288
    s_waitcnt lgkmcnt(5)
    v_mfma_f32_16x16x32_bf16 v[48:51], v[76:79], v[156:159], v[48:51]
    ds_read_b64_tr_b16 v[122:123], v166 offset:11264
    v_mfma_f32_16x16x32_bf16 v[52:55], v[80:83], v[156:159], v[52:55]
    ds_read_b64_tr_b16 v[120:121], v166 offset:10240
    v_mfma_f32_16x16x32_bf16 v[40:43], v[84:87], v[156:159], v[40:43]
    ds_read_b64_tr_b16 v[118:119], v165 offset:11264
    v_mfma_f32_16x16x32_bf16 v[44:47], v[88:91], v[156:159], v[44:47]
    ds_read_b64_tr_b16 v[116:117], v165 offset:10240
    v_mfma_f32_16x16x32_bf16 v[32:35], v[92:95], v[156:159], v[32:35]
    ds_read_b128 v[132:135], v164 offset:11264
    v_mfma_f32_16x16x32_bf16 v[36:39], v[96:99], v[156:159], v[36:39]
    ds_read_b64_tr_b16 v[114:115], v166 offset:9216
    v_mfma_f32_16x16x32_bf16 v[24:27], v[100:103], v[156:159], v[24:27]
    ds_read_b64_tr_b16 v[112:113], v166 offset:8192
    v_mfma_f32_16x16x32_bf16 v[28:31], v[104:107], v[156:159], v[28:31]
    ds_read_b64_tr_b16 v[110:111], v165 offset:9216
    s_waitcnt lgkmcnt(8)
    v_mfma_f32_16x16x32_bf16 v[56:59], v[76:79], v[160:163], v[56:59]
    ds_read_b64_tr_b16 v[108:109], v165 offset:8192
    v_mfma_f32_16x16x32_bf16 v[60:63], v[80:83], v[160:163], v[60:63]
    v_mfma_f32_16x16x32_bf16 v[48:51], v[84:87], v[160:163], v[48:51]
    v_mfma_f32_16x16x32_bf16 v[52:55], v[88:91], v[160:163], v[52:55]
    v_mfma_f32_16x16x32_bf16 v[40:43], v[92:95], v[160:163], v[40:43]
    ds_read_b128 v[136:139], v164 offset:12672
    v_mfma_f32_16x16x32_bf16 v[44:47], v[96:99], v[160:163], v[44:47]
    v_mfma_f32_16x16x32_bf16 v[32:35], v[100:103], v[160:163], v[32:35]
    v_mfma_f32_16x16x32_bf16 v[36:39], v[104:107], v[160:163], v[36:39]
    s_waitcnt lgkmcnt(2)
    v_mfma_f32_16x16x32_bf16 v[64:67], v[76:79], v[132:135], v[64:67]
    v_mfma_f32_16x16x32_bf16 v[68:71], v[80:83], v[132:135], v[68:71]
    v_mfma_f32_16x16x32_bf16 v[56:59], v[84:87], v[132:135], v[56:59]
    v_mfma_f32_16x16x32_bf16 v[60:63], v[88:91], v[132:135], v[60:63]
    ds_read_b128 v[140:143], v164 offset:14080
    v_mfma_f32_16x16x32_bf16 v[48:51], v[92:95], v[132:135], v[48:51]
    v_mfma_f32_16x16x32_bf16 v[52:55], v[96:99], v[132:135], v[52:55]
    v_mfma_f32_16x16x32_bf16 v[40:43], v[100:103], v[132:135], v[40:43]
    v_mfma_f32_16x16x32_bf16 v[44:47], v[104:107], v[132:135], v[44:47]
    s_waitcnt lgkmcnt(2)
    s_barrier
    s_waitcnt lgkmcnt(1)
    v_mfma_f32_16x16x32_bf16 v[72:75], v[76:79], v[136:139], v[72:75]
    ds_read_b128 v[144:147], v164 offset:15488
    v_mfma_f32_16x16x32_bf16 v[64:67], v[84:87], v[136:139], v[64:67]
    v_mfma_f32_16x16x32_bf16 v[68:71], v[88:91], v[136:139], v[68:71]
    v_mfma_f32_16x16x32_bf16 v[56:59], v[92:95], v[136:139], v[56:59]
    v_mfma_f32_16x16x32_bf16 v[60:63], v[96:99], v[136:139], v[60:63]
    v_mfma_f32_16x16x32_bf16 v[48:51], v[100:103], v[136:139], v[48:51]
    v_mfma_f32_16x16x32_bf16 v[52:55], v[104:107], v[136:139], v[52:55]
    s_waitcnt lgkmcnt(1)
    v_mfma_f32_16x16x32_bf16 v[72:75], v[84:87], v[140:143], v[72:75]
    v_mfma_f32_16x16x32_bf16 v[64:67], v[92:95], v[140:143], v[64:67]
    v_mfma_f32_16x16x32_bf16 v[68:71], v[96:99], v[140:143], v[68:71]
    v_mfma_f32_16x16x32_bf16 v[56:59], v[100:103], v[140:143], v[56:59]
    v_mfma_f32_16x16x32_bf16 v[60:63], v[104:107], v[140:143], v[60:63]
    s_waitcnt lgkmcnt(0)
    v_mfma_f32_16x16x32_bf16 v[72:75], v[92:95], v[144:147], v[72:75]
    ds_read_b128 v[140:143], v164 offset:16896
    v_mfma_f32_16x16x32_bf16 v[64:67], v[100:103], v[144:147], v[64:67]
    v_mfma_f32_16x16x32_bf16 v[68:71], v[104:107], v[144:147], v[68:71]
    s_waitcnt lgkmcnt(0)
    v_mfma_f32_16x16x32_bf16 v[72:75], v[100:103], v[140:143], v[72:75]
    v_mfma_f32_16x16x32_bf16 v[0:3], v[108:111], v[148:151], v[0:3]
    v_mfma_f32_16x16x32_bf16 v[4:7], v[112:115], v[148:151], v[4:7]
    v_mfma_f32_16x16x32_bf16 v[0:3], v[116:119], v[152:155], v[0:3]
    v_mfma_f32_16x16x32_bf16 v[4:7], v[120:123], v[152:155], v[4:7]
    v_mfma_f32_16x16x32_bf16 v[0:3], v[124:127], v[156:159], v[0:3]
    v_mfma_f32_16x16x32_bf16 v[4:7], v[128:131], v[156:159], v[4:7]
    v_mfma_f32_16x16x32_bf16 v[8:11], v[108:111], v[152:155], v[8:11]
    v_mfma_f32_16x16x32_bf16 v[12:15], v[112:115], v[152:155], v[12:15]
    v_mfma_f32_16x16x32_bf16 v[8:11], v[116:119], v[156:159], v[8:11]
    v_mfma_f32_16x16x32_bf16 v[12:15], v[120:123], v[156:159], v[12:15]
    v_mfma_f32_16x16x32_bf16 v[8:11], v[124:127], v[160:163], v[8:11]
    s_nop 1
    v_cvt_pk_bf16_f32 v0, v0, v1
    v_cvt_pk_bf16_f32 v1, v2, v3
    v_mfma_f32_16x16x32_bf16 v[12:15], v[128:131], v[160:163], v[12:15]
    ds_write_b64 v181, v[0:1] offset:0
    v_cvt_pk_bf16_f32 v4, v4, v5
    v_mfma_f32_16x16x32_bf16 v[16:19], v[108:111], v[156:159], v[16:19]
    v_cvt_pk_bf16_f32 v5, v6, v7
    ds_write_b64 v181, v[4:5] offset:32
    v_mfma_f32_16x16x32_bf16 v[20:23], v[112:115], v[156:159], v[20:23]
    ds_read_b128 v[188:191], v182 offset:0
    v_mfma_f32_16x16x32_bf16 v[16:19], v[116:119], v[160:163], v[16:19]
    v_mfma_f32_16x16x32_bf16 v[20:23], v[120:123], v[160:163], v[20:23]
    v_mfma_f32_16x16x32_bf16 v[16:19], v[124:127], v[132:135], v[16:19]
    ds_read_b128 v[148:151], v164 offset:14080
    v_cvt_pk_bf16_f32 v8, v8, v9
    v_cvt_pk_bf16_f32 v9, v10, v11
    v_mfma_f32_16x16x32_bf16 v[20:23], v[128:131], v[132:135], v[20:23]
    ds_write_b64 v181, v[8:9] offset:1280
    v_cvt_pk_bf16_f32 v12, v12, v13
    v_mfma_f32_16x16x32_bf16 v[24:27], v[108:111], v[160:163], v[24:27]
    v_cvt_pk_bf16_f32 v13, v14, v15
    ds_write_b64 v181, v[12:13] offset:1312
    v_mfma_f32_16x16x32_bf16 v[28:31], v[112:115], v[160:163], v[28:31]
    ds_read_b128 v[192:195], v182 offset:1280
    s_waitcnt lgkmcnt(1)
    s_barrier
    v_mfma_f32_16x16x32_bf16 v[24:27], v[116:119], v[132:135], v[24:27]
    v_mfma_f32_16x16x32_bf16 v[28:31], v[120:123], v[132:135], v[28:31]
    ds_read_b128 v[204:207], v184 offset:0
    s_mov_b32 s57, 0
    v_mfma_f32_16x16x32_bf16 v[24:27], v[124:127], v[136:139], v[24:27]
    buffer_store_dwordx4 v[188:191], v183, s[20:23], s57 offen
    v_cvt_pk_bf16_f32 v16, v16, v17
    v_mfma_f32_16x16x32_bf16 v[28:31], v[128:131], v[136:139], v[28:31]
    v_cvt_pk_bf16_f32 v17, v18, v19
    ds_write_b64 v181, v[16:17] offset:2560
    v_mfma_f32_16x16x32_bf16 v[32:35], v[108:111], v[132:135], v[32:35]
    v_cvt_pk_bf16_f32 v20, v20, v21
    v_cvt_pk_bf16_f32 v21, v22, v23
    v_mfma_f32_16x16x32_bf16 v[36:39], v[112:115], v[132:135], v[36:39]
    ds_write_b64 v181, v[20:21] offset:2592
    ds_read_b128 v[196:199], v182 offset:2560
    v_mfma_f32_16x16x32_bf16 v[32:35], v[116:119], v[136:139], v[32:35]
    s_mov_b32 s57, 86016
    s_waitcnt lgkmcnt(4)
    buffer_store_dwordx4 v[192:195], v183, s[20:23], s57 offen
    v_mfma_f32_16x16x32_bf16 v[36:39], v[120:123], v[136:139], v[36:39]
    s_waitcnt lgkmcnt(3)
    v_add_f32 v72, v72, v204
    v_add_f32 v73, v73, v205
    v_mfma_f32_16x16x32_bf16 v[32:35], v[124:127], v[148:151], v[32:35]
    v_add_f32 v74, v74, v206
    v_add_f32 v75, v75, v207
    v_mfma_f32_16x16x32_bf16 v[36:39], v[128:131], v[148:151], v[36:39]
    v_cvt_pk_bf16_f32 v72, v72, v73
    v_cvt_pk_bf16_f32 v73, v74, v75
    v_mfma_f32_16x16x32_bf16 v[40:43], v[108:111], v[136:139], v[40:43]
    s_mov_b32 s45, 774144
    buffer_store_dwordx2 v[72:73], v180, s[20:23], s45 offen offset:0
    v_mfma_f32_16x16x32_bf16 v[44:47], v[112:115], v[136:139], v[44:47]
    v_cvt_pk_bf16_f32 v24, v24, v25
    v_cvt_pk_bf16_f32 v25, v26, v27
    v_mfma_f32_16x16x32_bf16 v[40:43], v[116:119], v[148:151], v[40:43]
    ds_write_b64 v181, v[24:25] offset:3840
    v_cvt_pk_bf16_f32 v28, v28, v29
    v_mfma_f32_16x16x32_bf16 v[44:47], v[120:123], v[148:151], v[44:47]
    v_cvt_pk_bf16_f32 v29, v30, v31
    ds_write_b64 v181, v[28:29] offset:3872
    v_mfma_f32_16x16x32_bf16 v[40:43], v[124:127], v[144:147], v[40:43]
    ds_read_b128 v[152:155], v164 offset:18304
    ds_read_b128 v[200:203], v182 offset:3840
    s_mov_b32 s57, 172032
    v_mfma_f32_16x16x32_bf16 v[44:47], v[128:131], v[144:147], v[44:47]
    s_waitcnt lgkmcnt(4)
    buffer_store_dwordx4 v[196:199], v183, s[20:23], s57 offen
    v_cvt_pk_bf16_f32 v32, v32, v33
    v_mfma_f32_16x16x32_bf16 v[48:51], v[108:111], v[148:151], v[48:51]
    v_cvt_pk_bf16_f32 v33, v34, v35
    ds_write_b64 v181, v[32:33] offset:5120
    v_mfma_f32_16x16x32_bf16 v[52:55], v[112:115], v[148:151], v[52:55]
    v_cvt_pk_bf16_f32 v36, v36, v37
    v_cvt_pk_bf16_f32 v37, v38, v39
    v_mfma_f32_16x16x32_bf16 v[48:51], v[116:119], v[144:147], v[48:51]
    ds_write_b64 v181, v[36:37] offset:5152
    ds_read_b128 v[188:191], v182 offset:5120
    v_mfma_f32_16x16x32_bf16 v[52:55], v[120:123], v[144:147], v[52:55]
    s_mov_b32 s57, 258048
    s_waitcnt lgkmcnt(3)
    buffer_store_dwordx4 v[200:203], v183, s[20:23], s57 offen
    v_mfma_f32_16x16x32_bf16 v[48:51], v[124:127], v[140:143], v[48:51]
    ds_read_b128 v[156:159], v164 offset:19712
    v_cvt_pk_bf16_f32 v40, v40, v41
    v_cvt_pk_bf16_f32 v41, v42, v43
    v_mfma_f32_16x16x32_bf16 v[52:55], v[128:131], v[140:143], v[52:55]
    ds_write_b64 v181, v[40:41] offset:0
    v_cvt_pk_bf16_f32 v44, v44, v45
    v_mfma_f32_16x16x32_bf16 v[56:59], v[108:111], v[144:147], v[56:59]
    v_cvt_pk_bf16_f32 v45, v46, v47
    ds_write_b64 v181, v[44:45] offset:32
    v_mfma_f32_16x16x32_bf16 v[60:63], v[112:115], v[144:147], v[60:63]
    ds_read_b128 v[192:195], v182 offset:0
    s_mov_b32 s57, 344064
    v_mfma_f32_16x16x32_bf16 v[56:59], v[116:119], v[140:143], v[56:59]
    s_waitcnt lgkmcnt(4)
    buffer_store_dwordx4 v[188:191], v183, s[20:23], s57 offen
    v_mfma_f32_16x16x32_bf16 v[60:63], v[120:123], v[140:143], v[60:63]
    v_mfma_f32_16x16x32_bf16 v[56:59], v[124:127], v[152:155], v[56:59]
    v_cvt_pk_bf16_f32 v48, v48, v49
    v_cvt_pk_bf16_f32 v49, v50, v51
    v_mfma_f32_16x16x32_bf16 v[60:63], v[128:131], v[152:155], v[60:63]
    ds_write_b64 v181, v[48:49] offset:1280
    v_cvt_pk_bf16_f32 v52, v52, v53
    v_mfma_f32_16x16x32_bf16 v[64:67], v[108:111], v[140:143], v[64:67]
    v_cvt_pk_bf16_f32 v53, v54, v55
    ds_write_b64 v181, v[52:53] offset:1312
    v_mfma_f32_16x16x32_bf16 v[68:71], v[112:115], v[140:143], v[68:71]
    ds_read_b128 v[196:199], v182 offset:1280
    s_mov_b32 s57, 430080
    v_mfma_f32_16x16x32_bf16 v[64:67], v[116:119], v[152:155], v[64:67]
    s_waitcnt lgkmcnt(3)
    buffer_store_dwordx4 v[192:195], v183, s[20:23], s57 offen
    v_mfma_f32_16x16x32_bf16 v[68:71], v[120:123], v[152:155], v[68:71]
    v_mfma_f32_16x16x32_bf16 v[64:67], v[124:127], v[156:159], v[64:67]
    v_cvt_pk_bf16_f32 v56, v56, v57
    v_cvt_pk_bf16_f32 v57, v58, v59
    v_mfma_f32_16x16x32_bf16 v[68:71], v[128:131], v[156:159], v[68:71]
    ds_write_b64 v181, v[56:57] offset:2560
    v_cvt_pk_bf16_f32 v60, v60, v61
    v_cvt_pk_bf16_f32 v61, v62, v63
    ds_write_b64 v181, v[60:61] offset:2592
    ds_read_b128 v[200:203], v182 offset:2560
    s_mov_b32 s57, 516096
    s_waitcnt lgkmcnt(3)
    buffer_store_dwordx4 v[196:199], v183, s[20:23], s57 offen
    v_cvt_pk_bf16_f32 v64, v64, v65
    v_cvt_pk_bf16_f32 v65, v66, v67
    ds_write_b64 v181, v[64:65] offset:3840
    v_cvt_pk_bf16_f32 v68, v68, v69
    v_cvt_pk_bf16_f32 v69, v70, v71
    ds_write_b64 v181, v[68:69] offset:3872
    ds_read_b128 v[188:191], v182 offset:3840
    s_mov_b32 s57, 602112
    s_waitcnt lgkmcnt(3)
    buffer_store_dwordx4 v[200:203], v183, s[20:23], s57 offen
    s_mov_b32 s57, 688128
    s_waitcnt lgkmcnt(0)
    buffer_store_dwordx4 v[188:191], v183, s[20:23], s57 offen
    s_endpgm
.p2align 6
C_Q1:
    s_barrier
    ds_read_b64_tr_b16 v[80:81], v166 offset:0
    ds_read_b64_tr_b16 v[82:83], v166 offset:1024
    ds_read_b128 v[132:135], v164 offset:0
    ds_read_b64_tr_b16 v[76:77], v165 offset:0
    ds_read_b64_tr_b16 v[78:79], v165 offset:1024
    ds_read_b128 v[136:139], v164 offset:1408
    ds_read_b64_tr_b16 v[88:89], v166 offset:2048
    ds_read_b64_tr_b16 v[90:91], v166 offset:3072
    s_waitcnt lgkmcnt(5)
    v_mfma_f32_16x16x32_bf16 v[4:7], v[80:83], v[132:135], 0
    ds_read_b64_tr_b16 v[84:85], v165 offset:2048
    ds_read_b64_tr_b16 v[86:87], v165 offset:3072
    s_waitcnt lgkmcnt(4)
    v_mfma_f32_16x16x32_bf16 v[8:11], v[76:79], v[136:139], 0
    s_barrier
    ds_read_b128 v[140:143], v164 offset:2816
    v_mfma_f32_16x16x32_bf16 v[12:15], v[80:83], v[136:139], 0
    ds_read_b64_tr_b16 v[96:97], v166 offset:4096
    ds_read_b64_tr_b16 v[98:99], v166 offset:5120
    s_waitcnt lgkmcnt(5)
    v_mfma_f32_16x16x32_bf16 v[4:7], v[88:91], v[136:139], v[4:7]
    ds_read_b128 v[144:147], v164 offset:4224
    ds_read_b64_tr_b16 v[92:93], v165 offset:4096
    s_waitcnt lgkmcnt(4)
    v_mfma_f32_16x16x32_bf16 v[16:19], v[76:79], v[140:143], 0
    ds_read_b64_tr_b16 v[94:95], v165 offset:5120
    ds_read_b64_tr_b16 v[104:105], v166 offset:6144
    v_mfma_f32_16x16x32_bf16 v[20:23], v[80:83], v[140:143], 0
    ds_read_b64_tr_b16 v[106:107], v166 offset:7168
    ds_read_b64_tr_b16 v[100:101], v165 offset:6144
    v_mfma_f32_16x16x32_bf16 v[8:11], v[84:87], v[140:143], v[8:11]
    ds_read_b64_tr_b16 v[102:103], v165 offset:7168
    v_mfma_f32_16x16x32_bf16 v[12:15], v[88:91], v[140:143], v[12:15]
    s_waitcnt lgkmcnt(7)
    v_mfma_f32_16x16x32_bf16 v[4:7], v[96:99], v[140:143], v[4:7]
    s_waitcnt lgkmcnt(6)
    v_mfma_f32_16x16x32_bf16 v[24:27], v[76:79], v[144:147], 0
    v_mfma_f32_16x16x32_bf16 v[28:31], v[80:83], v[144:147], 0
    v_mfma_f32_16x16x32_bf16 v[16:19], v[84:87], v[144:147], v[16:19]
    s_barrier
    ds_read_b128 v[148:151], v164 offset:5632
    v_mfma_f32_16x16x32_bf16 v[20:23], v[88:91], v[144:147], v[20:23]
    ds_read_b64_tr_b16 v[108:109], v165 offset:8192
    ds_read_b64_tr_b16 v[110:111], v165 offset:9216
    s_waitcnt lgkmcnt(6)
    v_mfma_f32_16x16x32_bf16 v[8:11], v[92:95], v[144:147], v[8:11]
    ds_read_b64_tr_b16 v[112:113], v166 offset:8192
    ds_read_b64_tr_b16 v[114:115], v166 offset:9216
    v_mfma_f32_16x16x32_bf16 v[12:15], v[96:99], v[144:147], v[12:15]
    ds_read_b128 v[152:155], v164 offset:7040
    ds_read_b64_tr_b16 v[116:117], v165 offset:10240
    s_waitcnt lgkmcnt(7)
    v_mfma_f32_16x16x32_bf16 v[4:7], v[104:107], v[144:147], v[4:7]
    ds_read_b64_tr_b16 v[118:119], v165 offset:11264
    ds_read_b64_tr_b16 v[120:121], v166 offset:10240
    s_waitcnt lgkmcnt(8)
    v_mfma_f32_16x16x32_bf16 v[32:35], v[76:79], v[148:151], 0
    ds_read_b64_tr_b16 v[122:123], v166 offset:11264
    v_mfma_f32_16x16x32_bf16 v[36:39], v[80:83], v[148:151], 0
    v_mfma_f32_16x16x32_bf16 v[24:27], v[84:87], v[148:151], v[24:27]
    v_mfma_f32_16x16x32_bf16 v[28:31], v[88:91], v[148:151], v[28:31]
    v_mfma_f32_16x16x32_bf16 v[16:19], v[92:95], v[148:151], v[16:19]
    v_mfma_f32_16x16x32_bf16 v[20:23], v[96:99], v[148:151], v[20:23]
    v_mfma_f32_16x16x32_bf16 v[8:11], v[100:103], v[148:151], v[8:11]
    v_mfma_f32_16x16x32_bf16 v[12:15], v[104:107], v[148:151], v[12:15]
    s_waitcnt lgkmcnt(1)
    v_mfma_f32_16x16x32_bf16 v[0:3], v[108:111], v[148:151], 0
    v_mfma_f32_16x16x32_bf16 v[4:7], v[112:115], v[148:151], v[4:7]
    v_mfma_f32_16x16x32_bf16 v[40:43], v[76:79], v[152:155], 0
    v_mfma_f32_16x16x32_bf16 v[44:47], v[80:83], v[152:155], 0
    v_mfma_f32_16x16x32_bf16 v[32:35], v[84:87], v[152:155], v[32:35]
    v_mfma_f32_16x16x32_bf16 v[36:39], v[88:91], v[152:155], v[36:39]
    v_mfma_f32_16x16x32_bf16 v[24:27], v[92:95], v[152:155], v[24:27]
    v_mfma_f32_16x16x32_bf16 v[28:31], v[96:99], v[152:155], v[28:31]
    s_barrier
    v_mfma_f32_16x16x32_bf16 v[16:19], v[100:103], v[152:155], v[16:19]
    ds_read_b128 v[156:159], v164 offset:8448
    ds_read_b64_tr_b16 v[124:125], v165 offset:12288
    v_mfma_f32_16x16x32_bf16 v[20:23], v[104:107], v[152:155], v[20:23]
    ds_read_b64_tr_b16 v[126:127], v165 offset:13312
    ds_read_b64_tr_b16 v[128:129], v166 offset:12288
    v_mfma_f32_16x16x32_bf16 v[8:11], v[108:111], v[152:155], v[8:11]
    ds_read_b64_tr_b16 v[130:131], v166 offset:13312
    ds_read_b128 v[160:163], v164 offset:9856
    v_mfma_f32_16x16x32_bf16 v[12:15], v[112:115], v[152:155], v[12:15]
    v_mfma_f32_16x16x32_bf16 v[0:3], v[116:119], v[152:155], v[0:3]
    s_waitcnt lgkmcnt(6)
    v_mfma_f32_16x16x32_bf16 v[4:7], v[120:123], v[152:155], v[4:7]
    s_waitcnt lgkmcnt(5)
    v_mfma_f32_16x16x32_bf16 v[48:51], v[76:79], v[156:159], 0
    v_mfma_f32_16x16x32_bf16 v[52:55], v[80:83], v[156:159], 0
    v_mfma_f32_16x16x32_bf16 v[40:43], v[84:87], v[156:159], v[40:43]
    ds_read_b128 v[136:139], v164 offset:12672
    v_mfma_f32_16x16x32_bf16 v[44:47], v[88:91], v[156:159], v[44:47]
    v_mfma_f32_16x16x32_bf16 v[32:35], v[92:95], v[156:159], v[32:35]
    v_mfma_f32_16x16x32_bf16 v[36:39], v[96:99], v[156:159], v[36:39]
    v_mfma_f32_16x16x32_bf16 v[24:27], v[100:103], v[156:159], v[24:27]
    v_mfma_f32_16x16x32_bf16 v[28:31], v[104:107], v[156:159], v[28:31]
    v_mfma_f32_16x16x32_bf16 v[16:19], v[108:111], v[156:159], v[16:19]
    v_mfma_f32_16x16x32_bf16 v[20:23], v[112:115], v[156:159], v[20:23]
    v_mfma_f32_16x16x32_bf16 v[8:11], v[116:119], v[156:159], v[8:11]
    v_mfma_f32_16x16x32_bf16 v[12:15], v[120:123], v[156:159], v[12:15]
    s_waitcnt lgkmcnt(0)
    v_mfma_f32_16x16x32_bf16 v[0:3], v[124:127], v[156:159], v[0:3]
    v_mfma_f32_16x16x32_bf16 v[4:7], v[128:131], v[156:159], v[4:7]
    v_mfma_f32_16x16x32_bf16 v[56:59], v[76:79], v[160:163], 0
    v_mfma_f32_16x16x32_bf16 v[60:63], v[80:83], v[160:163], 0
    ds_read_b128 v[140:143], v164 offset:14080
    v_mfma_f32_16x16x32_bf16 v[48:51], v[84:87], v[160:163], v[48:51]
    v_mfma_f32_16x16x32_bf16 v[52:55], v[88:91], v[160:163], v[52:55]
    v_mfma_f32_16x16x32_bf16 v[40:43], v[92:95], v[160:163], v[40:43]
    v_mfma_f32_16x16x32_bf16 v[44:47], v[96:99], v[160:163], v[44:47]
    s_barrier
    v_mfma_f32_16x16x32_bf16 v[32:35], v[100:103], v[160:163], v[32:35]
    ds_read_b128 v[132:135], v164 offset:11264
    v_mfma_f32_16x16x32_bf16 v[36:39], v[104:107], v[160:163], v[36:39]
    v_mfma_f32_16x16x32_bf16 v[24:27], v[108:111], v[160:163], v[24:27]
    v_mfma_f32_16x16x32_bf16 v[28:31], v[112:115], v[160:163], v[28:31]
    v_mfma_f32_16x16x32_bf16 v[16:19], v[116:119], v[160:163], v[16:19]
    s_add_u32 s48, s48, 1
    v_mfma_f32_16x16x32_bf16 v[20:23], v[120:123], v[160:163], v[20:23]
    s_cmp_eq_u32 s48, 7
    v_mfma_f32_16x16x32_bf16 v[8:11], v[124:127], v[160:163], v[8:11]
    ds_read_b128 v[144:147], v164 offset:15488
    v_mfma_f32_16x16x32_bf16 v[12:15], v[128:131], v[160:163], v[12:15]
    s_cselect_b32 s44, s51, 0
    s_waitcnt lgkmcnt(1)
    v_mfma_f32_16x16x32_bf16 v[64:67], v[76:79], v[132:135], 0
    s_cselect_b32 s48, 0, s48
    v_mfma_f32_16x16x32_bf16 v[68:71], v[80:83], v[132:135], 0
    s_xor_b32 s50, s50, s44
    v_mfma_f32_16x16x32_bf16 v[56:59], v[84:87], v[132:135], v[56:59]
    v_add_u32 v172, s48, v167
    v_mfma_f32_16x16x32_bf16 v[60:63], v[88:91], v[132:135], v[60:63]
    v_and_b32 v173, 4, v172
    v_mfma_f32_16x16x32_bf16 v[48:51], v[92:95], v[132:135], v[48:51]
    v_lshlrev_b32 v173, 3, v173
    v_mfma_f32_16x16x32_bf16 v[52:55], v[96:99], v[132:135], v[52:55]
    v_xor_b32 v173, v173, v168
    v_mfma_f32_16x16x32_bf16 v[40:43], v[100:103], v[132:135], v[40:43]
    v_lshl_add_u32 v173, v172, 6, v173
    v_mfma_f32_16x16x32_bf16 v[44:47], v[104:107], v[132:135], v[44:47]
    ds_read_b128 v[148:151], v164 offset:16896
    v_mfma_f32_16x16x32_bf16 v[32:35], v[108:111], v[132:135], v[32:35]
    v_add_u32 v170, s50, v173
    v_mfma_f32_16x16x32_bf16 v[36:39], v[112:115], v[132:135], v[36:39]
    v_mfma_f32_16x16x32_bf16 v[24:27], v[116:119], v[132:135], v[24:27]
    v_mfma_f32_16x16x32_bf16 v[28:31], v[120:123], v[132:135], v[28:31]
    v_mfma_f32_16x16x32_bf16 v[16:19], v[124:127], v[132:135], v[16:19]
    v_mfma_f32_16x16x32_bf16 v[20:23], v[128:131], v[132:135], v[20:23]
    v_mfma_f32_16x16x32_bf16 v[72:75], v[76:79], v[136:139], 0
    ds_read_b128 v[152:155], v164 offset:18304
    v_mfma_f32_16x16x32_bf16 v[64:67], v[84:87], v[136:139], v[64:67]
    v_mfma_f32_16x16x32_bf16 v[68:71], v[88:91], v[136:139], v[68:71]
    v_mfma_f32_16x16x32_bf16 v[56:59], v[92:95], v[136:139], v[56:59]
    s_barrier
    v_mfma_f32_16x16x32_bf16 v[60:63], v[96:99], v[136:139], v[60:63]
    s_xor_b32 s52, s52, s53
    v_mfma_f32_16x16x32_bf16 v[48:51], v[100:103], v[136:139], v[48:51]
    ds_read_b128 v[156:159], v164 offset:19712
    v_mfma_f32_16x16x32_bf16 v[52:55], v[104:107], v[136:139], v[52:55]
    v_add_u32 v165, s52, v169
    v_mfma_f32_16x16x32_bf16 v[40:43], v[108:111], v[136:139], v[40:43]
    v_xor_b32 v166, 32, v165
    v_mfma_f32_16x16x32_bf16 v[44:47], v[112:115], v[136:139], v[44:47]
    ds_read_b128 v[160:163], v164 offset:21120
    v_mfma_f32_16x16x32_bf16 v[32:35], v[116:119], v[136:139], v[32:35]
    v_mfma_f32_16x16x32_bf16 v[36:39], v[120:123], v[136:139], v[36:39]
    v_mfma_f32_16x16x32_bf16 v[24:27], v[124:127], v[136:139], v[24:27]
    v_mfma_f32_16x16x32_bf16 v[28:31], v[128:131], v[136:139], v[28:31]
    v_mfma_f32_16x16x32_bf16 v[72:75], v[84:87], v[140:143], v[72:75]
    v_mfma_f32_16x16x32_bf16 v[64:67], v[92:95], v[140:143], v[64:67]
    v_mfma_f32_16x16x32_bf16 v[68:71], v[96:99], v[140:143], v[68:71]
    v_mfma_f32_16x16x32_bf16 v[56:59], v[100:103], v[140:143], v[56:59]
    v_mfma_f32_16x16x32_bf16 v[60:63], v[104:107], v[140:143], v[60:63]
    v_mfma_f32_16x16x32_bf16 v[48:51], v[108:111], v[140:143], v[48:51]
    v_mfma_f32_16x16x32_bf16 v[52:55], v[112:115], v[140:143], v[52:55]
    v_mfma_f32_16x16x32_bf16 v[40:43], v[116:119], v[140:143], v[40:43]
    v_mov_b32 v164, v170
    v_mfma_f32_16x16x32_bf16 v[44:47], v[120:123], v[140:143], v[44:47]
    v_mfma_f32_16x16x32_bf16 v[32:35], v[124:127], v[140:143], v[32:35]
    v_mfma_f32_16x16x32_bf16 v[36:39], v[128:131], v[140:143], v[36:39]
    s_waitcnt lgkmcnt(0)
    v_mfma_f32_16x16x32_bf16 v[72:75], v[92:95], v[144:147], v[72:75]
    v_mfma_f32_16x16x32_bf16 v[64:67], v[100:103], v[144:147], v[64:67]
    s_barrier
    v_mfma_f32_16x16x32_bf16 v[68:71], v[104:107], v[144:147], v[68:71]
    v_mfma_f32_16x16x32_bf16 v[56:59], v[108:111], v[144:147], v[56:59]
    v_mfma_f32_16x16x32_bf16 v[60:63], v[112:115], v[144:147], v[60:63]
    ds_read_b64_tr_b16 v[106:107], v166 offset:7168
    v_mfma_f32_16x16x32_bf16 v[48:51], v[116:119], v[144:147], v[48:51]
    ds_read_b64_tr_b16 v[94:95], v165 offset:5120
    v_mfma_f32_16x16x32_bf16 v[52:55], v[120:123], v[144:147], v[52:55]
    ds_read_b64_tr_b16 v[98:99], v166 offset:5120
    v_mfma_f32_16x16x32_bf16 v[40:43], v[124:127], v[144:147], v[40:43]
    ds_read_b128 v[140:143], v170 offset:2816
    v_mfma_f32_16x16x32_bf16 v[44:47], v[128:131], v[144:147], v[44:47]
    ds_read_b128 v[136:139], v170 offset:1408
    v_mfma_f32_16x16x32_bf16 v[72:75], v[100:103], v[148:151], v[72:75]
    ds_read_b64_tr_b16 v[78:79], v165 offset:1024
    v_mfma_f32_16x16x32_bf16 v[64:67], v[108:111], v[148:151], v[64:67]
    ds_read_b64_tr_b16 v[76:77], v165 offset:0
    v_mfma_f32_16x16x32_bf16 v[68:71], v[112:115], v[148:151], v[68:71]
    ds_read_b128 v[132:135], v170 offset:0
    v_mfma_f32_16x16x32_bf16 v[56:59], v[116:119], v[148:151], v[56:59]
    ds_read_b64_tr_b16 v[82:83], v166 offset:1024
    v_mfma_f32_16x16x32_bf16 v[60:63], v[120:123], v[148:151], v[60:63]
    ds_read_b64_tr_b16 v[80:81], v166 offset:0
    v_mfma_f32_16x16x32_bf16 v[48:51], v[124:127], v[148:151], v[48:51]
    v_mfma_f32_16x16x32_bf16 v[52:55], v[128:131], v[148:151], v[52:55]
    ds_read_b64_tr_b16 v[90:91], v166 offset:3072
    v_mfma_f32_16x16x32_bf16 v[72:75], v[108:111], v[152:155], v[72:75]
    ds_read_b64_tr_b16 v[88:89], v166 offset:2048
    v_mfma_f32_16x16x32_bf16 v[64:67], v[116:119], v[152:155], v[64:67]
    v_mfma_f32_16x16x32_bf16 v[68:71], v[120:123], v[152:155], v[68:71]
    ds_read_b64_tr_b16 v[86:87], v165 offset:3072
    v_mfma_f32_16x16x32_bf16 v[56:59], v[124:127], v[152:155], v[56:59]
    ds_read_b64_tr_b16 v[84:85], v165 offset:2048
    v_mfma_f32_16x16x32_bf16 v[60:63], v[128:131], v[152:155], v[60:63]
    v_mfma_f32_16x16x32_bf16 v[72:75], v[116:119], v[156:159], v[72:75]
    ds_read_b64_tr_b16 v[96:97], v166 offset:4096
    v_mfma_f32_16x16x32_bf16 v[64:67], v[124:127], v[156:159], v[64:67]
    ds_read_b128 v[144:147], v170 offset:4224
    v_mfma_f32_16x16x32_bf16 v[68:71], v[128:131], v[156:159], v[68:71]
    v_mfma_f32_16x16x32_bf16 v[72:75], v[124:127], v[160:163], v[72:75]
    s_waitcnt lgkmcnt(4)
    s_barrier
C_Q1_LOOP:
    v_mfma_f32_16x16x32_bf16 v[4:7], v[80:83], v[132:135], v[4:7]
    v_mfma_f32_16x16x32_bf16 v[8:11], v[76:79], v[136:139], v[8:11]
    ds_read_b64_tr_b16 v[92:93], v165 offset:4096
    v_mfma_f32_16x16x32_bf16 v[12:15], v[80:83], v[136:139], v[12:15]
    v_mfma_f32_16x16x32_bf16 v[4:7], v[88:91], v[136:139], v[4:7]
    ds_read_b64_tr_b16 v[104:105], v166 offset:6144
    v_mfma_f32_16x16x32_bf16 v[16:19], v[76:79], v[140:143], v[16:19]
    ds_read_b128 v[148:151], v164 offset:5632
    v_mfma_f32_16x16x32_bf16 v[20:23], v[80:83], v[140:143], v[20:23]
    s_waitcnt lgkmcnt(3)
    v_mfma_f32_16x16x32_bf16 v[8:11], v[84:87], v[140:143], v[8:11]
    ds_read_b64_tr_b16 v[114:115], v166 offset:9216
    v_mfma_f32_16x16x32_bf16 v[12:15], v[88:91], v[140:143], v[12:15]
    ds_read_b64_tr_b16 v[112:113], v166 offset:8192
    v_mfma_f32_16x16x32_bf16 v[4:7], v[96:99], v[140:143], v[4:7]
    ds_read_b64_tr_b16 v[110:111], v165 offset:9216
    v_mfma_f32_16x16x32_bf16 v[24:27], v[76:79], v[144:147], v[24:27]
    ds_read_b64_tr_b16 v[102:103], v165 offset:7168
    v_mfma_f32_16x16x32_bf16 v[28:31], v[80:83], v[144:147], v[28:31]
    ds_read_b64_tr_b16 v[100:101], v165 offset:6144
    v_mfma_f32_16x16x32_bf16 v[16:19], v[84:87], v[144:147], v[16:19]
    v_mfma_f32_16x16x32_bf16 v[20:23], v[88:91], v[144:147], v[20:23]
    ds_read_b64_tr_b16 v[108:109], v165 offset:8192
    s_waitcnt lgkmcnt(6)
    v_mfma_f32_16x16x32_bf16 v[8:11], v[92:95], v[144:147], v[8:11]
    v_mfma_f32_16x16x32_bf16 v[12:15], v[96:99], v[144:147], v[12:15]
    ds_read_b128 v[152:155], v164 offset:7040
    v_mfma_f32_16x16x32_bf16 v[4:7], v[104:107], v[144:147], v[4:7]
    v_mfma_f32_16x16x32_bf16 v[32:35], v[76:79], v[148:151], v[32:35]
    v_mfma_f32_16x16x32_bf16 v[36:39], v[80:83], v[148:151], v[36:39]
    v_mfma_f32_16x16x32_bf16 v[24:27], v[84:87], v[148:151], v[24:27]
    v_mfma_f32_16x16x32_bf16 v[28:31], v[88:91], v[148:151], v[28:31]
    v_mfma_f32_16x16x32_bf16 v[16:19], v[92:95], v[148:151], v[16:19]
    v_mfma_f32_16x16x32_bf16 v[20:23], v[96:99], v[148:151], v[20:23]
    ds_read_b64_tr_b16 v[122:123], v166 offset:11264
    s_waitcnt lgkmcnt(2)
    v_mfma_f32_16x16x32_bf16 v[8:11], v[100:103], v[148:151], v[8:11]
    ds_read_b64_tr_b16 v[120:121], v166 offset:10240
    v_mfma_f32_16x16x32_bf16 v[12:15], v[104:107], v[148:151], v[12:15]
    ds_read_b64_tr_b16 v[118:119], v165 offset:11264
    v_mfma_f32_16x16x32_bf16 v[0:3], v[108:111], v[148:151], v[0:3]
    ds_read_b64_tr_b16 v[116:117], v165 offset:10240
    v_mfma_f32_16x16x32_bf16 v[4:7], v[112:115], v[148:151], v[4:7]
    s_waitcnt lgkmcnt(4)
    v_mfma_f32_16x16x32_bf16 v[40:43], v[76:79], v[152:155], v[40:43]
    ds_read_b128 v[156:159], v164 offset:8448
    v_mfma_f32_16x16x32_bf16 v[44:47], v[80:83], v[152:155], v[44:47]
    v_mfma_f32_16x16x32_bf16 v[32:35], v[84:87], v[152:155], v[32:35]
    v_mfma_f32_16x16x32_bf16 v[36:39], v[88:91], v[152:155], v[36:39]
    v_mfma_f32_16x16x32_bf16 v[24:27], v[92:95], v[152:155], v[24:27]
    v_mfma_f32_16x16x32_bf16 v[28:31], v[96:99], v[152:155], v[28:31]
    v_mfma_f32_16x16x32_bf16 v[16:19], v[100:103], v[152:155], v[16:19]
    v_mfma_f32_16x16x32_bf16 v[20:23], v[104:107], v[152:155], v[20:23]
    v_mfma_f32_16x16x32_bf16 v[8:11], v[108:111], v[152:155], v[8:11]
    v_mfma_f32_16x16x32_bf16 v[12:15], v[112:115], v[152:155], v[12:15]
    ds_read_b64_tr_b16 v[130:131], v166 offset:13312
    s_waitcnt lgkmcnt(1)
    v_mfma_f32_16x16x32_bf16 v[0:3], v[116:119], v[152:155], v[0:3]
    ds_read_b64_tr_b16 v[128:129], v166 offset:12288
    v_mfma_f32_16x16x32_bf16 v[4:7], v[120:123], v[152:155], v[4:7]
    ds_read_b64_tr_b16 v[126:127], v165 offset:13312
    v_mfma_f32_16x16x32_bf16 v[48:51], v[76:79], v[156:159], v[48:51]
    ds_read_b64_tr_b16 v[124:125], v165 offset:12288
    v_mfma_f32_16x16x32_bf16 v[52:55], v[80:83], v[156:159], v[52:55]
    v_mfma_f32_16x16x32_bf16 v[40:43], v[84:87], v[156:159], v[40:43]
    ds_read_b128 v[160:163], v164 offset:9856
    v_mfma_f32_16x16x32_bf16 v[44:47], v[88:91], v[156:159], v[44:47]
    v_mfma_f32_16x16x32_bf16 v[32:35], v[92:95], v[156:159], v[32:35]
    v_mfma_f32_16x16x32_bf16 v[36:39], v[96:99], v[156:159], v[36:39]
    v_mfma_f32_16x16x32_bf16 v[24:27], v[100:103], v[156:159], v[24:27]
    v_mfma_f32_16x16x32_bf16 v[28:31], v[104:107], v[156:159], v[28:31]
    v_mfma_f32_16x16x32_bf16 v[16:19], v[108:111], v[156:159], v[16:19]
    v_mfma_f32_16x16x32_bf16 v[20:23], v[112:115], v[156:159], v[20:23]
    v_mfma_f32_16x16x32_bf16 v[8:11], v[116:119], v[156:159], v[8:11]
    v_mfma_f32_16x16x32_bf16 v[12:15], v[120:123], v[156:159], v[12:15]
    s_waitcnt lgkmcnt(0)
    v_mfma_f32_16x16x32_bf16 v[0:3], v[124:127], v[156:159], v[0:3]
    v_mfma_f32_16x16x32_bf16 v[4:7], v[128:131], v[156:159], v[4:7]
    v_mfma_f32_16x16x32_bf16 v[56:59], v[76:79], v[160:163], v[56:59]
    v_mfma_f32_16x16x32_bf16 v[60:63], v[80:83], v[160:163], v[60:63]
    v_mfma_f32_16x16x32_bf16 v[48:51], v[84:87], v[160:163], v[48:51]
    ds_read_b128 v[132:135], v164 offset:11264
    v_mfma_f32_16x16x32_bf16 v[52:55], v[88:91], v[160:163], v[52:55]
    v_mfma_f32_16x16x32_bf16 v[40:43], v[92:95], v[160:163], v[40:43]
    v_mfma_f32_16x16x32_bf16 v[44:47], v[96:99], v[160:163], v[44:47]
    v_mfma_f32_16x16x32_bf16 v[32:35], v[100:103], v[160:163], v[32:35]
    v_mfma_f32_16x16x32_bf16 v[36:39], v[104:107], v[160:163], v[36:39]
    s_barrier
    v_mfma_f32_16x16x32_bf16 v[24:27], v[108:111], v[160:163], v[24:27]
    s_xor_b32 s52, s52, s53
    v_mfma_f32_16x16x32_bf16 v[28:31], v[112:115], v[160:163], v[28:31]
    v_add_u32 v165, s52, v169
    v_mfma_f32_16x16x32_bf16 v[16:19], v[116:119], v[160:163], v[16:19]
    v_xor_b32 v166, 32, v165
    v_mfma_f32_16x16x32_bf16 v[20:23], v[120:123], v[160:163], v[20:23]
    v_mfma_f32_16x16x32_bf16 v[8:11], v[124:127], v[160:163], v[8:11]
    s_add_u32 s48, s48, 1
    v_mfma_f32_16x16x32_bf16 v[12:15], v[128:131], v[160:163], v[12:15]
    s_cmp_eq_u32 s48, 7
    s_waitcnt lgkmcnt(0)
    v_mfma_f32_16x16x32_bf16 v[64:67], v[76:79], v[132:135], v[64:67]
    s_cselect_b32 s44, s51, 0
    v_mfma_f32_16x16x32_bf16 v[68:71], v[80:83], v[132:135], v[68:71]
    s_cselect_b32 s48, 0, s48
    v_mfma_f32_16x16x32_bf16 v[56:59], v[84:87], v[132:135], v[56:59]
    ds_read_b128 v[136:139], v164 offset:12672
    v_mfma_f32_16x16x32_bf16 v[60:63], v[88:91], v[132:135], v[60:63]
    s_xor_b32 s50, s50, s44
    v_mfma_f32_16x16x32_bf16 v[48:51], v[92:95], v[132:135], v[48:51]
    v_add_u32 v172, s48, v167
    v_mfma_f32_16x16x32_bf16 v[52:55], v[96:99], v[132:135], v[52:55]
    v_and_b32 v173, 4, v172
    v_mfma_f32_16x16x32_bf16 v[40:43], v[100:103], v[132:135], v[40:43]
    v_lshlrev_b32 v173, 3, v173
    v_mfma_f32_16x16x32_bf16 v[44:47], v[104:107], v[132:135], v[44:47]
    v_xor_b32 v173, v173, v168
    v_mfma_f32_16x16x32_bf16 v[32:35], v[108:111], v[132:135], v[32:35]
    v_lshl_add_u32 v173, v172, 6, v173
    v_mfma_f32_16x16x32_bf16 v[36:39], v[112:115], v[132:135], v[36:39]
    v_add_u32 v170, s50, v173
    v_mfma_f32_16x16x32_bf16 v[24:27], v[116:119], v[132:135], v[24:27]
    v_mfma_f32_16x16x32_bf16 v[28:31], v[120:123], v[132:135], v[28:31]
    v_mfma_f32_16x16x32_bf16 v[16:19], v[124:127], v[132:135], v[16:19]
    v_mfma_f32_16x16x32_bf16 v[20:23], v[128:131], v[132:135], v[20:23]
    s_waitcnt lgkmcnt(0)
    v_mfma_f32_16x16x32_bf16 v[72:75], v[76:79], v[136:139], v[72:75]
    v_mfma_f32_16x16x32_bf16 v[64:67], v[84:87], v[136:139], v[64:67]
    ds_read_b128 v[140:143], v164 offset:14080
    v_mfma_f32_16x16x32_bf16 v[68:71], v[88:91], v[136:139], v[68:71]
    v_mfma_f32_16x16x32_bf16 v[56:59], v[92:95], v[136:139], v[56:59]
    v_mfma_f32_16x16x32_bf16 v[60:63], v[96:99], v[136:139], v[60:63]
    v_mfma_f32_16x16x32_bf16 v[48:51], v[100:103], v[136:139], v[48:51]
    v_mfma_f32_16x16x32_bf16 v[52:55], v[104:107], v[136:139], v[52:55]
    v_mfma_f32_16x16x32_bf16 v[40:43], v[108:111], v[136:139], v[40:43]
    v_mfma_f32_16x16x32_bf16 v[44:47], v[112:115], v[136:139], v[44:47]
    v_mfma_f32_16x16x32_bf16 v[32:35], v[116:119], v[136:139], v[32:35]
    v_mfma_f32_16x16x32_bf16 v[36:39], v[120:123], v[136:139], v[36:39]
    v_mfma_f32_16x16x32_bf16 v[24:27], v[124:127], v[136:139], v[24:27]
    v_mfma_f32_16x16x32_bf16 v[28:31], v[128:131], v[136:139], v[28:31]
    ds_read_b128 v[144:147], v164 offset:15488
    s_waitcnt lgkmcnt(1)
    v_mfma_f32_16x16x32_bf16 v[72:75], v[84:87], v[140:143], v[72:75]
    v_mfma_f32_16x16x32_bf16 v[64:67], v[92:95], v[140:143], v[64:67]
    v_mfma_f32_16x16x32_bf16 v[68:71], v[96:99], v[140:143], v[68:71]
    v_mfma_f32_16x16x32_bf16 v[56:59], v[100:103], v[140:143], v[56:59]
    v_mfma_f32_16x16x32_bf16 v[60:63], v[104:107], v[140:143], v[60:63]
    v_mfma_f32_16x16x32_bf16 v[48:51], v[108:111], v[140:143], v[48:51]
    v_mfma_f32_16x16x32_bf16 v[52:55], v[112:115], v[140:143], v[52:55]
    v_mfma_f32_16x16x32_bf16 v[40:43], v[116:119], v[140:143], v[40:43]
    v_mfma_f32_16x16x32_bf16 v[44:47], v[120:123], v[140:143], v[44:47]
    ds_read_b128 v[148:151], v164 offset:16896
    v_mfma_f32_16x16x32_bf16 v[32:35], v[124:127], v[140:143], v[32:35]
    v_mfma_f32_16x16x32_bf16 v[36:39], v[128:131], v[140:143], v[36:39]
    s_waitcnt lgkmcnt(1)
    v_mfma_f32_16x16x32_bf16 v[72:75], v[92:95], v[144:147], v[72:75]
    v_mfma_f32_16x16x32_bf16 v[64:67], v[100:103], v[144:147], v[64:67]
    ds_read_b128 v[160:163], v164 offset:21120
    v_mfma_f32_16x16x32_bf16 v[68:71], v[104:107], v[144:147], v[68:71]
    ds_read_b128 v[156:159], v164 offset:19712
    v_mfma_f32_16x16x32_bf16 v[56:59], v[108:111], v[144:147], v[56:59]
    ds_read_b128 v[152:155], v164 offset:18304
    v_mfma_f32_16x16x32_bf16 v[60:63], v[112:115], v[144:147], v[60:63]
    ds_read_b64_tr_b16 v[106:107], v166 offset:7168
    v_mfma_f32_16x16x32_bf16 v[48:51], v[116:119], v[144:147], v[48:51]
    ds_read_b64_tr_b16 v[94:95], v165 offset:5120
    v_mfma_f32_16x16x32_bf16 v[52:55], v[120:123], v[144:147], v[52:55]
    ds_read_b64_tr_b16 v[98:99], v166 offset:5120
    v_mfma_f32_16x16x32_bf16 v[40:43], v[124:127], v[144:147], v[40:43]
    ds_read_b128 v[140:143], v170 offset:2816
    v_mfma_f32_16x16x32_bf16 v[44:47], v[128:131], v[144:147], v[44:47]
    ds_read_b128 v[136:139], v170 offset:1408
    s_waitcnt lgkmcnt(8)
    v_mfma_f32_16x16x32_bf16 v[72:75], v[100:103], v[148:151], v[72:75]
    ds_read_b64_tr_b16 v[78:79], v165 offset:1024
    v_mfma_f32_16x16x32_bf16 v[64:67], v[108:111], v[148:151], v[64:67]
    ds_read_b64_tr_b16 v[76:77], v165 offset:0
    v_mfma_f32_16x16x32_bf16 v[68:71], v[112:115], v[148:151], v[68:71]
    ds_read_b128 v[132:135], v170 offset:0
    v_mfma_f32_16x16x32_bf16 v[56:59], v[116:119], v[148:151], v[56:59]
    ds_read_b64_tr_b16 v[82:83], v166 offset:1024
    v_mfma_f32_16x16x32_bf16 v[60:63], v[120:123], v[148:151], v[60:63]
    ds_read_b64_tr_b16 v[80:81], v166 offset:0
    v_mfma_f32_16x16x32_bf16 v[48:51], v[124:127], v[148:151], v[48:51]
    v_mov_b32 v164, v170
    v_mfma_f32_16x16x32_bf16 v[52:55], v[128:131], v[148:151], v[52:55]
    ds_read_b64_tr_b16 v[90:91], v166 offset:3072
    s_waitcnt lgkmcnt(7)
    v_mfma_f32_16x16x32_bf16 v[72:75], v[108:111], v[152:155], v[72:75]
    ds_read_b64_tr_b16 v[88:89], v166 offset:2048
    v_mfma_f32_16x16x32_bf16 v[64:67], v[116:119], v[152:155], v[64:67]
    s_add_u32 s49, s49, 1
    v_mfma_f32_16x16x32_bf16 v[68:71], v[120:123], v[152:155], v[68:71]
    ds_read_b64_tr_b16 v[86:87], v165 offset:3072
    v_mfma_f32_16x16x32_bf16 v[56:59], v[124:127], v[152:155], v[56:59]
    ds_read_b64_tr_b16 v[84:85], v165 offset:2048
    v_mfma_f32_16x16x32_bf16 v[60:63], v[128:131], v[152:155], v[60:63]
    s_cmp_lt_u32 s49, 20
    v_mfma_f32_16x16x32_bf16 v[72:75], v[116:119], v[156:159], v[72:75]
    ds_read_b64_tr_b16 v[96:97], v166 offset:4096
    v_mfma_f32_16x16x32_bf16 v[64:67], v[124:127], v[156:159], v[64:67]
    ds_read_b128 v[144:147], v170 offset:4224
    v_mfma_f32_16x16x32_bf16 v[68:71], v[128:131], v[156:159], v[68:71]
    s_waitcnt lgkmcnt(4)
    v_mfma_f32_16x16x32_bf16 v[72:75], v[124:127], v[160:163], v[72:75]
    s_cbranch_scc1 C_Q1_LOOP
    v_mfma_f32_16x16x32_bf16 v[4:7], v[80:83], v[132:135], v[4:7]
    v_mfma_f32_16x16x32_bf16 v[8:11], v[76:79], v[136:139], v[8:11]
    ds_read_b64_tr_b16 v[92:93], v165 offset:4096
    v_mfma_f32_16x16x32_bf16 v[12:15], v[80:83], v[136:139], v[12:15]
    v_mfma_f32_16x16x32_bf16 v[4:7], v[88:91], v[136:139], v[4:7]
    ds_read_b64_tr_b16 v[104:105], v166 offset:6144
    v_mfma_f32_16x16x32_bf16 v[16:19], v[76:79], v[140:143], v[16:19]
    ds_read_b128 v[148:151], v164 offset:5632
    v_mfma_f32_16x16x32_bf16 v[20:23], v[80:83], v[140:143], v[20:23]
    s_waitcnt lgkmcnt(3)
    v_mfma_f32_16x16x32_bf16 v[8:11], v[84:87], v[140:143], v[8:11]
    v_mfma_f32_16x16x32_bf16 v[12:15], v[88:91], v[140:143], v[12:15]
    v_mfma_f32_16x16x32_bf16 v[4:7], v[96:99], v[140:143], v[4:7]
    v_mfma_f32_16x16x32_bf16 v[24:27], v[76:79], v[144:147], v[24:27]
    ds_read_b64_tr_b16 v[102:103], v165 offset:7168
    v_mfma_f32_16x16x32_bf16 v[28:31], v[80:83], v[144:147], v[28:31]
    ds_read_b64_tr_b16 v[100:101], v165 offset:6144
    v_mfma_f32_16x16x32_bf16 v[16:19], v[84:87], v[144:147], v[16:19]
    v_mfma_f32_16x16x32_bf16 v[20:23], v[88:91], v[144:147], v[20:23]
    ds_read_b128 v[152:155], v164 offset:7040
    s_waitcnt lgkmcnt(3)
    v_mfma_f32_16x16x32_bf16 v[8:11], v[92:95], v[144:147], v[8:11]
    v_mfma_f32_16x16x32_bf16 v[12:15], v[96:99], v[144:147], v[12:15]
    v_mfma_f32_16x16x32_bf16 v[4:7], v[104:107], v[144:147], v[4:7]
    v_mfma_f32_16x16x32_bf16 v[32:35], v[76:79], v[148:151], v[32:35]
    v_mfma_f32_16x16x32_bf16 v[36:39], v[80:83], v[148:151], v[36:39]
    v_mfma_f32_16x16x32_bf16 v[24:27], v[84:87], v[148:151], v[24:27]
    v_mfma_f32_16x16x32_bf16 v[28:31], v[88:91], v[148:151], v[28:31]
    v_mfma_f32_16x16x32_bf16 v[16:19], v[92:95], v[148:151], v[16:19]
    ds_read_b128 v[156:159], v164 offset:8448
    v_mfma_f32_16x16x32_bf16 v[20:23], v[96:99], v[148:151], v[20:23]
    s_waitcnt lgkmcnt(1)
    v_mfma_f32_16x16x32_bf16 v[8:11], v[100:103], v[148:151], v[8:11]
    v_mfma_f32_16x16x32_bf16 v[12:15], v[104:107], v[148:151], v[12:15]
    v_mfma_f32_16x16x32_bf16 v[40:43], v[76:79], v[152:155], v[40:43]
    v_mfma_f32_16x16x32_bf16 v[44:47], v[80:83], v[152:155], v[44:47]
    v_mfma_f32_16x16x32_bf16 v[32:35], v[84:87], v[152:155], v[32:35]
    v_mfma_f32_16x16x32_bf16 v[36:39], v[88:91], v[152:155], v[36:39]
    v_mfma_f32_16x16x32_bf16 v[24:27], v[92:95], v[152:155], v[24:27]
    ds_read_b128 v[160:163], v164 offset:9856
    v_mfma_f32_16x16x32_bf16 v[28:31], v[96:99], v[152:155], v[28:31]
    v_mfma_f32_16x16x32_bf16 v[16:19], v[100:103], v[152:155], v[16:19]
    v_mfma_f32_16x16x32_bf16 v[20:23], v[104:107], v[152:155], v[20:23]
    ds_read_b128 v[136:139], v164 offset:12672
    s_waitcnt lgkmcnt(2)
    v_mfma_f32_16x16x32_bf16 v[48:51], v[76:79], v[156:159], v[48:51]
    ds_read_b64_tr_b16 v[130:131], v166 offset:13312
    v_mfma_f32_16x16x32_bf16 v[52:55], v[80:83], v[156:159], v[52:55]
    ds_read_b64_tr_b16 v[128:129], v166 offset:12288
    v_mfma_f32_16x16x32_bf16 v[40:43], v[84:87], v[156:159], v[40:43]
    ds_read_b64_tr_b16 v[126:127], v165 offset:13312
    v_mfma_f32_16x16x32_bf16 v[44:47], v[88:91], v[156:159], v[44:47]
    ds_read_b64_tr_b16 v[124:125], v165 offset:12288
    v_mfma_f32_16x16x32_bf16 v[32:35], v[92:95], v[156:159], v[32:35]
    ds_read_b128 v[132:135], v164 offset:11264
    v_mfma_f32_16x16x32_bf16 v[36:39], v[96:99], v[156:159], v[36:39]
    ds_read_b64_tr_b16 v[122:123], v166 offset:11264
    v_mfma_f32_16x16x32_bf16 v[24:27], v[100:103], v[156:159], v[24:27]
    ds_read_b64_tr_b16 v[120:121], v166 offset:10240
    v_mfma_f32_16x16x32_bf16 v[28:31], v[104:107], v[156:159], v[28:31]
    ds_read_b64_tr_b16 v[118:119], v165 offset:11264
    s_waitcnt lgkmcnt(8)
    v_mfma_f32_16x16x32_bf16 v[56:59], v[76:79], v[160:163], v[56:59]
    ds_read_b64_tr_b16 v[116:117], v165 offset:10240
    v_mfma_f32_16x16x32_bf16 v[60:63], v[80:83], v[160:163], v[60:63]
    ds_read_b64_tr_b16 v[114:115], v166 offset:9216
    v_mfma_f32_16x16x32_bf16 v[48:51], v[84:87], v[160:163], v[48:51]
    ds_read_b64_tr_b16 v[112:113], v166 offset:8192
    v_mfma_f32_16x16x32_bf16 v[52:55], v[88:91], v[160:163], v[52:55]
    ds_read_b64_tr_b16 v[110:111], v165 offset:9216
    v_mfma_f32_16x16x32_bf16 v[40:43], v[92:95], v[160:163], v[40:43]
    ds_read_b64_tr_b16 v[108:109], v165 offset:8192
    v_mfma_f32_16x16x32_bf16 v[44:47], v[96:99], v[160:163], v[44:47]
    v_mfma_f32_16x16x32_bf16 v[32:35], v[100:103], v[160:163], v[32:35]
    v_mfma_f32_16x16x32_bf16 v[36:39], v[104:107], v[160:163], v[36:39]
    s_waitcnt lgkmcnt(5)
    v_mfma_f32_16x16x32_bf16 v[64:67], v[76:79], v[132:135], v[64:67]
    v_mfma_f32_16x16x32_bf16 v[68:71], v[80:83], v[132:135], v[68:71]
    v_mfma_f32_16x16x32_bf16 v[56:59], v[84:87], v[132:135], v[56:59]
    v_mfma_f32_16x16x32_bf16 v[60:63], v[88:91], v[132:135], v[60:63]
    ds_read_b128 v[140:143], v164 offset:14080
    v_mfma_f32_16x16x32_bf16 v[48:51], v[92:95], v[132:135], v[48:51]
    v_mfma_f32_16x16x32_bf16 v[52:55], v[96:99], v[132:135], v[52:55]
    v_mfma_f32_16x16x32_bf16 v[40:43], v[100:103], v[132:135], v[40:43]
    v_mfma_f32_16x16x32_bf16 v[44:47], v[104:107], v[132:135], v[44:47]
    v_mfma_f32_16x16x32_bf16 v[72:75], v[76:79], v[136:139], v[72:75]
    ds_read_b128 v[144:147], v164 offset:15488
    v_mfma_f32_16x16x32_bf16 v[64:67], v[84:87], v[136:139], v[64:67]
    v_mfma_f32_16x16x32_bf16 v[68:71], v[88:91], v[136:139], v[68:71]
    v_mfma_f32_16x16x32_bf16 v[56:59], v[92:95], v[136:139], v[56:59]
    s_waitcnt lgkmcnt(2)
    s_barrier
    v_mfma_f32_16x16x32_bf16 v[60:63], v[96:99], v[136:139], v[60:63]
    v_mfma_f32_16x16x32_bf16 v[48:51], v[100:103], v[136:139], v[48:51]
    v_mfma_f32_16x16x32_bf16 v[52:55], v[104:107], v[136:139], v[52:55]
    s_waitcnt lgkmcnt(1)
    v_mfma_f32_16x16x32_bf16 v[72:75], v[84:87], v[140:143], v[72:75]
    v_mfma_f32_16x16x32_bf16 v[64:67], v[92:95], v[140:143], v[64:67]
    v_mfma_f32_16x16x32_bf16 v[68:71], v[96:99], v[140:143], v[68:71]
    v_mfma_f32_16x16x32_bf16 v[56:59], v[100:103], v[140:143], v[56:59]
    v_mfma_f32_16x16x32_bf16 v[60:63], v[104:107], v[140:143], v[60:63]
    s_waitcnt lgkmcnt(0)
    v_mfma_f32_16x16x32_bf16 v[72:75], v[92:95], v[144:147], v[72:75]
    ds_read_b128 v[140:143], v164 offset:16896
    v_mfma_f32_16x16x32_bf16 v[64:67], v[100:103], v[144:147], v[64:67]
    v_mfma_f32_16x16x32_bf16 v[68:71], v[104:107], v[144:147], v[68:71]
    s_waitcnt lgkmcnt(0)
    v_mfma_f32_16x16x32_bf16 v[72:75], v[100:103], v[140:143], v[72:75]
    v_mfma_f32_16x16x32_bf16 v[0:3], v[108:111], v[148:151], v[0:3]
    v_mfma_f32_16x16x32_bf16 v[4:7], v[112:115], v[148:151], v[4:7]
    v_mfma_f32_16x16x32_bf16 v[0:3], v[116:119], v[152:155], v[0:3]
    v_mfma_f32_16x16x32_bf16 v[4:7], v[120:123], v[152:155], v[4:7]
    v_mfma_f32_16x16x32_bf16 v[0:3], v[124:127], v[156:159], v[0:3]
    v_mfma_f32_16x16x32_bf16 v[4:7], v[128:131], v[156:159], v[4:7]
    v_mfma_f32_16x16x32_bf16 v[8:11], v[108:111], v[152:155], v[8:11]
    v_mfma_f32_16x16x32_bf16 v[12:15], v[112:115], v[152:155], v[12:15]
    v_mfma_f32_16x16x32_bf16 v[8:11], v[116:119], v[156:159], v[8:11]
    v_mfma_f32_16x16x32_bf16 v[12:15], v[120:123], v[156:159], v[12:15]
    s_nop 2
    ds_write_b128 v184, v[0:3] offset:0
    v_mfma_f32_16x16x32_bf16 v[8:11], v[124:127], v[160:163], v[8:11]
    s_nop 0
    v_cvt_pk_bf16_f32 v4, v4, v5
    v_cvt_pk_bf16_f32 v5, v6, v7
    v_mfma_f32_16x16x32_bf16 v[12:15], v[128:131], v[160:163], v[12:15]
    s_mov_b32 s45, 0
    buffer_store_dwordx2 v[4:5], v180, s[20:23], s45 offen offset:32
    v_mfma_f32_16x16x32_bf16 v[16:19], v[108:111], v[156:159], v[16:19]
    v_mfma_f32_16x16x32_bf16 v[20:23], v[112:115], v[156:159], v[20:23]
    v_mfma_f32_16x16x32_bf16 v[16:19], v[116:119], v[160:163], v[16:19]
    v_mfma_f32_16x16x32_bf16 v[20:23], v[120:123], v[160:163], v[20:23]
    v_mfma_f32_16x16x32_bf16 v[16:19], v[124:127], v[132:135], v[16:19]
    ds_read_b128 v[148:151], v164 offset:14080
    v_cvt_pk_bf16_f32 v8, v8, v9
    v_cvt_pk_bf16_f32 v9, v10, v11
    v_mfma_f32_16x16x32_bf16 v[20:23], v[128:131], v[132:135], v[20:23]
    ds_write_b64 v181, v[8:9] offset:1280
    v_cvt_pk_bf16_f32 v12, v12, v13
    v_mfma_f32_16x16x32_bf16 v[24:27], v[108:111], v[160:163], v[24:27]
    v_cvt_pk_bf16_f32 v13, v14, v15
    ds_write_b64 v181, v[12:13] offset:1312
    v_mfma_f32_16x16x32_bf16 v[28:31], v[112:115], v[160:163], v[28:31]
    ds_read_b128 v[188:191], v182 offset:1280
    v_mfma_f32_16x16x32_bf16 v[24:27], v[116:119], v[132:135], v[24:27]
    v_mfma_f32_16x16x32_bf16 v[28:31], v[120:123], v[132:135], v[28:31]
    v_mfma_f32_16x16x32_bf16 v[24:27], v[124:127], v[136:139], v[24:27]
    v_cvt_pk_bf16_f32 v16, v16, v17
    v_cvt_pk_bf16_f32 v17, v18, v19
    v_mfma_f32_16x16x32_bf16 v[28:31], v[128:131], v[136:139], v[28:31]
    ds_write_b64 v181, v[16:17] offset:2560
    v_cvt_pk_bf16_f32 v20, v20, v21
    s_waitcnt lgkmcnt(0)
    s_barrier
    v_mfma_f32_16x16x32_bf16 v[32:35], v[108:111], v[132:135], v[32:35]
    v_cvt_pk_bf16_f32 v21, v22, v23
    ds_write_b64 v181, v[20:21] offset:2592
    v_mfma_f32_16x16x32_bf16 v[36:39], v[112:115], v[132:135], v[36:39]
    ds_read_b128 v[192:195], v182 offset:2560
    s_mov_b32 s57, 86016
    v_mfma_f32_16x16x32_bf16 v[32:35], v[116:119], v[136:139], v[32:35]
    buffer_store_dwordx4 v[188:191], v183, s[20:23], s57 offen
    v_mfma_f32_16x16x32_bf16 v[36:39], v[120:123], v[136:139], v[36:39]
    v_mfma_f32_16x16x32_bf16 v[32:35], v[124:127], v[148:151], v[32:35]
    v_cvt_pk_bf16_f32 v24, v24, v25
    v_cvt_pk_bf16_f32 v25, v26, v27
    v_mfma_f32_16x16x32_bf16 v[36:39], v[128:131], v[148:151], v[36:39]
    ds_write_b64 v181, v[24:25] offset:3840
    v_cvt_pk_bf16_f32 v28, v28, v29
    v_mfma_f32_16x16x32_bf16 v[40:43], v[108:111], v[136:139], v[40:43]
    v_cvt_pk_bf16_f32 v29, v30, v31
    ds_write_b64 v181, v[28:29] offset:3872
    v_mfma_f32_16x16x32_bf16 v[44:47], v[112:115], v[136:139], v[44:47]
    ds_read_b128 v[196:199], v182 offset:3840
    s_mov_b32 s57, 172032
    v_mfma_f32_16x16x32_bf16 v[40:43], v[116:119], v[148:151], v[40:43]
    s_waitcnt lgkmcnt(3)
    buffer_store_dwordx4 v[192:195], v183, s[20:23], s57 offen
    v_mfma_f32_16x16x32_bf16 v[44:47], v[120:123], v[148:151], v[44:47]
    v_mfma_f32_16x16x32_bf16 v[40:43], v[124:127], v[144:147], v[40:43]
    ds_read_b128 v[152:155], v164 offset:18304
    v_cvt_pk_bf16_f32 v32, v32, v33
    v_cvt_pk_bf16_f32 v33, v34, v35
    v_mfma_f32_16x16x32_bf16 v[44:47], v[128:131], v[144:147], v[44:47]
    ds_write_b64 v181, v[32:33] offset:5120
    v_cvt_pk_bf16_f32 v36, v36, v37
    v_mfma_f32_16x16x32_bf16 v[48:51], v[108:111], v[148:151], v[48:51]
    v_cvt_pk_bf16_f32 v37, v38, v39
    ds_write_b64 v181, v[36:37] offset:5152
    v_mfma_f32_16x16x32_bf16 v[52:55], v[112:115], v[148:151], v[52:55]
    ds_read_b128 v[200:203], v182 offset:5120
    s_mov_b32 s57, 258048
    v_mfma_f32_16x16x32_bf16 v[48:51], v[116:119], v[144:147], v[48:51]
    s_waitcnt lgkmcnt(4)
    buffer_store_dwordx4 v[196:199], v183, s[20:23], s57 offen
    v_mfma_f32_16x16x32_bf16 v[52:55], v[120:123], v[144:147], v[52:55]
    v_mfma_f32_16x16x32_bf16 v[48:51], v[124:127], v[140:143], v[48:51]
    ds_read_b128 v[156:159], v164 offset:19712
    v_cvt_pk_bf16_f32 v40, v40, v41
    v_cvt_pk_bf16_f32 v41, v42, v43
    v_mfma_f32_16x16x32_bf16 v[52:55], v[128:131], v[140:143], v[52:55]
    ds_write_b64 v181, v[40:41] offset:0
    v_cvt_pk_bf16_f32 v44, v44, v45
    v_mfma_f32_16x16x32_bf16 v[56:59], v[108:111], v[144:147], v[56:59]
    v_cvt_pk_bf16_f32 v45, v46, v47
    ds_write_b64 v181, v[44:45] offset:32
    v_mfma_f32_16x16x32_bf16 v[60:63], v[112:115], v[144:147], v[60:63]
    ds_read_b128 v[188:191], v182 offset:0
    s_mov_b32 s57, 344064
    v_mfma_f32_16x16x32_bf16 v[56:59], v[116:119], v[140:143], v[56:59]
    ds_read_b128 v[160:163], v164 offset:21120
    s_waitcnt lgkmcnt(5)
    buffer_store_dwordx4 v[200:203], v183, s[20:23], s57 offen
    v_mfma_f32_16x16x32_bf16 v[60:63], v[120:123], v[140:143], v[60:63]
    v_mfma_f32_16x16x32_bf16 v[56:59], v[124:127], v[152:155], v[56:59]
    v_cvt_pk_bf16_f32 v48, v48, v49
    v_cvt_pk_bf16_f32 v49, v50, v51
    v_mfma_f32_16x16x32_bf16 v[60:63], v[128:131], v[152:155], v[60:63]
    ds_write_b64 v181, v[48:49] offset:1280
    v_cvt_pk_bf16_f32 v52, v52, v53
    v_mfma_f32_16x16x32_bf16 v[64:67], v[108:111], v[140:143], v[64:67]
    v_cvt_pk_bf16_f32 v53, v54, v55
    ds_write_b64 v181, v[52:53] offset:1312
    v_mfma_f32_16x16x32_bf16 v[68:71], v[112:115], v[140:143], v[68:71]
    ds_read_b128 v[192:195], v182 offset:1280
    s_mov_b32 s57, 430080
    v_mfma_f32_16x16x32_bf16 v[64:67], v[116:119], v[152:155], v[64:67]
    s_waitcnt lgkmcnt(4)
    buffer_store_dwordx4 v[188:191], v183, s[20:23], s57 offen
    v_mfma_f32_16x16x32_bf16 v[68:71], v[120:123], v[152:155], v[68:71]
    v_mfma_f32_16x16x32_bf16 v[64:67], v[124:127], v[156:159], v[64:67]
    v_cvt_pk_bf16_f32 v56, v56, v57
    v_cvt_pk_bf16_f32 v57, v58, v59
    v_mfma_f32_16x16x32_bf16 v[68:71], v[128:131], v[156:159], v[68:71]
    ds_write_b64 v181, v[56:57] offset:2560
    v_cvt_pk_bf16_f32 v60, v60, v61
    v_mfma_f32_16x16x32_bf16 v[72:75], v[108:111], v[152:155], v[72:75]
    v_cvt_pk_bf16_f32 v61, v62, v63
    ds_write_b64 v181, v[60:61] offset:2592
    v_mfma_f32_16x16x32_bf16 v[72:75], v[116:119], v[156:159], v[72:75]
    ds_read_b128 v[196:199], v182 offset:2560
    s_mov_b32 s57, 516096
    s_waitcnt lgkmcnt(5)
    v_mfma_f32_16x16x32_bf16 v[72:75], v[124:127], v[160:163], v[72:75]
    s_waitcnt lgkmcnt(3)
    buffer_store_dwordx4 v[192:195], v183, s[20:23], s57 offen
    v_cvt_pk_bf16_f32 v64, v64, v65
    v_cvt_pk_bf16_f32 v65, v66, v67
    ds_write_b64 v181, v[64:65] offset:3840
    v_cvt_pk_bf16_f32 v68, v68, v69
    v_cvt_pk_bf16_f32 v69, v70, v71
    ds_write_b64 v181, v[68:69] offset:3872
    ds_read_b128 v[200:203], v182 offset:3840
    s_mov_b32 s57, 602112
    s_waitcnt lgkmcnt(3)
    buffer_store_dwordx4 v[196:199], v183, s[20:23], s57 offen
    v_cvt_pk_bf16_f32 v72, v72, v73
    v_cvt_pk_bf16_f32 v73, v74, v75
    s_mov_b32 s45, 774144
    buffer_store_dwordx2 v[72:73], v180, s[20:23], s45 offen offset:0
    s_mov_b32 s57, 688128
    s_waitcnt lgkmcnt(0)
    buffer_store_dwordx4 v[200:203], v183, s[20:23], s57 offen
    s_endpgm
.p2align 6
C_Q2:
    s_barrier
    ds_read_b64_tr_b16 v[80:81], v166 offset:0
    ds_read_b64_tr_b16 v[82:83], v166 offset:1024
    ds_read_b128 v[132:135], v164 offset:0
    ds_read_b64_tr_b16 v[76:77], v165 offset:0
    ds_read_b64_tr_b16 v[78:79], v165 offset:1024
    ds_read_b128 v[136:139], v164 offset:1408
    ds_read_b64_tr_b16 v[88:89], v166 offset:2048
    ds_read_b64_tr_b16 v[90:91], v166 offset:3072
    s_waitcnt lgkmcnt(5)
    v_mfma_f32_16x16x32_bf16 v[0:3], v[80:83], v[132:135], 0
    ds_read_b64_tr_b16 v[84:85], v165 offset:2048
    ds_read_b64_tr_b16 v[86:87], v165 offset:3072
    s_waitcnt lgkmcnt(4)
    v_mfma_f32_16x16x32_bf16 v[4:7], v[76:79], v[136:139], 0
    s_barrier
    ds_read_b128 v[140:143], v164 offset:2816
    v_mfma_f32_16x16x32_bf16 v[8:11], v[80:83], v[136:139], 0
    ds_read_b64_tr_b16 v[96:97], v166 offset:4096
    ds_read_b64_tr_b16 v[98:99], v166 offset:5120
    s_waitcnt lgkmcnt(5)
    v_mfma_f32_16x16x32_bf16 v[0:3], v[88:91], v[136:139], v[0:3]
    ds_read_b128 v[144:147], v164 offset:4224
    ds_read_b64_tr_b16 v[92:93], v165 offset:4096
    s_waitcnt lgkmcnt(4)
    v_mfma_f32_16x16x32_bf16 v[12:15], v[76:79], v[140:143], 0
    ds_read_b64_tr_b16 v[94:95], v165 offset:5120
    ds_read_b64_tr_b16 v[104:105], v166 offset:6144
    v_mfma_f32_16x16x32_bf16 v[16:19], v[80:83], v[140:143], 0
    ds_read_b64_tr_b16 v[106:107], v166 offset:7168
    ds_read_b64_tr_b16 v[100:101], v165 offset:6144
    v_mfma_f32_16x16x32_bf16 v[4:7], v[84:87], v[140:143], v[4:7]
    ds_read_b64_tr_b16 v[102:103], v165 offset:7168
    v_mfma_f32_16x16x32_bf16 v[8:11], v[88:91], v[140:143], v[8:11]
    s_waitcnt lgkmcnt(7)
    v_mfma_f32_16x16x32_bf16 v[0:3], v[96:99], v[140:143], v[0:3]
    s_waitcnt lgkmcnt(6)
    v_mfma_f32_16x16x32_bf16 v[20:23], v[76:79], v[144:147], 0
    v_mfma_f32_16x16x32_bf16 v[24:27], v[80:83], v[144:147], 0
    v_mfma_f32_16x16x32_bf16 v[12:15], v[84:87], v[144:147], v[12:15]
    s_barrier
    ds_read_b128 v[148:151], v164 offset:5632
    v_mfma_f32_16x16x32_bf16 v[16:19], v[88:91], v[144:147], v[16:19]
    ds_read_b64_tr_b16 v[112:113], v166 offset:8192
    ds_read_b64_tr_b16 v[114:115], v166 offset:9216
    s_waitcnt lgkmcnt(6)
    v_mfma_f32_16x16x32_bf16 v[4:7], v[92:95], v[144:147], v[4:7]
    ds_read_b128 v[152:155], v164 offset:7040
    ds_read_b64_tr_b16 v[108:109], v165 offset:8192
    v_mfma_f32_16x16x32_bf16 v[8:11], v[96:99], v[144:147], v[8:11]
    ds_read_b64_tr_b16 v[110:111], v165 offset:9216
    ds_read_b64_tr_b16 v[120:121], v166 offset:10240
    s_waitcnt lgkmcnt(7)
    v_mfma_f32_16x16x32_bf16 v[0:3], v[104:107], v[144:147], v[0:3]
    ds_read_b64_tr_b16 v[122:123], v166 offset:11264
    ds_read_b64_tr_b16 v[116:117], v165 offset:10240
    s_waitcnt lgkmcnt(8)
    v_mfma_f32_16x16x32_bf16 v[28:31], v[76:79], v[148:151], 0
    ds_read_b64_tr_b16 v[118:119], v165 offset:11264
    v_mfma_f32_16x16x32_bf16 v[32:35], v[80:83], v[148:151], 0
    v_mfma_f32_16x16x32_bf16 v[20:23], v[84:87], v[148:151], v[20:23]
    v_mfma_f32_16x16x32_bf16 v[24:27], v[88:91], v[148:151], v[24:27]
    v_mfma_f32_16x16x32_bf16 v[12:15], v[92:95], v[148:151], v[12:15]
    v_mfma_f32_16x16x32_bf16 v[16:19], v[96:99], v[148:151], v[16:19]
    v_mfma_f32_16x16x32_bf16 v[4:7], v[100:103], v[148:151], v[4:7]
    v_mfma_f32_16x16x32_bf16 v[8:11], v[104:107], v[148:151], v[8:11]
    s_waitcnt lgkmcnt(1)
    v_mfma_f32_16x16x32_bf16 v[0:3], v[112:115], v[148:151], v[0:3]
    v_mfma_f32_16x16x32_bf16 v[36:39], v[76:79], v[152:155], 0
    v_mfma_f32_16x16x32_bf16 v[40:43], v[80:83], v[152:155], 0
    v_mfma_f32_16x16x32_bf16 v[28:31], v[84:87], v[152:155], v[28:31]
    v_mfma_f32_16x16x32_bf16 v[32:35], v[88:91], v[152:155], v[32:35]
    v_mfma_f32_16x16x32_bf16 v[20:23], v[92:95], v[152:155], v[20:23]
    v_mfma_f32_16x16x32_bf16 v[24:27], v[96:99], v[152:155], v[24:27]
    v_mfma_f32_16x16x32_bf16 v[12:15], v[100:103], v[152:155], v[12:15]
    s_barrier
    ds_read_b128 v[156:159], v164 offset:8448
    v_mfma_f32_16x16x32_bf16 v[16:19], v[104:107], v[152:155], v[16:19]
    ds_read_b64_tr_b16 v[128:129], v166 offset:12288
    ds_read_b64_tr_b16 v[130:131], v166 offset:13312
    v_mfma_f32_16x16x32_bf16 v[4:7], v[108:111], v[152:155], v[4:7]
    ds_read_b128 v[160:163], v164 offset:9856
    ds_read_b64_tr_b16 v[124:125], v165 offset:12288
    v_mfma_f32_16x16x32_bf16 v[8:11], v[112:115], v[152:155], v[8:11]
    ds_read_b64_tr_b16 v[126:127], v165 offset:13312
    v_mfma_f32_16x16x32_bf16 v[0:3], v[120:123], v[152:155], v[0:3]
    s_waitcnt lgkmcnt(5)
    v_mfma_f32_16x16x32_bf16 v[44:47], v[76:79], v[156:159], 0
    v_mfma_f32_16x16x32_bf16 v[48:51], v[80:83], v[156:159], 0
    ds_read_b128 v[136:139], v164 offset:12672
    v_mfma_f32_16x16x32_bf16 v[36:39], v[84:87], v[156:159], v[36:39]
    v_mfma_f32_16x16x32_bf16 v[40:43], v[88:91], v[156:159], v[40:43]
    v_mfma_f32_16x16x32_bf16 v[28:31], v[92:95], v[156:159], v[28:31]
    v_mfma_f32_16x16x32_bf16 v[32:35], v[96:99], v[156:159], v[32:35]
    v_mfma_f32_16x16x32_bf16 v[20:23], v[100:103], v[156:159], v[20:23]
    v_mfma_f32_16x16x32_bf16 v[24:27], v[104:107], v[156:159], v[24:27]
    v_mfma_f32_16x16x32_bf16 v[12:15], v[108:111], v[156:159], v[12:15]
    v_mfma_f32_16x16x32_bf16 v[16:19], v[112:115], v[156:159], v[16:19]
    v_mfma_f32_16x16x32_bf16 v[4:7], v[116:119], v[156:159], v[4:7]
    v_mfma_f32_16x16x32_bf16 v[8:11], v[120:123], v[156:159], v[8:11]
    s_waitcnt lgkmcnt(0)
    v_mfma_f32_16x16x32_bf16 v[0:3], v[128:131], v[156:159], v[0:3]
    v_mfma_f32_16x16x32_bf16 v[52:55], v[76:79], v[160:163], 0
    v_mfma_f32_16x16x32_bf16 v[56:59], v[80:83], v[160:163], 0
    v_mfma_f32_16x16x32_bf16 v[44:47], v[84:87], v[160:163], v[44:47]
    ds_read_b128 v[140:143], v164 offset:14080
    v_mfma_f32_16x16x32_bf16 v[48:51], v[88:91], v[160:163], v[48:51]
    v_mfma_f32_16x16x32_bf16 v[36:39], v[92:95], v[160:163], v[36:39]
    v_mfma_f32_16x16x32_bf16 v[40:43], v[96:99], v[160:163], v[40:43]
    v_mfma_f32_16x16x32_bf16 v[28:31], v[100:103], v[160:163], v[28:31]
    v_mfma_f32_16x16x32_bf16 v[32:35], v[104:107], v[160:163], v[32:35]
    v_mfma_f32_16x16x32_bf16 v[20:23], v[108:111], v[160:163], v[20:23]
    s_barrier
    ds_read_b128 v[132:135], v164 offset:11264
    v_mfma_f32_16x16x32_bf16 v[24:27], v[112:115], v[160:163], v[24:27]
    v_mfma_f32_16x16x32_bf16 v[12:15], v[116:119], v[160:163], v[12:15]
    v_mfma_f32_16x16x32_bf16 v[16:19], v[120:123], v[160:163], v[16:19]
    v_mfma_f32_16x16x32_bf16 v[4:7], v[124:127], v[160:163], v[4:7]
    v_mfma_f32_16x16x32_bf16 v[8:11], v[128:131], v[160:163], v[8:11]
    s_add_u32 s48, s48, 1
    s_waitcnt lgkmcnt(0)
    v_mfma_f32_16x16x32_bf16 v[60:63], v[76:79], v[132:135], 0
    ds_read_b128 v[144:147], v164 offset:15488
    v_mfma_f32_16x16x32_bf16 v[64:67], v[80:83], v[132:135], 0
    s_cmp_eq_u32 s48, 7
    v_mfma_f32_16x16x32_bf16 v[52:55], v[84:87], v[132:135], v[52:55]
    s_cselect_b32 s44, s51, 0
    v_mfma_f32_16x16x32_bf16 v[56:59], v[88:91], v[132:135], v[56:59]
    s_cselect_b32 s48, 0, s48
    v_mfma_f32_16x16x32_bf16 v[44:47], v[92:95], v[132:135], v[44:47]
    s_xor_b32 s50, s50, s44
    v_mfma_f32_16x16x32_bf16 v[48:51], v[96:99], v[132:135], v[48:51]
    v_add_u32 v172, s48, v167
    v_mfma_f32_16x16x32_bf16 v[36:39], v[100:103], v[132:135], v[36:39]
    v_and_b32 v173, 4, v172
    v_mfma_f32_16x16x32_bf16 v[40:43], v[104:107], v[132:135], v[40:43]
    v_lshlrev_b32 v173, 3, v173
    v_mfma_f32_16x16x32_bf16 v[28:31], v[108:111], v[132:135], v[28:31]
    v_xor_b32 v173, v173, v168
    v_mfma_f32_16x16x32_bf16 v[32:35], v[112:115], v[132:135], v[32:35]
    v_lshl_add_u32 v173, v172, 6, v173
    v_mfma_f32_16x16x32_bf16 v[20:23], v[116:119], v[132:135], v[20:23]
    ds_read_b128 v[148:151], v164 offset:16896
    v_mfma_f32_16x16x32_bf16 v[24:27], v[120:123], v[132:135], v[24:27]
    v_add_u32 v170, s50, v173
    v_mfma_f32_16x16x32_bf16 v[12:15], v[124:127], v[132:135], v[12:15]
    v_mfma_f32_16x16x32_bf16 v[16:19], v[128:131], v[132:135], v[16:19]
    v_mfma_f32_16x16x32_bf16 v[68:71], v[76:79], v[136:139], 0
    v_mfma_f32_16x16x32_bf16 v[72:75], v[80:83], v[136:139], 0
    v_mfma_f32_16x16x32_bf16 v[60:63], v[84:87], v[136:139], v[60:63]
    v_mfma_f32_16x16x32_bf16 v[64:67], v[88:91], v[136:139], v[64:67]
    v_mfma_f32_16x16x32_bf16 v[52:55], v[92:95], v[136:139], v[52:55]
    ds_read_b128 v[152:155], v164 offset:18304
    v_mfma_f32_16x16x32_bf16 v[56:59], v[96:99], v[136:139], v[56:59]
    v_mfma_f32_16x16x32_bf16 v[44:47], v[100:103], v[136:139], v[44:47]
    s_barrier
    v_mfma_f32_16x16x32_bf16 v[48:51], v[104:107], v[136:139], v[48:51]
    s_xor_b32 s52, s52, s53
    v_mfma_f32_16x16x32_bf16 v[36:39], v[108:111], v[136:139], v[36:39]
    v_add_u32 v165, s52, v169
    v_mfma_f32_16x16x32_bf16 v[40:43], v[112:115], v[136:139], v[40:43]
    ds_read_b128 v[156:159], v164 offset:19712
    v_mfma_f32_16x16x32_bf16 v[28:31], v[116:119], v[136:139], v[28:31]
    v_xor_b32 v166, 32, v165
    v_mfma_f32_16x16x32_bf16 v[32:35], v[120:123], v[136:139], v[32:35]
    v_mfma_f32_16x16x32_bf16 v[20:23], v[124:127], v[136:139], v[20:23]
    ds_read_b128 v[160:163], v164 offset:21120
    v_mfma_f32_16x16x32_bf16 v[24:27], v[128:131], v[136:139], v[24:27]
    v_mfma_f32_16x16x32_bf16 v[68:71], v[84:87], v[140:143], v[68:71]
    v_mfma_f32_16x16x32_bf16 v[72:75], v[88:91], v[140:143], v[72:75]
    v_mfma_f32_16x16x32_bf16 v[60:63], v[92:95], v[140:143], v[60:63]
    v_mfma_f32_16x16x32_bf16 v[64:67], v[96:99], v[140:143], v[64:67]
    v_mfma_f32_16x16x32_bf16 v[52:55], v[100:103], v[140:143], v[52:55]
    v_mfma_f32_16x16x32_bf16 v[56:59], v[104:107], v[140:143], v[56:59]
    v_mfma_f32_16x16x32_bf16 v[44:47], v[108:111], v[140:143], v[44:47]
    v_mfma_f32_16x16x32_bf16 v[48:51], v[112:115], v[140:143], v[48:51]
    v_mfma_f32_16x16x32_bf16 v[36:39], v[116:119], v[140:143], v[36:39]
    v_mfma_f32_16x16x32_bf16 v[40:43], v[120:123], v[140:143], v[40:43]
    v_mov_b32 v164, v170
    v_mfma_f32_16x16x32_bf16 v[28:31], v[124:127], v[140:143], v[28:31]
    v_mfma_f32_16x16x32_bf16 v[32:35], v[128:131], v[140:143], v[32:35]
    s_waitcnt lgkmcnt(0)
    v_mfma_f32_16x16x32_bf16 v[68:71], v[92:95], v[144:147], v[68:71]
    v_mfma_f32_16x16x32_bf16 v[72:75], v[96:99], v[144:147], v[72:75]
    v_mfma_f32_16x16x32_bf16 v[60:63], v[100:103], v[144:147], v[60:63]
    s_barrier
    v_mfma_f32_16x16x32_bf16 v[64:67], v[104:107], v[144:147], v[64:67]
    v_mfma_f32_16x16x32_bf16 v[52:55], v[108:111], v[144:147], v[52:55]
    v_mfma_f32_16x16x32_bf16 v[56:59], v[112:115], v[144:147], v[56:59]
    v_mfma_f32_16x16x32_bf16 v[44:47], v[116:119], v[144:147], v[44:47]
    v_mfma_f32_16x16x32_bf16 v[48:51], v[120:123], v[144:147], v[48:51]
    ds_read_b64_tr_b16 v[94:95], v165 offset:5120
    v_mfma_f32_16x16x32_bf16 v[36:39], v[124:127], v[144:147], v[36:39]
    ds_read_b64_tr_b16 v[98:99], v166 offset:5120
    v_mfma_f32_16x16x32_bf16 v[40:43], v[128:131], v[144:147], v[40:43]
    ds_read_b128 v[140:143], v170 offset:2816
    v_mfma_f32_16x16x32_bf16 v[68:71], v[100:103], v[148:151], v[68:71]
    ds_read_b128 v[136:139], v170 offset:1408
    v_mfma_f32_16x16x32_bf16 v[72:75], v[104:107], v[148:151], v[72:75]
    ds_read_b64_tr_b16 v[78:79], v165 offset:1024
    v_mfma_f32_16x16x32_bf16 v[60:63], v[108:111], v[148:151], v[60:63]
    ds_read_b64_tr_b16 v[76:77], v165 offset:0
    v_mfma_f32_16x16x32_bf16 v[64:67], v[112:115], v[148:151], v[64:67]
    ds_read_b128 v[132:135], v170 offset:0
    v_mfma_f32_16x16x32_bf16 v[52:55], v[116:119], v[148:151], v[52:55]
    ds_read_b64_tr_b16 v[82:83], v166 offset:1024
    v_mfma_f32_16x16x32_bf16 v[56:59], v[120:123], v[148:151], v[56:59]
    ds_read_b64_tr_b16 v[80:81], v166 offset:0
    v_mfma_f32_16x16x32_bf16 v[44:47], v[124:127], v[148:151], v[44:47]
    v_mfma_f32_16x16x32_bf16 v[48:51], v[128:131], v[148:151], v[48:51]
    ds_read_b64_tr_b16 v[90:91], v166 offset:3072
    v_mfma_f32_16x16x32_bf16 v[68:71], v[108:111], v[152:155], v[68:71]
    ds_read_b64_tr_b16 v[88:89], v166 offset:2048
    v_mfma_f32_16x16x32_bf16 v[60:63], v[116:119], v[152:155], v[60:63]
    v_mfma_f32_16x16x32_bf16 v[64:67], v[120:123], v[152:155], v[64:67]
    ds_read_b64_tr_b16 v[86:87], v165 offset:3072
    v_mfma_f32_16x16x32_bf16 v[52:55], v[124:127], v[152:155], v[52:55]
    ds_read_b64_tr_b16 v[84:85], v165 offset:2048
    v_mfma_f32_16x16x32_bf16 v[56:59], v[128:131], v[152:155], v[56:59]
    v_mfma_f32_16x16x32_bf16 v[68:71], v[116:119], v[156:159], v[68:71]
    ds_read_b64_tr_b16 v[96:97], v166 offset:4096
    v_mfma_f32_16x16x32_bf16 v[60:63], v[124:127], v[156:159], v[60:63]
    ds_read_b128 v[144:147], v170 offset:4224
    v_mfma_f32_16x16x32_bf16 v[64:67], v[128:131], v[156:159], v[64:67]
    v_mfma_f32_16x16x32_bf16 v[68:71], v[124:127], v[160:163], v[68:71]
    s_waitcnt lgkmcnt(4)
    s_barrier
C_Q2_LOOP:
    v_mfma_f32_16x16x32_bf16 v[0:3], v[80:83], v[132:135], v[0:3]
    v_mfma_f32_16x16x32_bf16 v[4:7], v[76:79], v[136:139], v[4:7]
    ds_read_b64_tr_b16 v[92:93], v165 offset:4096
    v_mfma_f32_16x16x32_bf16 v[8:11], v[80:83], v[136:139], v[8:11]
    ds_read_b64_tr_b16 v[106:107], v166 offset:7168
    v_mfma_f32_16x16x32_bf16 v[0:3], v[88:91], v[136:139], v[0:3]
    ds_read_b64_tr_b16 v[104:105], v166 offset:6144
    v_mfma_f32_16x16x32_bf16 v[12:15], v[76:79], v[140:143], v[12:15]
    ds_read_b128 v[148:151], v164 offset:5632
    v_mfma_f32_16x16x32_bf16 v[16:19], v[80:83], v[140:143], v[16:19]
    s_waitcnt lgkmcnt(4)
    v_mfma_f32_16x16x32_bf16 v[4:7], v[84:87], v[140:143], v[4:7]
    v_mfma_f32_16x16x32_bf16 v[8:11], v[88:91], v[140:143], v[8:11]
    ds_read_b128 v[152:155], v164 offset:7040
    v_mfma_f32_16x16x32_bf16 v[0:3], v[96:99], v[140:143], v[0:3]
    ds_read_b64_tr_b16 v[114:115], v166 offset:9216
    v_mfma_f32_16x16x32_bf16 v[20:23], v[76:79], v[144:147], v[20:23]
    ds_read_b64_tr_b16 v[102:103], v165 offset:7168
    v_mfma_f32_16x16x32_bf16 v[24:27], v[80:83], v[144:147], v[24:27]
    ds_read_b64_tr_b16 v[100:101], v165 offset:6144
    v_mfma_f32_16x16x32_bf16 v[12:15], v[84:87], v[144:147], v[12:15]
    v_mfma_f32_16x16x32_bf16 v[16:19], v[88:91], v[144:147], v[16:19]
    ds_read_b64_tr_b16 v[112:113], v166 offset:8192
    s_waitcnt lgkmcnt(5)
    v_mfma_f32_16x16x32_bf16 v[4:7], v[92:95], v[144:147], v[4:7]
    v_mfma_f32_16x16x32_bf16 v[8:11], v[96:99], v[144:147], v[8:11]
    v_mfma_f32_16x16x32_bf16 v[0:3], v[104:107], v[144:147], v[0:3]
    v_mfma_f32_16x16x32_bf16 v[28:31], v[76:79], v[148:151], v[28:31]
    v_mfma_f32_16x16x32_bf16 v[32:35], v[80:83], v[148:151], v[32:35]
    v_mfma_f32_16x16x32_bf16 v[20:23], v[84:87], v[148:151], v[20:23]
    ds_read_b128 v[156:159], v164 offset:8448
    v_mfma_f32_16x16x32_bf16 v[24:27], v[88:91], v[148:151], v[24:27]
    ds_read_b64_tr_b16 v[122:123], v166 offset:11264
    v_mfma_f32_16x16x32_bf16 v[12:15], v[92:95], v[148:151], v[12:15]
    ds_read_b64_tr_b16 v[110:111], v165 offset:9216
    v_mfma_f32_16x16x32_bf16 v[16:19], v[96:99], v[148:151], v[16:19]
    ds_read_b64_tr_b16 v[108:109], v165 offset:8192
    s_waitcnt lgkmcnt(4)
    v_mfma_f32_16x16x32_bf16 v[4:7], v[100:103], v[148:151], v[4:7]
    v_mfma_f32_16x16x32_bf16 v[8:11], v[104:107], v[148:151], v[8:11]
    ds_read_b64_tr_b16 v[120:121], v166 offset:10240
    v_mfma_f32_16x16x32_bf16 v[0:3], v[112:115], v[148:151], v[0:3]
    v_mfma_f32_16x16x32_bf16 v[36:39], v[76:79], v[152:155], v[36:39]
    v_mfma_f32_16x16x32_bf16 v[40:43], v[80:83], v[152:155], v[40:43]
    v_mfma_f32_16x16x32_bf16 v[28:31], v[84:87], v[152:155], v[28:31]
    v_mfma_f32_16x16x32_bf16 v[32:35], v[88:91], v[152:155], v[32:35]
    v_mfma_f32_16x16x32_bf16 v[20:23], v[92:95], v[152:155], v[20:23]
    v_mfma_f32_16x16x32_bf16 v[24:27], v[96:99], v[152:155], v[24:27]
    v_mfma_f32_16x16x32_bf16 v[12:15], v[100:103], v[152:155], v[12:15]
    ds_read_b128 v[160:163], v164 offset:9856
    v_mfma_f32_16x16x32_bf16 v[16:19], v[104:107], v[152:155], v[16:19]
    ds_read_b64_tr_b16 v[130:131], v166 offset:13312
    s_waitcnt lgkmcnt(2)
    v_mfma_f32_16x16x32_bf16 v[4:7], v[108:111], v[152:155], v[4:7]
    ds_read_b64_tr_b16 v[118:119], v165 offset:11264
    v_mfma_f32_16x16x32_bf16 v[8:11], v[112:115], v[152:155], v[8:11]
    ds_read_b64_tr_b16 v[116:117], v165 offset:10240
    v_mfma_f32_16x16x32_bf16 v[0:3], v[120:123], v[152:155], v[0:3]
    v_mfma_f32_16x16x32_bf16 v[44:47], v[76:79], v[156:159], v[44:47]
    ds_read_b64_tr_b16 v[128:129], v166 offset:12288
    v_mfma_f32_16x16x32_bf16 v[48:51], v[80:83], v[156:159], v[48:51]
    v_mfma_f32_16x16x32_bf16 v[36:39], v[84:87], v[156:159], v[36:39]
    v_mfma_f32_16x16x32_bf16 v[40:43], v[88:91], v[156:159], v[40:43]
    v_mfma_f32_16x16x32_bf16 v[28:31], v[92:95], v[156:159], v[28:31]
    v_mfma_f32_16x16x32_bf16 v[32:35], v[96:99], v[156:159], v[32:35]
    v_mfma_f32_16x16x32_bf16 v[20:23], v[100:103], v[156:159], v[20:23]
    v_mfma_f32_16x16x32_bf16 v[24:27], v[104:107], v[156:159], v[24:27]
    v_mfma_f32_16x16x32_bf16 v[12:15], v[108:111], v[156:159], v[12:15]
    v_mfma_f32_16x16x32_bf16 v[16:19], v[112:115], v[156:159], v[16:19]
    s_waitcnt lgkmcnt(0)
    v_mfma_f32_16x16x32_bf16 v[4:7], v[116:119], v[156:159], v[4:7]
    v_mfma_f32_16x16x32_bf16 v[8:11], v[120:123], v[156:159], v[8:11]
    ds_read_b64_tr_b16 v[126:127], v165 offset:13312
    v_mfma_f32_16x16x32_bf16 v[0:3], v[128:131], v[156:159], v[0:3]
    ds_read_b64_tr_b16 v[124:125], v165 offset:12288
    v_mfma_f32_16x16x32_bf16 v[52:55], v[76:79], v[160:163], v[52:55]
    v_mfma_f32_16x16x32_bf16 v[56:59], v[80:83], v[160:163], v[56:59]
    v_mfma_f32_16x16x32_bf16 v[44:47], v[84:87], v[160:163], v[44:47]
    ds_read_b128 v[132:135], v164 offset:11264
    v_mfma_f32_16x16x32_bf16 v[48:51], v[88:91], v[160:163], v[48:51]
    v_mfma_f32_16x16x32_bf16 v[36:39], v[92:95], v[160:163], v[36:39]
    v_mfma_f32_16x16x32_bf16 v[40:43], v[96:99], v[160:163], v[40:43]
    v_mfma_f32_16x16x32_bf16 v[28:31], v[100:103], v[160:163], v[28:31]
    v_mfma_f32_16x16x32_bf16 v[32:35], v[104:107], v[160:163], v[32:35]
    v_mfma_f32_16x16x32_bf16 v[20:23], v[108:111], v[160:163], v[20:23]
    v_mfma_f32_16x16x32_bf16 v[24:27], v[112:115], v[160:163], v[24:27]
    v_mfma_f32_16x16x32_bf16 v[12:15], v[116:119], v[160:163], v[12:15]
    s_waitcnt lgkmcnt(1)
    s_barrier
    v_mfma_f32_16x16x32_bf16 v[16:19], v[120:123], v[160:163], v[16:19]
    s_xor_b32 s52, s52, s53
    v_mfma_f32_16x16x32_bf16 v[4:7], v[124:127], v[160:163], v[4:7]
    v_add_u32 v165, s52, v169
    v_mfma_f32_16x16x32_bf16 v[8:11], v[128:131], v[160:163], v[8:11]
    v_xor_b32 v166, 32, v165
    s_waitcnt lgkmcnt(0)
    v_mfma_f32_16x16x32_bf16 v[60:63], v[76:79], v[132:135], v[60:63]
    v_mfma_f32_16x16x32_bf16 v[64:67], v[80:83], v[132:135], v[64:67]
    s_add_u32 s48, s48, 1
    v_mfma_f32_16x16x32_bf16 v[52:55], v[84:87], v[132:135], v[52:55]
    ds_read_b128 v[136:139], v164 offset:12672
    v_mfma_f32_16x16x32_bf16 v[56:59], v[88:91], v[132:135], v[56:59]
    s_cmp_eq_u32 s48, 7
    v_mfma_f32_16x16x32_bf16 v[44:47], v[92:95], v[132:135], v[44:47]
    s_cselect_b32 s44, s51, 0
    v_mfma_f32_16x16x32_bf16 v[48:51], v[96:99], v[132:135], v[48:51]
    s_cselect_b32 s48, 0, s48
    v_mfma_f32_16x16x32_bf16 v[36:39], v[100:103], v[132:135], v[36:39]
    s_xor_b32 s50, s50, s44
    v_mfma_f32_16x16x32_bf16 v[40:43], v[104:107], v[132:135], v[40:43]
    v_add_u32 v172, s48, v167
    v_mfma_f32_16x16x32_bf16 v[28:31], v[108:111], v[132:135], v[28:31]
    v_and_b32 v173, 4, v172
    v_mfma_f32_16x16x32_bf16 v[32:35], v[112:115], v[132:135], v[32:35]
    v_lshlrev_b32 v173, 3, v173
    v_mfma_f32_16x16x32_bf16 v[20:23], v[116:119], v[132:135], v[20:23]
    v_xor_b32 v173, v173, v168
    v_mfma_f32_16x16x32_bf16 v[24:27], v[120:123], v[132:135], v[24:27]
    v_lshl_add_u32 v173, v172, 6, v173
    v_mfma_f32_16x16x32_bf16 v[12:15], v[124:127], v[132:135], v[12:15]
    v_add_u32 v170, s50, v173
    v_mfma_f32_16x16x32_bf16 v[16:19], v[128:131], v[132:135], v[16:19]
    s_waitcnt lgkmcnt(0)
    v_mfma_f32_16x16x32_bf16 v[68:71], v[76:79], v[136:139], v[68:71]
    v_mfma_f32_16x16x32_bf16 v[72:75], v[80:83], v[136:139], v[72:75]
    v_mfma_f32_16x16x32_bf16 v[60:63], v[84:87], v[136:139], v[60:63]
    ds_read_b128 v[140:143], v164 offset:14080
    v_mfma_f32_16x16x32_bf16 v[64:67], v[88:91], v[136:139], v[64:67]
    v_mfma_f32_16x16x32_bf16 v[52:55], v[92:95], v[136:139], v[52:55]
    v_mfma_f32_16x16x32_bf16 v[56:59], v[96:99], v[136:139], v[56:59]
    v_mfma_f32_16x16x32_bf16 v[44:47], v[100:103], v[136:139], v[44:47]
    v_mfma_f32_16x16x32_bf16 v[48:51], v[104:107], v[136:139], v[48:51]
    v_mfma_f32_16x16x32_bf16 v[36:39], v[108:111], v[136:139], v[36:39]
    v_mfma_f32_16x16x32_bf16 v[40:43], v[112:115], v[136:139], v[40:43]
    v_mfma_f32_16x16x32_bf16 v[28:31], v[116:119], v[136:139], v[28:31]
    v_mfma_f32_16x16x32_bf16 v[32:35], v[120:123], v[136:139], v[32:35]
    v_mfma_f32_16x16x32_bf16 v[20:23], v[124:127], v[136:139], v[20:23]
    v_mfma_f32_16x16x32_bf16 v[24:27], v[128:131], v[136:139], v[24:27]
    s_waitcnt lgkmcnt(0)
    v_mfma_f32_16x16x32_bf16 v[68:71], v[84:87], v[140:143], v[68:71]
    ds_read_b128 v[144:147], v164 offset:15488
    v_mfma_f32_16x16x32_bf16 v[72:75], v[88:91], v[140:143], v[72:75]
    v_mfma_f32_16x16x32_bf16 v[60:63], v[92:95], v[140:143], v[60:63]
    v_mfma_f32_16x16x32_bf16 v[64:67], v[96:99], v[140:143], v[64:67]
    v_mfma_f32_16x16x32_bf16 v[52:55], v[100:103], v[140:143], v[52:55]
    v_mfma_f32_16x16x32_bf16 v[56:59], v[104:107], v[140:143], v[56:59]
    v_mfma_f32_16x16x32_bf16 v[44:47], v[108:111], v[140:143], v[44:47]
    v_mfma_f32_16x16x32_bf16 v[48:51], v[112:115], v[140:143], v[48:51]
    v_mfma_f32_16x16x32_bf16 v[36:39], v[116:119], v[140:143], v[36:39]
    v_mfma_f32_16x16x32_bf16 v[40:43], v[120:123], v[140:143], v[40:43]
    v_mfma_f32_16x16x32_bf16 v[28:31], v[124:127], v[140:143], v[28:31]
    ds_read_b128 v[148:151], v164 offset:16896
    v_mfma_f32_16x16x32_bf16 v[32:35], v[128:131], v[140:143], v[32:35]
    s_waitcnt lgkmcnt(1)
    v_mfma_f32_16x16x32_bf16 v[68:71], v[92:95], v[144:147], v[68:71]
    v_mfma_f32_16x16x32_bf16 v[72:75], v[96:99], v[144:147], v[72:75]
    v_mfma_f32_16x16x32_bf16 v[60:63], v[100:103], v[144:147], v[60:63]
    v_mfma_f32_16x16x32_bf16 v[64:67], v[104:107], v[144:147], v[64:67]
    v_mfma_f32_16x16x32_bf16 v[52:55], v[108:111], v[144:147], v[52:55]
    ds_read_b128 v[160:163], v164 offset:21120
    v_mfma_f32_16x16x32_bf16 v[56:59], v[112:115], v[144:147], v[56:59]
    ds_read_b128 v[156:159], v164 offset:19712
    v_mfma_f32_16x16x32_bf16 v[44:47], v[116:119], v[144:147], v[44:47]
    ds_read_b128 v[152:155], v164 offset:18304
    v_mfma_f32_16x16x32_bf16 v[48:51], v[120:123], v[144:147], v[48:51]
    ds_read_b64_tr_b16 v[94:95], v165 offset:5120
    v_mfma_f32_16x16x32_bf16 v[36:39], v[124:127], v[144:147], v[36:39]
    ds_read_b64_tr_b16 v[98:99], v166 offset:5120
    v_mfma_f32_16x16x32_bf16 v[40:43], v[128:131], v[144:147], v[40:43]
    ds_read_b128 v[140:143], v170 offset:2816
    s_waitcnt lgkmcnt(6)
    v_mfma_f32_16x16x32_bf16 v[68:71], v[100:103], v[148:151], v[68:71]
    ds_read_b128 v[136:139], v170 offset:1408
    v_mfma_f32_16x16x32_bf16 v[72:75], v[104:107], v[148:151], v[72:75]
    ds_read_b64_tr_b16 v[78:79], v165 offset:1024
    v_mfma_f32_16x16x32_bf16 v[60:63], v[108:111], v[148:151], v[60:63]
    ds_read_b64_tr_b16 v[76:77], v165 offset:0
    v_mfma_f32_16x16x32_bf16 v[64:67], v[112:115], v[148:151], v[64:67]
    ds_read_b128 v[132:135], v170 offset:0
    v_mfma_f32_16x16x32_bf16 v[52:55], v[116:119], v[148:151], v[52:55]
    ds_read_b64_tr_b16 v[82:83], v166 offset:1024
    v_mfma_f32_16x16x32_bf16 v[56:59], v[120:123], v[148:151], v[56:59]
    ds_read_b64_tr_b16 v[80:81], v166 offset:0
    v_mfma_f32_16x16x32_bf16 v[44:47], v[124:127], v[148:151], v[44:47]
    v_mov_b32 v164, v170
    v_mfma_f32_16x16x32_bf16 v[48:51], v[128:131], v[148:151], v[48:51]
    ds_read_b64_tr_b16 v[90:91], v166 offset:3072
    s_waitcnt lgkmcnt(7)
    v_mfma_f32_16x16x32_bf16 v[68:71], v[108:111], v[152:155], v[68:71]
    ds_read_b64_tr_b16 v[88:89], v166 offset:2048
    v_mfma_f32_16x16x32_bf16 v[60:63], v[116:119], v[152:155], v[60:63]
    s_add_u32 s49, s49, 1
    v_mfma_f32_16x16x32_bf16 v[64:67], v[120:123], v[152:155], v[64:67]
    ds_read_b64_tr_b16 v[86:87], v165 offset:3072
    v_mfma_f32_16x16x32_bf16 v[52:55], v[124:127], v[152:155], v[52:55]
    ds_read_b64_tr_b16 v[84:85], v165 offset:2048
    v_mfma_f32_16x16x32_bf16 v[56:59], v[128:131], v[152:155], v[56:59]
    s_cmp_lt_u32 s49, 20
    v_mfma_f32_16x16x32_bf16 v[68:71], v[116:119], v[156:159], v[68:71]
    ds_read_b64_tr_b16 v[96:97], v166 offset:4096
    v_mfma_f32_16x16x32_bf16 v[60:63], v[124:127], v[156:159], v[60:63]
    ds_read_b128 v[144:147], v170 offset:4224
    v_mfma_f32_16x16x32_bf16 v[64:67], v[128:131], v[156:159], v[64:67]
    s_waitcnt lgkmcnt(4)
    v_mfma_f32_16x16x32_bf16 v[68:71], v[124:127], v[160:163], v[68:71]
    s_cbranch_scc1 C_Q2_LOOP
    v_mfma_f32_16x16x32_bf16 v[0:3], v[80:83], v[132:135], v[0:3]
    v_mfma_f32_16x16x32_bf16 v[4:7], v[76:79], v[136:139], v[4:7]
    ds_read_b64_tr_b16 v[92:93], v165 offset:4096
    v_mfma_f32_16x16x32_bf16 v[8:11], v[80:83], v[136:139], v[8:11]
    ds_read_b64_tr_b16 v[106:107], v166 offset:7168
    v_mfma_f32_16x16x32_bf16 v[0:3], v[88:91], v[136:139], v[0:3]
    ds_read_b64_tr_b16 v[104:105], v166 offset:6144
    v_mfma_f32_16x16x32_bf16 v[12:15], v[76:79], v[140:143], v[12:15]
    ds_read_b128 v[148:151], v164 offset:5632
    v_mfma_f32_16x16x32_bf16 v[16:19], v[80:83], v[140:143], v[16:19]
    s_waitcnt lgkmcnt(4)
    v_mfma_f32_16x16x32_bf16 v[4:7], v[84:87], v[140:143], v[4:7]
    v_mfma_f32_16x16x32_bf16 v[8:11], v[88:91], v[140:143], v[8:11]
    v_mfma_f32_16x16x32_bf16 v[0:3], v[96:99], v[140:143], v[0:3]
    v_mfma_f32_16x16x32_bf16 v[20:23], v[76:79], v[144:147], v[20:23]
    ds_read_b64_tr_b16 v[102:103], v165 offset:7168
    v_mfma_f32_16x16x32_bf16 v[24:27], v[80:83], v[144:147], v[24:27]
    ds_read_b64_tr_b16 v[100:101], v165 offset:6144
    v_mfma_f32_16x16x32_bf16 v[12:15], v[84:87], v[144:147], v[12:15]
    v_mfma_f32_16x16x32_bf16 v[16:19], v[88:91], v[144:147], v[16:19]
    ds_read_b128 v[152:155], v164 offset:7040
    s_waitcnt lgkmcnt(3)
    v_mfma_f32_16x16x32_bf16 v[4:7], v[92:95], v[144:147], v[4:7]
    v_mfma_f32_16x16x32_bf16 v[8:11], v[96:99], v[144:147], v[8:11]
    v_mfma_f32_16x16x32_bf16 v[0:3], v[104:107], v[144:147], v[0:3]
    v_mfma_f32_16x16x32_bf16 v[28:31], v[76:79], v[148:151], v[28:31]
    v_mfma_f32_16x16x32_bf16 v[32:35], v[80:83], v[148:151], v[32:35]
    v_mfma_f32_16x16x32_bf16 v[20:23], v[84:87], v[148:151], v[20:23]
    v_mfma_f32_16x16x32_bf16 v[24:27], v[88:91], v[148:151], v[24:27]
    v_mfma_f32_16x16x32_bf16 v[12:15], v[92:95], v[148:151], v[12:15]
    ds_read_b128 v[156:159], v164 offset:8448
    v_mfma_f32_16x16x32_bf16 v[16:19], v[96:99], v[148:151], v[16:19]
    s_waitcnt lgkmcnt(1)
    v_mfma_f32_16x16x32_bf16 v[4:7], v[100:103], v[148:151], v[4:7]
    v_mfma_f32_16x16x32_bf16 v[8:11], v[104:107], v[148:151], v[8:11]
    v_mfma_f32_16x16x32_bf16 v[36:39], v[76:79], v[152:155], v[36:39]
    v_mfma_f32_16x16x32_bf16 v[40:43], v[80:83], v[152:155], v[40:43]
    v_mfma_f32_16x16x32_bf16 v[28:31], v[84:87], v[152:155], v[28:31]
    v_mfma_f32_16x16x32_bf16 v[32:35], v[88:91], v[152:155], v[32:35]
    v_mfma_f32_16x16x32_bf16 v[20:23], v[92:95], v[152:155], v[20:23]
    ds_read_b128 v[160:163], v164 offset:9856
    v_mfma_f32_16x16x32_bf16 v[24:27], v[96:99], v[152:155], v[24:27]
    v_mfma_f32_16x16x32_bf16 v[12:15], v[100:103], v[152:155], v[12:15]
    v_mfma_f32_16x16x32_bf16 v[16:19], v[104:107], v[152:155], v[16:19]
    ds_read_b128 v[136:139], v164 offset:12672
    s_waitcnt lgkmcnt(2)
    v_mfma_f32_16x16x32_bf16 v[44:47], v[76:79], v[156:159], v[44:47]
    ds_read_b64_tr_b16 v[126:127], v165 offset:13312
    v_mfma_f32_16x16x32_bf16 v[48:51], v[80:83], v[156:159], v[48:51]
    ds_read_b64_tr_b16 v[124:125], v165 offset:12288
    v_mfma_f32_16x16x32_bf16 v[36:39], v[84:87], v[156:159], v[36:39]
    ds_read_b64_tr_b16 v[130:131], v166 offset:13312
    v_mfma_f32_16x16x32_bf16 v[40:43], v[88:91], v[156:159], v[40:43]
    ds_read_b64_tr_b16 v[128:129], v166 offset:12288
    v_mfma_f32_16x16x32_bf16 v[28:31], v[92:95], v[156:159], v[28:31]
    ds_read_b128 v[132:135], v164 offset:11264
    v_mfma_f32_16x16x32_bf16 v[32:35], v[96:99], v[156:159], v[32:35]
    ds_read_b64_tr_b16 v[118:119], v165 offset:11264
    v_mfma_f32_16x16x32_bf16 v[20:23], v[100:103], v[156:159], v[20:23]
    ds_read_b64_tr_b16 v[116:117], v165 offset:10240
    v_mfma_f32_16x16x32_bf16 v[24:27], v[104:107], v[156:159], v[24:27]
    ds_read_b64_tr_b16 v[122:123], v166 offset:11264
    s_waitcnt lgkmcnt(8)
    v_mfma_f32_16x16x32_bf16 v[52:55], v[76:79], v[160:163], v[52:55]
    ds_read_b64_tr_b16 v[120:121], v166 offset:10240
    v_mfma_f32_16x16x32_bf16 v[56:59], v[80:83], v[160:163], v[56:59]
    ds_read_b64_tr_b16 v[110:111], v165 offset:9216
    v_mfma_f32_16x16x32_bf16 v[44:47], v[84:87], v[160:163], v[44:47]
    ds_read_b64_tr_b16 v[108:109], v165 offset:8192
    v_mfma_f32_16x16x32_bf16 v[48:51], v[88:91], v[160:163], v[48:51]
    ds_read_b64_tr_b16 v[114:115], v166 offset:9216
    v_mfma_f32_16x16x32_bf16 v[36:39], v[92:95], v[160:163], v[36:39]
    ds_read_b64_tr_b16 v[112:113], v166 offset:8192
    v_mfma_f32_16x16x32_bf16 v[40:43], v[96:99], v[160:163], v[40:43]
    v_mfma_f32_16x16x32_bf16 v[28:31], v[100:103], v[160:163], v[28:31]
    v_mfma_f32_16x16x32_bf16 v[32:35], v[104:107], v[160:163], v[32:35]
    s_waitcnt lgkmcnt(5)
    v_mfma_f32_16x16x32_bf16 v[60:63], v[76:79], v[132:135], v[60:63]
    v_mfma_f32_16x16x32_bf16 v[64:67], v[80:83], v[132:135], v[64:67]
    v_mfma_f32_16x16x32_bf16 v[52:55], v[84:87], v[132:135], v[52:55]
    v_mfma_f32_16x16x32_bf16 v[56:59], v[88:91], v[132:135], v[56:59]
    v_mfma_f32_16x16x32_bf16 v[44:47], v[92:95], v[132:135], v[44:47]
    ds_read_b128 v[140:143], v164 offset:14080
    v_mfma_f32_16x16x32_bf16 v[48:51], v[96:99], v[132:135], v[48:51]
    v_mfma_f32_16x16x32_bf16 v[36:39], v[100:103], v[132:135], v[36:39]
    v_mfma_f32_16x16x32_bf16 v[40:43], v[104:107], v[132:135], v[40:43]
    v_mfma_f32_16x16x32_bf16 v[68:71], v[76:79], v[136:139], v[68:71]
    v_mfma_f32_16x16x32_bf16 v[72:75], v[80:83], v[136:139], v[72:75]
    v_mfma_f32_16x16x32_bf16 v[60:63], v[84:87], v[136:139], v[60:63]
    ds_read_b128 v[144:147], v164 offset:15488
    v_mfma_f32_16x16x32_bf16 v[64:67], v[88:91], v[136:139], v[64:67]
    s_waitcnt lgkmcnt(2)
    s_barrier
    v_mfma_f32_16x16x32_bf16 v[52:55], v[92:95], v[136:139], v[52:55]
    v_mfma_f32_16x16x32_bf16 v[56:59], v[96:99], v[136:139], v[56:59]
    v_mfma_f32_16x16x32_bf16 v[44:47], v[100:103], v[136:139], v[44:47]
    v_mfma_f32_16x16x32_bf16 v[48:51], v[104:107], v[136:139], v[48:51]
    s_waitcnt lgkmcnt(1)
    v_mfma_f32_16x16x32_bf16 v[68:71], v[84:87], v[140:143], v[68:71]
    v_mfma_f32_16x16x32_bf16 v[72:75], v[88:91], v[140:143], v[72:75]
    v_mfma_f32_16x16x32_bf16 v[60:63], v[92:95], v[140:143], v[60:63]
    v_mfma_f32_16x16x32_bf16 v[64:67], v[96:99], v[140:143], v[64:67]
    v_mfma_f32_16x16x32_bf16 v[52:55], v[100:103], v[140:143], v[52:55]
    v_mfma_f32_16x16x32_bf16 v[56:59], v[104:107], v[140:143], v[56:59]
    s_waitcnt lgkmcnt(0)
    v_mfma_f32_16x16x32_bf16 v[68:71], v[92:95], v[144:147], v[68:71]
    ds_read_b128 v[140:143], v164 offset:16896
    v_mfma_f32_16x16x32_bf16 v[72:75], v[96:99], v[144:147], v[72:75]
    v_mfma_f32_16x16x32_bf16 v[60:63], v[100:103], v[144:147], v[60:63]
    v_mfma_f32_16x16x32_bf16 v[64:67], v[104:107], v[144:147], v[64:67]
    s_waitcnt lgkmcnt(0)
    v_mfma_f32_16x16x32_bf16 v[68:71], v[100:103], v[140:143], v[68:71]
    v_mfma_f32_16x16x32_bf16 v[72:75], v[104:107], v[140:143], v[72:75]
    v_mfma_f32_16x16x32_bf16 v[0:3], v[112:115], v[148:151], v[0:3]
    v_mfma_f32_16x16x32_bf16 v[0:3], v[120:123], v[152:155], v[0:3]
    v_mfma_f32_16x16x32_bf16 v[0:3], v[128:131], v[156:159], v[0:3]
    v_mfma_f32_16x16x32_bf16 v[4:7], v[108:111], v[152:155], v[4:7]
    v_mfma_f32_16x16x32_bf16 v[8:11], v[112:115], v[152:155], v[8:11]
    v_mfma_f32_16x16x32_bf16 v[4:7], v[116:119], v[156:159], v[4:7]
    v_mfma_f32_16x16x32_bf16 v[8:11], v[120:123], v[156:159], v[8:11]
    v_mfma_f32_16x16x32_bf16 v[4:7], v[124:127], v[160:163], v[4:7]
    s_nop 2
    v_cvt_pk_bf16_f32 v0, v0, v1
    s_nop 0
    v_cvt_pk_bf16_f32 v1, v2, v3
    v_mfma_f32_16x16x32_bf16 v[8:11], v[128:131], v[160:163], v[8:11]
    s_mov_b32 s45, 0
    buffer_store_dwordx2 v[0:1], v180, s[20:23], s45 offen offset:32
    v_mfma_f32_16x16x32_bf16 v[12:15], v[108:111], v[156:159], v[12:15]
    v_mfma_f32_16x16x32_bf16 v[16:19], v[112:115], v[156:159], v[16:19]
    v_mfma_f32_16x16x32_bf16 v[12:15], v[116:119], v[160:163], v[12:15]
    v_mfma_f32_16x16x32_bf16 v[16:19], v[120:123], v[160:163], v[16:19]
    v_mfma_f32_16x16x32_bf16 v[12:15], v[124:127], v[132:135], v[12:15]
    ds_read_b128 v[148:151], v164 offset:14080
    v_cvt_pk_bf16_f32 v4, v4, v5
    v_cvt_pk_bf16_f32 v5, v6, v7
    v_mfma_f32_16x16x32_bf16 v[16:19], v[128:131], v[132:135], v[16:19]
    ds_write_b64 v181, v[4:5] offset:1280
    v_cvt_pk_bf16_f32 v8, v8, v9
    v_mfma_f32_16x16x32_bf16 v[20:23], v[108:111], v[160:163], v[20:23]
    v_cvt_pk_bf16_f32 v9, v10, v11
    ds_write_b64 v181, v[8:9] offset:1312
    v_mfma_f32_16x16x32_bf16 v[24:27], v[112:115], v[160:163], v[24:27]
    ds_read_b128 v[188:191], v182 offset:1280
    v_mfma_f32_16x16x32_bf16 v[20:23], v[116:119], v[132:135], v[20:23]
    v_mfma_f32_16x16x32_bf16 v[24:27], v[120:123], v[132:135], v[24:27]
    v_mfma_f32_16x16x32_bf16 v[20:23], v[124:127], v[136:139], v[20:23]
    s_waitcnt lgkmcnt(1)
    s_barrier
    v_mfma_f32_16x16x32_bf16 v[24:27], v[128:131], v[136:139], v[24:27]
    v_mfma_f32_16x16x32_bf16 v[28:31], v[108:111], v[132:135], v[28:31]
    ds_read_b128 v[204:207], v184 offset:1024
    v_cvt_pk_bf16_f32 v12, v12, v13
    v_mfma_f32_16x16x32_bf16 v[32:35], v[112:115], v[132:135], v[32:35]
    v_cvt_pk_bf16_f32 v13, v14, v15
    ds_write_b64 v181, v[12:13] offset:2560
    v_mfma_f32_16x16x32_bf16 v[28:31], v[116:119], v[136:139], v[28:31]
    v_cvt_pk_bf16_f32 v16, v16, v17
    v_cvt_pk_bf16_f32 v17, v18, v19
    v_mfma_f32_16x16x32_bf16 v[32:35], v[120:123], v[136:139], v[32:35]
    ds_write_b64 v181, v[16:17] offset:2592
    ds_read_b128 v[192:195], v182 offset:2560
    v_mfma_f32_16x16x32_bf16 v[28:31], v[124:127], v[148:151], v[28:31]
    s_mov_b32 s57, 86016
    s_waitcnt lgkmcnt(4)
    buffer_store_dwordx4 v[188:191], v183, s[20:23], s57 offen
    v_mfma_f32_16x16x32_bf16 v[32:35], v[128:131], v[148:151], v[32:35]
    v_cvt_pk_bf16_f32 v20, v20, v21
    v_cvt_pk_bf16_f32 v21, v22, v23
    v_mfma_f32_16x16x32_bf16 v[36:39], v[108:111], v[136:139], v[36:39]
    ds_write_b64 v181, v[20:21] offset:3840
    v_cvt_pk_bf16_f32 v24, v24, v25
    v_mfma_f32_16x16x32_bf16 v[40:43], v[112:115], v[136:139], v[40:43]
    v_cvt_pk_bf16_f32 v25, v26, v27
    ds_write_b64 v181, v[24:25] offset:3872
    v_mfma_f32_16x16x32_bf16 v[36:39], v[116:119], v[148:151], v[36:39]
    ds_read_b128 v[196:199], v182 offset:3840
    s_mov_b32 s57, 172032
    v_mfma_f32_16x16x32_bf16 v[40:43], v[120:123], v[148:151], v[40:43]
    s_waitcnt lgkmcnt(3)
    buffer_store_dwordx4 v[192:195], v183, s[20:23], s57 offen
    v_mfma_f32_16x16x32_bf16 v[36:39], v[124:127], v[144:147], v[36:39]
    ds_read_b128 v[152:155], v164 offset:18304
    v_cvt_pk_bf16_f32 v28, v28, v29
    v_cvt_pk_bf16_f32 v29, v30, v31
    v_mfma_f32_16x16x32_bf16 v[40:43], v[128:131], v[144:147], v[40:43]
    ds_write_b64 v181, v[28:29] offset:5120
    v_cvt_pk_bf16_f32 v32, v32, v33
    v_mfma_f32_16x16x32_bf16 v[44:47], v[108:111], v[148:151], v[44:47]
    v_cvt_pk_bf16_f32 v33, v34, v35
    ds_write_b64 v181, v[32:33] offset:5152
    v_mfma_f32_16x16x32_bf16 v[48:51], v[112:115], v[148:151], v[48:51]
    ds_read_b128 v[200:203], v182 offset:5120
    s_mov_b32 s57, 258048
    v_mfma_f32_16x16x32_bf16 v[44:47], v[116:119], v[144:147], v[44:47]
    s_waitcnt lgkmcnt(4)
    buffer_store_dwordx4 v[196:199], v183, s[20:23], s57 offen
    v_mfma_f32_16x16x32_bf16 v[48:51], v[120:123], v[144:147], v[48:51]
    v_mfma_f32_16x16x32_bf16 v[44:47], v[124:127], v[140:143], v[44:47]
    ds_read_b128 v[156:159], v164 offset:19712
    v_cvt_pk_bf16_f32 v36, v36, v37
    v_cvt_pk_bf16_f32 v37, v38, v39
    v_mfma_f32_16x16x32_bf16 v[48:51], v[128:131], v[140:143], v[48:51]
    ds_write_b64 v181, v[36:37] offset:0
    v_cvt_pk_bf16_f32 v40, v40, v41
    v_mfma_f32_16x16x32_bf16 v[52:55], v[108:111], v[144:147], v[52:55]
    v_cvt_pk_bf16_f32 v41, v42, v43
    ds_write_b64 v181, v[40:41] offset:32
    v_mfma_f32_16x16x32_bf16 v[56:59], v[112:115], v[144:147], v[56:59]
    ds_read_b128 v[188:191], v182 offset:0
    s_mov_b32 s57, 344064
    v_mfma_f32_16x16x32_bf16 v[52:55], v[116:119], v[140:143], v[52:55]
    ds_read_b128 v[160:163], v164 offset:21120
    s_waitcnt lgkmcnt(5)
    buffer_store_dwordx4 v[200:203], v183, s[20:23], s57 offen
    v_mfma_f32_16x16x32_bf16 v[56:59], v[120:123], v[140:143], v[56:59]
    v_mfma_f32_16x16x32_bf16 v[52:55], v[124:127], v[152:155], v[52:55]
    v_cvt_pk_bf16_f32 v44, v44, v45
    v_cvt_pk_bf16_f32 v45, v46, v47
    v_mfma_f32_16x16x32_bf16 v[56:59], v[128:131], v[152:155], v[56:59]
    ds_write_b64 v181, v[44:45] offset:1280
    v_cvt_pk_bf16_f32 v48, v48, v49
    v_mfma_f32_16x16x32_bf16 v[60:63], v[108:111], v[140:143], v[60:63]
    v_cvt_pk_bf16_f32 v49, v50, v51
    ds_write_b64 v181, v[48:49] offset:1312
    v_mfma_f32_16x16x32_bf16 v[64:67], v[112:115], v[140:143], v[64:67]
    ds_read_b128 v[192:195], v182 offset:1280
    s_mov_b32 s57, 430080
    v_mfma_f32_16x16x32_bf16 v[60:63], v[116:119], v[152:155], v[60:63]
    s_waitcnt lgkmcnt(4)
    buffer_store_dwordx4 v[188:191], v183, s[20:23], s57 offen
    v_mfma_f32_16x16x32_bf16 v[64:67], v[120:123], v[152:155], v[64:67]
    v_mfma_f32_16x16x32_bf16 v[60:63], v[124:127], v[156:159], v[60:63]
    v_cvt_pk_bf16_f32 v52, v52, v53
    v_cvt_pk_bf16_f32 v53, v54, v55
    v_mfma_f32_16x16x32_bf16 v[64:67], v[128:131], v[156:159], v[64:67]
    ds_write_b64 v181, v[52:53] offset:2560
    v_cvt_pk_bf16_f32 v56, v56, v57
    v_mfma_f32_16x16x32_bf16 v[68:71], v[108:111], v[152:155], v[68:71]
    v_cvt_pk_bf16_f32 v57, v58, v59
    ds_write_b64 v181, v[56:57] offset:2592
    v_mfma_f32_16x16x32_bf16 v[68:71], v[116:119], v[156:159], v[68:71]
    ds_read_b128 v[196:199], v182 offset:2560
    s_mov_b32 s57, 516096
    s_waitcnt lgkmcnt(5)
    v_mfma_f32_16x16x32_bf16 v[68:71], v[124:127], v[160:163], v[68:71]
    s_waitcnt lgkmcnt(3)
    buffer_store_dwordx4 v[192:195], v183, s[20:23], s57 offen
    v_cvt_pk_bf16_f32 v60, v60, v61
    v_cvt_pk_bf16_f32 v61, v62, v63
    ds_write_b64 v181, v[60:61] offset:3840
    v_cvt_pk_bf16_f32 v64, v64, v65
    v_cvt_pk_bf16_f32 v65, v66, v67
    ds_write_b64 v181, v[64:65] offset:3872
    ds_read_b128 v[200:203], v182 offset:3840
    s_mov_b32 s57, 602112
    s_waitcnt lgkmcnt(3)
    buffer_store_dwordx4 v[196:199], v183, s[20:23], s57 offen
    v_add_f32 v72, v72, v204
    v_add_f32 v73, v73, v205
    v_add_f32 v74, v74, v206
    v_add_f32 v75, v75, v207
    v_cvt_pk_bf16_f32 v68, v68, v69
    v_cvt_pk_bf16_f32 v69, v70, v71
    ds_write_b64 v181, v[68:69] offset:5120
    v_cvt_pk_bf16_f32 v72, v72, v73
    v_cvt_pk_bf16_f32 v73, v74, v75
    ds_write_b64 v181, v[72:73] offset:5152
    ds_read_b128 v[188:191], v182 offset:5120
    s_mov_b32 s57, 688128
    s_waitcnt lgkmcnt(3)
    buffer_store_dwordx4 v[200:203], v183, s[20:23], s57 offen
    s_mov_b32 s57, 774144
    s_waitcnt lgkmcnt(0)
    buffer_store_dwordx4 v[188:191], v183, s[20:23], s57 offen
    s_endpgm
.p2align 6
C_Q3:
    s_barrier
    ds_read_b64_tr_b16 v[76:77], v165 offset:0
    ds_read_b64_tr_b16 v[78:79], v165 offset:1024
    ds_read_b128 v[132:135], v164 offset:1408
    ds_read_b64_tr_b16 v[80:81], v166 offset:0
    ds_read_b64_tr_b16 v[82:83], v166 offset:1024
    ds_read_b64_tr_b16 v[84:85], v165 offset:2048
    ds_read_b64_tr_b16 v[86:87], v165 offset:3072
    ds_read_b64_tr_b16 v[88:89], v166 offset:2048
    ds_read_b64_tr_b16 v[90:91], v166 offset:3072
    s_waitcnt lgkmcnt(6)
    v_mfma_f32_16x16x32_bf16 v[4:7], v[76:79], v[132:135], 0
    s_waitcnt lgkmcnt(4)
    v_mfma_f32_16x16x32_bf16 v[8:11], v[80:83], v[132:135], 0
    s_barrier
    ds_read_b128 v[136:139], v164 offset:2816
    ds_read_b128 v[140:143], v164 offset:4224
    s_waitcnt lgkmcnt(1)
    v_mfma_f32_16x16x32_bf16 v[12:15], v[76:79], v[136:139], 0
    ds_read_b64_tr_b16 v[92:93], v165 offset:4096
    ds_read_b64_tr_b16 v[94:95], v165 offset:5120
    v_mfma_f32_16x16x32_bf16 v[16:19], v[80:83], v[136:139], 0
    ds_read_b64_tr_b16 v[96:97], v166 offset:4096
    ds_read_b64_tr_b16 v[98:99], v166 offset:5120
    v_mfma_f32_16x16x32_bf16 v[4:7], v[84:87], v[136:139], v[4:7]
    ds_read_b64_tr_b16 v[100:101], v165 offset:6144
    ds_read_b64_tr_b16 v[102:103], v165 offset:7168
    v_mfma_f32_16x16x32_bf16 v[8:11], v[88:91], v[136:139], v[8:11]
    ds_read_b64_tr_b16 v[104:105], v166 offset:6144
    ds_read_b64_tr_b16 v[106:107], v166 offset:7168
    s_waitcnt lgkmcnt(8)
    v_mfma_f32_16x16x32_bf16 v[20:23], v[76:79], v[140:143], 0
    v_mfma_f32_16x16x32_bf16 v[24:27], v[80:83], v[140:143], 0
    v_mfma_f32_16x16x32_bf16 v[12:15], v[84:87], v[140:143], v[12:15]
    v_mfma_f32_16x16x32_bf16 v[16:19], v[88:91], v[140:143], v[16:19]
    s_waitcnt lgkmcnt(6)
    v_mfma_f32_16x16x32_bf16 v[4:7], v[92:95], v[140:143], v[4:7]
    s_waitcnt lgkmcnt(4)
    v_mfma_f32_16x16x32_bf16 v[8:11], v[96:99], v[140:143], v[8:11]
    s_barrier
    ds_read_b128 v[144:147], v164 offset:5632
    s_waitcnt lgkmcnt(0)
    v_mfma_f32_16x16x32_bf16 v[28:31], v[76:79], v[144:147], 0
    ds_read_b64_tr_b16 v[112:113], v166 offset:8192
    ds_read_b64_tr_b16 v[114:115], v166 offset:9216
    v_mfma_f32_16x16x32_bf16 v[32:35], v[80:83], v[144:147], 0
    ds_read_b128 v[148:151], v164 offset:7040
    ds_read_b64_tr_b16 v[108:109], v165 offset:8192
    v_mfma_f32_16x16x32_bf16 v[20:23], v[84:87], v[144:147], v[20:23]
    ds_read_b64_tr_b16 v[110:111], v165 offset:9216
    ds_read_b64_tr_b16 v[120:121], v166 offset:10240
    v_mfma_f32_16x16x32_bf16 v[24:27], v[88:91], v[144:147], v[24:27]
    ds_read_b64_tr_b16 v[122:123], v166 offset:11264
    ds_read_b64_tr_b16 v[116:117], v165 offset:10240
    v_mfma_f32_16x16x32_bf16 v[12:15], v[92:95], v[144:147], v[12:15]
    ds_read_b64_tr_b16 v[118:119], v165 offset:11264
    v_mfma_f32_16x16x32_bf16 v[16:19], v[96:99], v[144:147], v[16:19]
    v_mfma_f32_16x16x32_bf16 v[4:7], v[100:103], v[144:147], v[4:7]
    v_mfma_f32_16x16x32_bf16 v[8:11], v[104:107], v[144:147], v[8:11]
    s_waitcnt lgkmcnt(7)
    v_mfma_f32_16x16x32_bf16 v[0:3], v[112:115], v[144:147], 0
    s_waitcnt lgkmcnt(6)
    v_mfma_f32_16x16x32_bf16 v[36:39], v[76:79], v[148:151], 0
    v_mfma_f32_16x16x32_bf16 v[40:43], v[80:83], v[148:151], 0
    v_mfma_f32_16x16x32_bf16 v[28:31], v[84:87], v[148:151], v[28:31]
    v_mfma_f32_16x16x32_bf16 v[32:35], v[88:91], v[148:151], v[32:35]
    v_mfma_f32_16x16x32_bf16 v[20:23], v[92:95], v[148:151], v[20:23]
    v_mfma_f32_16x16x32_bf16 v[24:27], v[96:99], v[148:151], v[24:27]
    v_mfma_f32_16x16x32_bf16 v[12:15], v[100:103], v[148:151], v[12:15]
    v_mfma_f32_16x16x32_bf16 v[16:19], v[104:107], v[148:151], v[16:19]
    s_waitcnt lgkmcnt(0)
    v_mfma_f32_16x16x32_bf16 v[4:7], v[108:111], v[148:151], v[4:7]
    v_mfma_f32_16x16x32_bf16 v[8:11], v[112:115], v[148:151], v[8:11]
    v_mfma_f32_16x16x32_bf16 v[0:3], v[120:123], v[148:151], v[0:3]
    s_barrier
    ds_read_b128 v[132:135], v164 offset:8448
    s_waitcnt lgkmcnt(0)
    v_mfma_f32_16x16x32_bf16 v[44:47], v[76:79], v[132:135], 0
    ds_read_b64_tr_b16 v[128:129], v166 offset:12288
    ds_read_b64_tr_b16 v[130:131], v166 offset:13312
    v_mfma_f32_16x16x32_bf16 v[48:51], v[80:83], v[132:135], 0
    ds_read_b128 v[136:139], v164 offset:9856
    ds_read_b64_tr_b16 v[124:125], v165 offset:12288
    v_mfma_f32_16x16x32_bf16 v[36:39], v[84:87], v[132:135], v[36:39]
    ds_read_b64_tr_b16 v[126:127], v165 offset:13312
    v_mfma_f32_16x16x32_bf16 v[40:43], v[88:91], v[132:135], v[40:43]
    v_mfma_f32_16x16x32_bf16 v[28:31], v[92:95], v[132:135], v[28:31]
    v_mfma_f32_16x16x32_bf16 v[32:35], v[96:99], v[132:135], v[32:35]
    v_mfma_f32_16x16x32_bf16 v[20:23], v[100:103], v[132:135], v[20:23]
    v_mfma_f32_16x16x32_bf16 v[24:27], v[104:107], v[132:135], v[24:27]
    v_mfma_f32_16x16x32_bf16 v[12:15], v[108:111], v[132:135], v[12:15]
    v_mfma_f32_16x16x32_bf16 v[16:19], v[112:115], v[132:135], v[16:19]
    v_mfma_f32_16x16x32_bf16 v[4:7], v[116:119], v[132:135], v[4:7]
    v_mfma_f32_16x16x32_bf16 v[8:11], v[120:123], v[132:135], v[8:11]
    s_waitcnt lgkmcnt(0)
    v_mfma_f32_16x16x32_bf16 v[0:3], v[128:131], v[132:135], v[0:3]
    v_mfma_f32_16x16x32_bf16 v[52:55], v[76:79], v[136:139], 0
    v_mfma_f32_16x16x32_bf16 v[56:59], v[80:83], v[136:139], 0
    v_mfma_f32_16x16x32_bf16 v[44:47], v[84:87], v[136:139], v[44:47]
    v_mfma_f32_16x16x32_bf16 v[48:51], v[88:91], v[136:139], v[48:51]
    v_mfma_f32_16x16x32_bf16 v[36:39], v[92:95], v[136:139], v[36:39]
    v_mfma_f32_16x16x32_bf16 v[40:43], v[96:99], v[136:139], v[40:43]
    v_mfma_f32_16x16x32_bf16 v[28:31], v[100:103], v[136:139], v[28:31]
    v_mfma_f32_16x16x32_bf16 v[32:35], v[104:107], v[136:139], v[32:35]
    v_mfma_f32_16x16x32_bf16 v[20:23], v[108:111], v[136:139], v[20:23]
    v_mfma_f32_16x16x32_bf16 v[24:27], v[112:115], v[136:139], v[24:27]
    v_mfma_f32_16x16x32_bf16 v[12:15], v[116:119], v[136:139], v[12:15]
    v_mfma_f32_16x16x32_bf16 v[16:19], v[120:123], v[136:139], v[16:19]
    v_mfma_f32_16x16x32_bf16 v[4:7], v[124:127], v[136:139], v[4:7]
    s_barrier
    ds_read_b128 v[140:143], v164 offset:11264
    v_mfma_f32_16x16x32_bf16 v[8:11], v[128:131], v[136:139], v[8:11]
    ds_read_b128 v[144:147], v164 offset:12672
    ds_read_b128 v[148:151], v164 offset:14080
    s_waitcnt lgkmcnt(2)
    v_mfma_f32_16x16x32_bf16 v[60:63], v[76:79], v[140:143], 0
    ds_read_b128 v[132:135], v164 offset:15488
    v_mfma_f32_16x16x32_bf16 v[64:67], v[80:83], v[140:143], 0
    v_mfma_f32_16x16x32_bf16 v[52:55], v[84:87], v[140:143], v[52:55]
    v_mfma_f32_16x16x32_bf16 v[56:59], v[88:91], v[140:143], v[56:59]
    s_add_u32 s48, s48, 1
    v_mfma_f32_16x16x32_bf16 v[44:47], v[92:95], v[140:143], v[44:47]
    s_cmp_eq_u32 s48, 7
    v_mfma_f32_16x16x32_bf16 v[48:51], v[96:99], v[140:143], v[48:51]
    s_cselect_b32 s44, s51, 0
    v_mfma_f32_16x16x32_bf16 v[36:39], v[100:103], v[140:143], v[36:39]
    s_cselect_b32 s48, 0, s48
    v_mfma_f32_16x16x32_bf16 v[40:43], v[104:107], v[140:143], v[40:43]
    s_xor_b32 s50, s50, s44
    v_mfma_f32_16x16x32_bf16 v[28:31], v[108:111], v[140:143], v[28:31]
    v_add_u32 v172, s48, v167
    v_mfma_f32_16x16x32_bf16 v[32:35], v[112:115], v[140:143], v[32:35]
    v_and_b32 v173, 4, v172
    v_mfma_f32_16x16x32_bf16 v[20:23], v[116:119], v[140:143], v[20:23]
    ds_read_b128 v[136:139], v164 offset:16896
    v_mfma_f32_16x16x32_bf16 v[24:27], v[120:123], v[140:143], v[24:27]
    v_lshlrev_b32 v173, 3, v173
    v_mfma_f32_16x16x32_bf16 v[12:15], v[124:127], v[140:143], v[12:15]
    v_xor_b32 v173, v173, v168
    v_mfma_f32_16x16x32_bf16 v[16:19], v[128:131], v[140:143], v[16:19]
    v_lshl_add_u32 v173, v172, 6, v173
    s_waitcnt lgkmcnt(1)
    v_mfma_f32_16x16x32_bf16 v[68:71], v[76:79], v[144:147], 0
    v_add_u32 v170, s50, v173
    v_mfma_f32_16x16x32_bf16 v[72:75], v[80:83], v[144:147], 0
    v_mfma_f32_16x16x32_bf16 v[60:63], v[84:87], v[144:147], v[60:63]
    v_mfma_f32_16x16x32_bf16 v[64:67], v[88:91], v[144:147], v[64:67]
    v_mfma_f32_16x16x32_bf16 v[52:55], v[92:95], v[144:147], v[52:55]
    ds_read_b128 v[140:143], v164 offset:18304
    v_mfma_f32_16x16x32_bf16 v[56:59], v[96:99], v[144:147], v[56:59]
    v_mfma_f32_16x16x32_bf16 v[44:47], v[100:103], v[144:147], v[44:47]
    v_mfma_f32_16x16x32_bf16 v[48:51], v[104:107], v[144:147], v[48:51]
    v_mfma_f32_16x16x32_bf16 v[36:39], v[108:111], v[144:147], v[36:39]
    v_mfma_f32_16x16x32_bf16 v[40:43], v[112:115], v[144:147], v[40:43]
    v_mfma_f32_16x16x32_bf16 v[28:31], v[116:119], v[144:147], v[28:31]
    s_barrier
    v_mfma_f32_16x16x32_bf16 v[32:35], v[120:123], v[144:147], v[32:35]
    s_xor_b32 s52, s52, s53
    v_mfma_f32_16x16x32_bf16 v[20:23], v[124:127], v[144:147], v[20:23]
    v_add_u32 v165, s52, v169
    v_mfma_f32_16x16x32_bf16 v[24:27], v[128:131], v[144:147], v[24:27]
    v_xor_b32 v166, 32, v165
    v_mfma_f32_16x16x32_bf16 v[68:71], v[84:87], v[148:151], v[68:71]
    ds_read_b128 v[144:147], v164 offset:19712
    v_mfma_f32_16x16x32_bf16 v[72:75], v[88:91], v[148:151], v[72:75]
    v_mfma_f32_16x16x32_bf16 v[60:63], v[92:95], v[148:151], v[60:63]
    v_mfma_f32_16x16x32_bf16 v[64:67], v[96:99], v[148:151], v[64:67]
    v_mfma_f32_16x16x32_bf16 v[52:55], v[100:103], v[148:151], v[52:55]
    v_mfma_f32_16x16x32_bf16 v[56:59], v[104:107], v[148:151], v[56:59]
    v_mfma_f32_16x16x32_bf16 v[44:47], v[108:111], v[148:151], v[44:47]
    v_mfma_f32_16x16x32_bf16 v[48:51], v[112:115], v[148:151], v[48:51]
    v_mfma_f32_16x16x32_bf16 v[36:39], v[116:119], v[148:151], v[36:39]
    v_mfma_f32_16x16x32_bf16 v[40:43], v[120:123], v[148:151], v[40:43]
    v_mfma_f32_16x16x32_bf16 v[28:31], v[124:127], v[148:151], v[28:31]
    v_mfma_f32_16x16x32_bf16 v[32:35], v[128:131], v[148:151], v[32:35]
    v_mfma_f32_16x16x32_bf16 v[68:71], v[92:95], v[132:135], v[68:71]
    ds_read_b128 v[148:151], v164 offset:21120
    v_mfma_f32_16x16x32_bf16 v[72:75], v[96:99], v[132:135], v[72:75]
    v_mov_b32 v164, v170
    v_mfma_f32_16x16x32_bf16 v[60:63], v[100:103], v[132:135], v[60:63]
    v_mfma_f32_16x16x32_bf16 v[64:67], v[104:107], v[132:135], v[64:67]
    v_mfma_f32_16x16x32_bf16 v[52:55], v[108:111], v[132:135], v[52:55]
    v_mfma_f32_16x16x32_bf16 v[56:59], v[112:115], v[132:135], v[56:59]
    v_mfma_f32_16x16x32_bf16 v[44:47], v[116:119], v[132:135], v[44:47]
    s_barrier
    v_mfma_f32_16x16x32_bf16 v[48:51], v[120:123], v[132:135], v[48:51]
    v_mfma_f32_16x16x32_bf16 v[36:39], v[124:127], v[132:135], v[36:39]
    v_mfma_f32_16x16x32_bf16 v[40:43], v[128:131], v[132:135], v[40:43]
    s_waitcnt lgkmcnt(0)
    v_mfma_f32_16x16x32_bf16 v[68:71], v[100:103], v[136:139], v[68:71]
    ds_read_b64_tr_b16 v[98:99], v166 offset:5120
    v_mfma_f32_16x16x32_bf16 v[72:75], v[104:107], v[136:139], v[72:75]
    ds_read_b64_tr_b16 v[90:91], v166 offset:3072
    v_mfma_f32_16x16x32_bf16 v[60:63], v[108:111], v[136:139], v[60:63]
    ds_read_b64_tr_b16 v[88:89], v166 offset:2048
    v_mfma_f32_16x16x32_bf16 v[64:67], v[112:115], v[136:139], v[64:67]
    ds_read_b64_tr_b16 v[86:87], v165 offset:3072
    v_mfma_f32_16x16x32_bf16 v[52:55], v[116:119], v[136:139], v[52:55]
    ds_read_b64_tr_b16 v[82:83], v166 offset:1024
    v_mfma_f32_16x16x32_bf16 v[56:59], v[120:123], v[136:139], v[56:59]
    ds_read_b64_tr_b16 v[80:81], v166 offset:0
    v_mfma_f32_16x16x32_bf16 v[44:47], v[124:127], v[136:139], v[44:47]
    ds_read_b128 v[132:135], v170 offset:1408
    v_mfma_f32_16x16x32_bf16 v[48:51], v[128:131], v[136:139], v[48:51]
    ds_read_b64_tr_b16 v[78:79], v165 offset:1024
    v_mfma_f32_16x16x32_bf16 v[68:71], v[108:111], v[140:143], v[68:71]
    ds_read_b64_tr_b16 v[76:77], v165 offset:0
    v_mfma_f32_16x16x32_bf16 v[72:75], v[112:115], v[140:143], v[72:75]
    v_mfma_f32_16x16x32_bf16 v[60:63], v[116:119], v[140:143], v[60:63]
    ds_read_b128 v[136:139], v170 offset:2816
    v_mfma_f32_16x16x32_bf16 v[64:67], v[120:123], v[140:143], v[64:67]
    v_mfma_f32_16x16x32_bf16 v[52:55], v[124:127], v[140:143], v[52:55]
    ds_read_b64_tr_b16 v[84:85], v165 offset:2048
    v_mfma_f32_16x16x32_bf16 v[56:59], v[128:131], v[140:143], v[56:59]
    v_mfma_f32_16x16x32_bf16 v[68:71], v[116:119], v[144:147], v[68:71]
    ds_read_b128 v[140:143], v170 offset:4224
    v_mfma_f32_16x16x32_bf16 v[72:75], v[120:123], v[144:147], v[72:75]
    v_mfma_f32_16x16x32_bf16 v[60:63], v[124:127], v[144:147], v[60:63]
    ds_read_b64_tr_b16 v[96:97], v166 offset:4096
    v_mfma_f32_16x16x32_bf16 v[64:67], v[128:131], v[144:147], v[64:67]
    ds_read_b64_tr_b16 v[94:95], v165 offset:5120
    v_mfma_f32_16x16x32_bf16 v[68:71], v[124:127], v[148:151], v[68:71]
    ds_read_b64_tr_b16 v[92:93], v165 offset:4096
    v_mfma_f32_16x16x32_bf16 v[72:75], v[128:131], v[148:151], v[72:75]
    s_waitcnt lgkmcnt(5)
    s_barrier
C_Q3_LOOP:
    v_mfma_f32_16x16x32_bf16 v[4:7], v[76:79], v[132:135], v[4:7]
    ds_read_b128 v[144:147], v164 offset:5632
    v_mfma_f32_16x16x32_bf16 v[8:11], v[80:83], v[132:135], v[8:11]
    v_mfma_f32_16x16x32_bf16 v[12:15], v[76:79], v[136:139], v[12:15]
    ds_read_b64_tr_b16 v[114:115], v166 offset:9216
    v_mfma_f32_16x16x32_bf16 v[16:19], v[80:83], v[136:139], v[16:19]
    ds_read_b64_tr_b16 v[106:107], v166 offset:7168
    s_waitcnt lgkmcnt(6)
    v_mfma_f32_16x16x32_bf16 v[4:7], v[84:87], v[136:139], v[4:7]
    ds_read_b64_tr_b16 v[104:105], v166 offset:6144
    v_mfma_f32_16x16x32_bf16 v[8:11], v[88:91], v[136:139], v[8:11]
    ds_read_b64_tr_b16 v[102:103], v165 offset:7168
    v_mfma_f32_16x16x32_bf16 v[20:23], v[76:79], v[140:143], v[20:23]
    ds_read_b64_tr_b16 v[100:101], v165 offset:6144
    v_mfma_f32_16x16x32_bf16 v[24:27], v[80:83], v[140:143], v[24:27]
    v_mfma_f32_16x16x32_bf16 v[12:15], v[84:87], v[140:143], v[12:15]
    ds_read_b64_tr_b16 v[112:113], v166 offset:8192
    v_mfma_f32_16x16x32_bf16 v[16:19], v[88:91], v[140:143], v[16:19]
    ds_read_b128 v[148:151], v164 offset:7040
    s_waitcnt lgkmcnt(7)
    v_mfma_f32_16x16x32_bf16 v[4:7], v[92:95], v[140:143], v[4:7]
    v_mfma_f32_16x16x32_bf16 v[8:11], v[96:99], v[140:143], v[8:11]
    v_mfma_f32_16x16x32_bf16 v[28:31], v[76:79], v[144:147], v[28:31]
    v_mfma_f32_16x16x32_bf16 v[32:35], v[80:83], v[144:147], v[32:35]
    v_mfma_f32_16x16x32_bf16 v[20:23], v[84:87], v[144:147], v[20:23]
    ds_read_b128 v[132:135], v164 offset:8448
    v_mfma_f32_16x16x32_bf16 v[24:27], v[88:91], v[144:147], v[24:27]
    ds_read_b64_tr_b16 v[122:123], v166 offset:11264
    v_mfma_f32_16x16x32_bf16 v[12:15], v[92:95], v[144:147], v[12:15]
    ds_read_b64_tr_b16 v[110:111], v165 offset:9216
    v_mfma_f32_16x16x32_bf16 v[16:19], v[96:99], v[144:147], v[16:19]
    ds_read_b64_tr_b16 v[108:109], v165 offset:8192
    s_waitcnt lgkmcnt(4)
    v_mfma_f32_16x16x32_bf16 v[4:7], v[100:103], v[144:147], v[4:7]
    v_mfma_f32_16x16x32_bf16 v[8:11], v[104:107], v[144:147], v[8:11]
    ds_read_b64_tr_b16 v[120:121], v166 offset:10240
    v_mfma_f32_16x16x32_bf16 v[0:3], v[112:115], v[144:147], v[0:3]
    v_mfma_f32_16x16x32_bf16 v[36:39], v[76:79], v[148:151], v[36:39]
    v_mfma_f32_16x16x32_bf16 v[40:43], v[80:83], v[148:151], v[40:43]
    v_mfma_f32_16x16x32_bf16 v[28:31], v[84:87], v[148:151], v[28:31]
    v_mfma_f32_16x16x32_bf16 v[32:35], v[88:91], v[148:151], v[32:35]
    v_mfma_f32_16x16x32_bf16 v[20:23], v[92:95], v[148:151], v[20:23]
    v_mfma_f32_16x16x32_bf16 v[24:27], v[96:99], v[148:151], v[24:27]
    v_mfma_f32_16x16x32_bf16 v[12:15], v[100:103], v[148:151], v[12:15]
    ds_read_b128 v[136:139], v164 offset:9856
    v_mfma_f32_16x16x32_bf16 v[16:19], v[104:107], v[148:151], v[16:19]
    ds_read_b64_tr_b16 v[130:131], v166 offset:13312
    s_waitcnt lgkmcnt(2)
    v_mfma_f32_16x16x32_bf16 v[4:7], v[108:111], v[148:151], v[4:7]
    ds_read_b64_tr_b16 v[118:119], v165 offset:11264
    v_mfma_f32_16x16x32_bf16 v[8:11], v[112:115], v[148:151], v[8:11]
    ds_read_b64_tr_b16 v[116:117], v165 offset:10240
    v_mfma_f32_16x16x32_bf16 v[0:3], v[120:123], v[148:151], v[0:3]
    v_mfma_f32_16x16x32_bf16 v[44:47], v[76:79], v[132:135], v[44:47]
    ds_read_b64_tr_b16 v[128:129], v166 offset:12288
    v_mfma_f32_16x16x32_bf16 v[48:51], v[80:83], v[132:135], v[48:51]
    v_mfma_f32_16x16x32_bf16 v[36:39], v[84:87], v[132:135], v[36:39]
    v_mfma_f32_16x16x32_bf16 v[40:43], v[88:91], v[132:135], v[40:43]
    v_mfma_f32_16x16x32_bf16 v[28:31], v[92:95], v[132:135], v[28:31]
    v_mfma_f32_16x16x32_bf16 v[32:35], v[96:99], v[132:135], v[32:35]
    v_mfma_f32_16x16x32_bf16 v[20:23], v[100:103], v[132:135], v[20:23]
    v_mfma_f32_16x16x32_bf16 v[24:27], v[104:107], v[132:135], v[24:27]
    v_mfma_f32_16x16x32_bf16 v[12:15], v[108:111], v[132:135], v[12:15]
    v_mfma_f32_16x16x32_bf16 v[16:19], v[112:115], v[132:135], v[16:19]
    s_waitcnt lgkmcnt(0)
    v_mfma_f32_16x16x32_bf16 v[4:7], v[116:119], v[132:135], v[4:7]
    v_mfma_f32_16x16x32_bf16 v[8:11], v[120:123], v[132:135], v[8:11]
    v_mfma_f32_16x16x32_bf16 v[0:3], v[128:131], v[132:135], v[0:3]
    ds_read_b64_tr_b16 v[126:127], v165 offset:13312
    v_mfma_f32_16x16x32_bf16 v[52:55], v[76:79], v[136:139], v[52:55]
    ds_read_b64_tr_b16 v[124:125], v165 offset:12288
    v_mfma_f32_16x16x32_bf16 v[56:59], v[80:83], v[136:139], v[56:59]
    v_mfma_f32_16x16x32_bf16 v[44:47], v[84:87], v[136:139], v[44:47]
    ds_read_b128 v[140:143], v164 offset:11264
    v_mfma_f32_16x16x32_bf16 v[48:51], v[88:91], v[136:139], v[48:51]
    v_mfma_f32_16x16x32_bf16 v[36:39], v[92:95], v[136:139], v[36:39]
    v_mfma_f32_16x16x32_bf16 v[40:43], v[96:99], v[136:139], v[40:43]
    v_mfma_f32_16x16x32_bf16 v[28:31], v[100:103], v[136:139], v[28:31]
    v_mfma_f32_16x16x32_bf16 v[32:35], v[104:107], v[136:139], v[32:35]
    v_mfma_f32_16x16x32_bf16 v[20:23], v[108:111], v[136:139], v[20:23]
    v_mfma_f32_16x16x32_bf16 v[24:27], v[112:115], v[136:139], v[24:27]
    v_mfma_f32_16x16x32_bf16 v[12:15], v[116:119], v[136:139], v[12:15]
    v_mfma_f32_16x16x32_bf16 v[16:19], v[120:123], v[136:139], v[16:19]
    s_waitcnt lgkmcnt(0)
    v_mfma_f32_16x16x32_bf16 v[4:7], v[124:127], v[136:139], v[4:7]
    v_mfma_f32_16x16x32_bf16 v[8:11], v[128:131], v[136:139], v[8:11]
    v_mfma_f32_16x16x32_bf16 v[60:63], v[76:79], v[140:143], v[60:63]
    s_barrier
    v_mfma_f32_16x16x32_bf16 v[64:67], v[80:83], v[140:143], v[64:67]
    s_xor_b32 s52, s52, s53
    v_mfma_f32_16x16x32_bf16 v[52:55], v[84:87], v[140:143], v[52:55]
    ds_read_b128 v[144:147], v164 offset:12672
    v_mfma_f32_16x16x32_bf16 v[56:59], v[88:91], v[140:143], v[56:59]
    v_add_u32 v165, s52, v169
    v_mfma_f32_16x16x32_bf16 v[44:47], v[92:95], v[140:143], v[44:47]
    v_xor_b32 v166, 32, v165
    v_mfma_f32_16x16x32_bf16 v[48:51], v[96:99], v[140:143], v[48:51]
    s_add_u32 s48, s48, 1
    v_mfma_f32_16x16x32_bf16 v[36:39], v[100:103], v[140:143], v[36:39]
    s_cmp_eq_u32 s48, 7
    v_mfma_f32_16x16x32_bf16 v[40:43], v[104:107], v[140:143], v[40:43]
    s_cselect_b32 s44, s51, 0
    v_mfma_f32_16x16x32_bf16 v[28:31], v[108:111], v[140:143], v[28:31]
    s_cselect_b32 s48, 0, s48
    v_mfma_f32_16x16x32_bf16 v[32:35], v[112:115], v[140:143], v[32:35]
    s_xor_b32 s50, s50, s44
    v_mfma_f32_16x16x32_bf16 v[20:23], v[116:119], v[140:143], v[20:23]
    v_add_u32 v172, s48, v167
    v_mfma_f32_16x16x32_bf16 v[24:27], v[120:123], v[140:143], v[24:27]
    v_and_b32 v173, 4, v172
    v_mfma_f32_16x16x32_bf16 v[12:15], v[124:127], v[140:143], v[12:15]
    v_lshlrev_b32 v173, 3, v173
    v_mfma_f32_16x16x32_bf16 v[16:19], v[128:131], v[140:143], v[16:19]
    v_xor_b32 v173, v173, v168
    s_waitcnt lgkmcnt(0)
    v_mfma_f32_16x16x32_bf16 v[68:71], v[76:79], v[144:147], v[68:71]
    v_lshl_add_u32 v173, v172, 6, v173
    v_mfma_f32_16x16x32_bf16 v[72:75], v[80:83], v[144:147], v[72:75]
    v_add_u32 v170, s50, v173
    v_mfma_f32_16x16x32_bf16 v[60:63], v[84:87], v[144:147], v[60:63]
    ds_read_b128 v[148:151], v164 offset:14080
    v_mfma_f32_16x16x32_bf16 v[64:67], v[88:91], v[144:147], v[64:67]
    v_mfma_f32_16x16x32_bf16 v[52:55], v[92:95], v[144:147], v[52:55]
    v_mfma_f32_16x16x32_bf16 v[56:59], v[96:99], v[144:147], v[56:59]
    v_mfma_f32_16x16x32_bf16 v[44:47], v[100:103], v[144:147], v[44:47]
    v_mfma_f32_16x16x32_bf16 v[48:51], v[104:107], v[144:147], v[48:51]
    v_mfma_f32_16x16x32_bf16 v[36:39], v[108:111], v[144:147], v[36:39]
    v_mfma_f32_16x16x32_bf16 v[40:43], v[112:115], v[144:147], v[40:43]
    v_mfma_f32_16x16x32_bf16 v[28:31], v[116:119], v[144:147], v[28:31]
    v_mfma_f32_16x16x32_bf16 v[32:35], v[120:123], v[144:147], v[32:35]
    v_mfma_f32_16x16x32_bf16 v[20:23], v[124:127], v[144:147], v[20:23]
    v_mfma_f32_16x16x32_bf16 v[24:27], v[128:131], v[144:147], v[24:27]
    s_waitcnt lgkmcnt(0)
    v_mfma_f32_16x16x32_bf16 v[68:71], v[84:87], v[148:151], v[68:71]
    ds_read_b128 v[132:135], v164 offset:15488
    v_mfma_f32_16x16x32_bf16 v[72:75], v[88:91], v[148:151], v[72:75]
    v_mfma_f32_16x16x32_bf16 v[60:63], v[92:95], v[148:151], v[60:63]
    v_mfma_f32_16x16x32_bf16 v[64:67], v[96:99], v[148:151], v[64:67]
    v_mfma_f32_16x16x32_bf16 v[52:55], v[100:103], v[148:151], v[52:55]
    v_mfma_f32_16x16x32_bf16 v[56:59], v[104:107], v[148:151], v[56:59]
    v_mfma_f32_16x16x32_bf16 v[44:47], v[108:111], v[148:151], v[44:47]
    v_mfma_f32_16x16x32_bf16 v[48:51], v[112:115], v[148:151], v[48:51]
    v_mfma_f32_16x16x32_bf16 v[36:39], v[116:119], v[148:151], v[36:39]
    v_mfma_f32_16x16x32_bf16 v[40:43], v[120:123], v[148:151], v[40:43]
    v_mfma_f32_16x16x32_bf16 v[28:31], v[124:127], v[148:151], v[28:31]
    ds_read_b128 v[136:139], v164 offset:16896
    v_mfma_f32_16x16x32_bf16 v[32:35], v[128:131], v[148:151], v[32:35]
    s_waitcnt lgkmcnt(1)
    v_mfma_f32_16x16x32_bf16 v[68:71], v[92:95], v[132:135], v[68:71]
    v_mfma_f32_16x16x32_bf16 v[72:75], v[96:99], v[132:135], v[72:75]
    v_mfma_f32_16x16x32_bf16 v[60:63], v[100:103], v[132:135], v[60:63]
    v_mfma_f32_16x16x32_bf16 v[64:67], v[104:107], v[132:135], v[64:67]
    v_mfma_f32_16x16x32_bf16 v[52:55], v[108:111], v[132:135], v[52:55]
    v_mfma_f32_16x16x32_bf16 v[56:59], v[112:115], v[132:135], v[56:59]
    v_mfma_f32_16x16x32_bf16 v[44:47], v[116:119], v[132:135], v[44:47]
    ds_read_b128 v[140:143], v164 offset:18304
    v_mfma_f32_16x16x32_bf16 v[48:51], v[120:123], v[132:135], v[48:51]
    v_mfma_f32_16x16x32_bf16 v[36:39], v[124:127], v[132:135], v[36:39]
    ds_read_b128 v[148:151], v164 offset:21120
    v_mfma_f32_16x16x32_bf16 v[40:43], v[128:131], v[132:135], v[40:43]
    ds_read_b128 v[144:147], v164 offset:19712
    s_waitcnt lgkmcnt(3)
    v_mfma_f32_16x16x32_bf16 v[68:71], v[100:103], v[136:139], v[68:71]
    ds_read_b64_tr_b16 v[98:99], v166 offset:5120
    v_mfma_f32_16x16x32_bf16 v[72:75], v[104:107], v[136:139], v[72:75]
    ds_read_b64_tr_b16 v[90:91], v166 offset:3072
    v_mfma_f32_16x16x32_bf16 v[60:63], v[108:111], v[136:139], v[60:63]
    ds_read_b64_tr_b16 v[88:89], v166 offset:2048
    v_mfma_f32_16x16x32_bf16 v[64:67], v[112:115], v[136:139], v[64:67]
    ds_read_b64_tr_b16 v[86:87], v165 offset:3072
    v_mfma_f32_16x16x32_bf16 v[52:55], v[116:119], v[136:139], v[52:55]
    ds_read_b64_tr_b16 v[82:83], v166 offset:1024
    v_mfma_f32_16x16x32_bf16 v[56:59], v[120:123], v[136:139], v[56:59]
    ds_read_b64_tr_b16 v[80:81], v166 offset:0
    v_mfma_f32_16x16x32_bf16 v[44:47], v[124:127], v[136:139], v[44:47]
    ds_read_b128 v[132:135], v170 offset:1408
    v_mfma_f32_16x16x32_bf16 v[48:51], v[128:131], v[136:139], v[48:51]
    ds_read_b64_tr_b16 v[78:79], v165 offset:1024
    s_waitcnt lgkmcnt(8)
    v_mfma_f32_16x16x32_bf16 v[68:71], v[108:111], v[140:143], v[68:71]
    ds_read_b64_tr_b16 v[76:77], v165 offset:0
    v_mfma_f32_16x16x32_bf16 v[72:75], v[112:115], v[140:143], v[72:75]
    v_mov_b32 v164, v170
    v_mfma_f32_16x16x32_bf16 v[60:63], v[116:119], v[140:143], v[60:63]
    ds_read_b128 v[136:139], v170 offset:2816
    v_mfma_f32_16x16x32_bf16 v[64:67], v[120:123], v[140:143], v[64:67]
    s_add_u32 s49, s49, 1
    v_mfma_f32_16x16x32_bf16 v[52:55], v[124:127], v[140:143], v[52:55]
    ds_read_b64_tr_b16 v[84:85], v165 offset:2048
    v_mfma_f32_16x16x32_bf16 v[56:59], v[128:131], v[140:143], v[56:59]
    s_cmp_lt_u32 s49, 20
    v_mfma_f32_16x16x32_bf16 v[68:71], v[116:119], v[144:147], v[68:71]
    ds_read_b128 v[140:143], v170 offset:4224
    v_mfma_f32_16x16x32_bf16 v[72:75], v[120:123], v[144:147], v[72:75]
    v_mfma_f32_16x16x32_bf16 v[60:63], v[124:127], v[144:147], v[60:63]
    ds_read_b64_tr_b16 v[96:97], v166 offset:4096
    v_mfma_f32_16x16x32_bf16 v[64:67], v[128:131], v[144:147], v[64:67]
    ds_read_b64_tr_b16 v[94:95], v165 offset:5120
    v_mfma_f32_16x16x32_bf16 v[68:71], v[124:127], v[148:151], v[68:71]
    ds_read_b64_tr_b16 v[92:93], v165 offset:4096
    s_waitcnt lgkmcnt(5)
    v_mfma_f32_16x16x32_bf16 v[72:75], v[128:131], v[148:151], v[72:75]
    s_cbranch_scc1 C_Q3_LOOP
    v_mfma_f32_16x16x32_bf16 v[4:7], v[76:79], v[132:135], v[4:7]
    ds_read_b128 v[144:147], v164 offset:5632
    v_mfma_f32_16x16x32_bf16 v[8:11], v[80:83], v[132:135], v[8:11]
    v_mfma_f32_16x16x32_bf16 v[12:15], v[76:79], v[136:139], v[12:15]
    v_mfma_f32_16x16x32_bf16 v[16:19], v[80:83], v[136:139], v[16:19]
    s_waitcnt lgkmcnt(4)
    v_mfma_f32_16x16x32_bf16 v[4:7], v[84:87], v[136:139], v[4:7]
    ds_read_b64_tr_b16 v[106:107], v166 offset:7168
    v_mfma_f32_16x16x32_bf16 v[8:11], v[88:91], v[136:139], v[8:11]
    ds_read_b64_tr_b16 v[102:103], v165 offset:7168
    v_mfma_f32_16x16x32_bf16 v[20:23], v[76:79], v[140:143], v[20:23]
    ds_read_b64_tr_b16 v[100:101], v165 offset:6144
    v_mfma_f32_16x16x32_bf16 v[24:27], v[80:83], v[140:143], v[24:27]
    ds_read_b64_tr_b16 v[104:105], v166 offset:6144
    v_mfma_f32_16x16x32_bf16 v[12:15], v[84:87], v[140:143], v[12:15]
    ds_read_b128 v[148:151], v164 offset:7040
    v_mfma_f32_16x16x32_bf16 v[16:19], v[88:91], v[140:143], v[16:19]
    s_waitcnt lgkmcnt(5)
    v_mfma_f32_16x16x32_bf16 v[4:7], v[92:95], v[140:143], v[4:7]
    v_mfma_f32_16x16x32_bf16 v[8:11], v[96:99], v[140:143], v[8:11]
    v_mfma_f32_16x16x32_bf16 v[28:31], v[76:79], v[144:147], v[28:31]
    v_mfma_f32_16x16x32_bf16 v[32:35], v[80:83], v[144:147], v[32:35]
    v_mfma_f32_16x16x32_bf16 v[20:23], v[84:87], v[144:147], v[20:23]
    v_mfma_f32_16x16x32_bf16 v[24:27], v[88:91], v[144:147], v[24:27]
    v_mfma_f32_16x16x32_bf16 v[12:15], v[92:95], v[144:147], v[12:15]
    ds_read_b128 v[152:155], v164 offset:8448
    v_mfma_f32_16x16x32_bf16 v[16:19], v[96:99], v[144:147], v[16:19]
    s_waitcnt lgkmcnt(1)
    v_mfma_f32_16x16x32_bf16 v[4:7], v[100:103], v[144:147], v[4:7]
    v_mfma_f32_16x16x32_bf16 v[8:11], v[104:107], v[144:147], v[8:11]
    v_mfma_f32_16x16x32_bf16 v[36:39], v[76:79], v[148:151], v[36:39]
    v_mfma_f32_16x16x32_bf16 v[40:43], v[80:83], v[148:151], v[40:43]
    v_mfma_f32_16x16x32_bf16 v[28:31], v[84:87], v[148:151], v[28:31]
    v_mfma_f32_16x16x32_bf16 v[32:35], v[88:91], v[148:151], v[32:35]
    v_mfma_f32_16x16x32_bf16 v[20:23], v[92:95], v[148:151], v[20:23]
    ds_read_b128 v[156:159], v164 offset:9856
    v_mfma_f32_16x16x32_bf16 v[24:27], v[96:99], v[148:151], v[24:27]
    v_mfma_f32_16x16x32_bf16 v[12:15], v[100:103], v[148:151], v[12:15]
    v_mfma_f32_16x16x32_bf16 v[16:19], v[104:107], v[148:151], v[16:19]
    s_waitcnt lgkmcnt(1)
    v_mfma_f32_16x16x32_bf16 v[44:47], v[76:79], v[152:155], v[44:47]
    v_mfma_f32_16x16x32_bf16 v[48:51], v[80:83], v[152:155], v[48:51]
    v_mfma_f32_16x16x32_bf16 v[36:39], v[84:87], v[152:155], v[36:39]
    v_mfma_f32_16x16x32_bf16 v[40:43], v[88:91], v[152:155], v[40:43]
    ds_read_b64_tr_b16 v[126:127], v165 offset:13312
    v_mfma_f32_16x16x32_bf16 v[28:31], v[92:95], v[152:155], v[28:31]
    ds_read_b128 v[160:163], v164 offset:11264
    v_mfma_f32_16x16x32_bf16 v[32:35], v[96:99], v[152:155], v[32:35]
    ds_read_b64_tr_b16 v[124:125], v165 offset:12288
    v_mfma_f32_16x16x32_bf16 v[20:23], v[100:103], v[152:155], v[20:23]
    ds_read_b64_tr_b16 v[130:131], v166 offset:13312
    v_mfma_f32_16x16x32_bf16 v[24:27], v[104:107], v[152:155], v[24:27]
    ds_read_b64_tr_b16 v[128:129], v166 offset:12288
    s_waitcnt lgkmcnt(5)
    v_mfma_f32_16x16x32_bf16 v[52:55], v[76:79], v[156:159], v[52:55]
    ds_read_b64_tr_b16 v[118:119], v165 offset:11264
    v_mfma_f32_16x16x32_bf16 v[56:59], v[80:83], v[156:159], v[56:59]
    ds_read_b64_tr_b16 v[116:117], v165 offset:10240
    v_mfma_f32_16x16x32_bf16 v[44:47], v[84:87], v[156:159], v[44:47]
    ds_read_b64_tr_b16 v[122:123], v166 offset:11264
    v_mfma_f32_16x16x32_bf16 v[48:51], v[88:91], v[156:159], v[48:51]
    ds_read_b64_tr_b16 v[120:121], v166 offset:10240
    v_mfma_f32_16x16x32_bf16 v[36:39], v[92:95], v[156:159], v[36:39]
    ds_read_b128 v[132:135], v164 offset:12672
    v_mfma_f32_16x16x32_bf16 v[40:43], v[96:99], v[156:159], v[40:43]
    ds_read_b64_tr_b16 v[110:111], v165 offset:9216
    v_mfma_f32_16x16x32_bf16 v[28:31], v[100:103], v[156:159], v[28:31]
    ds_read_b64_tr_b16 v[108:109], v165 offset:8192
    v_mfma_f32_16x16x32_bf16 v[32:35], v[104:107], v[156:159], v[32:35]
    ds_read_b64_tr_b16 v[114:115], v166 offset:9216
    s_waitcnt lgkmcnt(8)
    v_mfma_f32_16x16x32_bf16 v[60:63], v[76:79], v[160:163], v[60:63]
    ds_read_b64_tr_b16 v[112:113], v166 offset:8192
    v_mfma_f32_16x16x32_bf16 v[64:67], v[80:83], v[160:163], v[64:67]
    v_mfma_f32_16x16x32_bf16 v[52:55], v[84:87], v[160:163], v[52:55]
    v_mfma_f32_16x16x32_bf16 v[56:59], v[88:91], v[160:163], v[56:59]
    v_mfma_f32_16x16x32_bf16 v[44:47], v[92:95], v[160:163], v[44:47]
    ds_read_b128 v[136:139], v164 offset:14080
    v_mfma_f32_16x16x32_bf16 v[48:51], v[96:99], v[160:163], v[48:51]
    v_mfma_f32_16x16x32_bf16 v[36:39], v[100:103], v[160:163], v[36:39]
    v_mfma_f32_16x16x32_bf16 v[40:43], v[104:107], v[160:163], v[40:43]
    s_waitcnt lgkmcnt(2)
    v_mfma_f32_16x16x32_bf16 v[68:71], v[76:79], v[132:135], v[68:71]
    v_mfma_f32_16x16x32_bf16 v[72:75], v[80:83], v[132:135], v[72:75]
    v_mfma_f32_16x16x32_bf16 v[60:63], v[84:87], v[132:135], v[60:63]
    ds_read_b128 v[140:143], v164 offset:15488
    v_mfma_f32_16x16x32_bf16 v[64:67], v[88:91], v[132:135], v[64:67]
    v_mfma_f32_16x16x32_bf16 v[52:55], v[92:95], v[132:135], v[52:55]
    v_mfma_f32_16x16x32_bf16 v[56:59], v[96:99], v[132:135], v[56:59]
    v_mfma_f32_16x16x32_bf16 v[44:47], v[100:103], v[132:135], v[44:47]
    v_mfma_f32_16x16x32_bf16 v[48:51], v[104:107], v[132:135], v[48:51]
    s_waitcnt lgkmcnt(2)
    s_barrier
    s_waitcnt lgkmcnt(1)
    v_mfma_f32_16x16x32_bf16 v[68:71], v[84:87], v[136:139], v[68:71]
    v_mfma_f32_16x16x32_bf16 v[72:75], v[88:91], v[136:139], v[72:75]
    v_mfma_f32_16x16x32_bf16 v[60:63], v[92:95], v[136:139], v[60:63]
    v_mfma_f32_16x16x32_bf16 v[64:67], v[96:99], v[136:139], v[64:67]
    v_mfma_f32_16x16x32_bf16 v[52:55], v[100:103], v[136:139], v[52:55]
    v_mfma_f32_16x16x32_bf16 v[56:59], v[104:107], v[136:139], v[56:59]
    s_waitcnt lgkmcnt(0)
    v_mfma_f32_16x16x32_bf16 v[68:71], v[92:95], v[140:143], v[68:71]
    ds_read_b128 v[136:139], v164 offset:16896
    v_mfma_f32_16x16x32_bf16 v[72:75], v[96:99], v[140:143], v[72:75]
    v_mfma_f32_16x16x32_bf16 v[60:63], v[100:103], v[140:143], v[60:63]
    v_mfma_f32_16x16x32_bf16 v[64:67], v[104:107], v[140:143], v[64:67]
    s_waitcnt lgkmcnt(0)
    v_mfma_f32_16x16x32_bf16 v[68:71], v[100:103], v[136:139], v[68:71]
    v_mfma_f32_16x16x32_bf16 v[72:75], v[104:107], v[136:139], v[72:75]
    v_mfma_f32_16x16x32_bf16 v[0:3], v[112:115], v[144:147], v[0:3]
    v_mfma_f32_16x16x32_bf16 v[0:3], v[120:123], v[148:151], v[0:3]
    v_mfma_f32_16x16x32_bf16 v[0:3], v[128:131], v[152:155], v[0:3]
    v_mfma_f32_16x16x32_bf16 v[4:7], v[108:111], v[148:151], v[4:7]
    v_mfma_f32_16x16x32_bf16 v[8:11], v[112:115], v[148:151], v[8:11]
    v_mfma_f32_16x16x32_bf16 v[4:7], v[116:119], v[152:155], v[4:7]
    v_mfma_f32_16x16x32_bf16 v[8:11], v[120:123], v[152:155], v[8:11]
    v_mfma_f32_16x16x32_bf16 v[4:7], v[124:127], v[156:159], v[4:7]
    s_nop 2
    ds_write_b128 v184, v[0:3] offset:1024
    v_mfma_f32_16x16x32_bf16 v[8:11], v[128:131], v[156:159], v[8:11]
    v_mfma_f32_16x16x32_bf16 v[12:15], v[108:111], v[152:155], v[12:15]
    v_mfma_f32_16x16x32_bf16 v[16:19], v[112:115], v[152:155], v[16:19]
    v_mfma_f32_16x16x32_bf16 v[12:15], v[116:119], v[156:159], v[12:15]
    v_mfma_f32_16x16x32_bf16 v[16:19], v[120:123], v[156:159], v[16:19]
    v_mfma_f32_16x16x32_bf16 v[12:15], v[124:127], v[160:163], v[12:15]
    ds_read_b128 v[144:147], v164 offset:14080
    v_cvt_pk_bf16_f32 v4, v4, v5
    v_cvt_pk_bf16_f32 v5, v6, v7
    v_mfma_f32_16x16x32_bf16 v[16:19], v[128:131], v[160:163], v[16:19]
    ds_write_b64 v181, v[4:5] offset:1280
    v_cvt_pk_bf16_f32 v8, v8, v9
    v_mfma_f32_16x16x32_bf16 v[20:23], v[108:111], v[156:159], v[20:23]
    v_cvt_pk_bf16_f32 v9, v10, v11
    ds_write_b64 v181, v[8:9] offset:1312
    v_mfma_f32_16x16x32_bf16 v[24:27], v[112:115], v[156:159], v[24:27]
    ds_read_b128 v[188:191], v182 offset:1280
    v_mfma_f32_16x16x32_bf16 v[20:23], v[116:119], v[160:163], v[20:23]
    v_mfma_f32_16x16x32_bf16 v[24:27], v[120:123], v[160:163], v[24:27]
    v_mfma_f32_16x16x32_bf16 v[20:23], v[124:127], v[132:135], v[20:23]
    v_cvt_pk_bf16_f32 v12, v12, v13
    v_cvt_pk_bf16_f32 v13, v14, v15
    v_mfma_f32_16x16x32_bf16 v[24:27], v[128:131], v[132:135], v[24:27]
    ds_write_b64 v181, v[12:13] offset:2560
    v_cvt_pk_bf16_f32 v16, v16, v17
    v_mfma_f32_16x16x32_bf16 v[28:31], v[108:111], v[160:163], v[28:31]
    v_cvt_pk_bf16_f32 v17, v18, v19
    ds_write_b64 v181, v[16:17] offset:2592
    v_mfma_f32_16x16x32_bf16 v[32:35], v[112:115], v[160:163], v[32:35]
    ds_read_b128 v[192:195], v182 offset:2560
    s_mov_b32 s57, 86016
    v_mfma_f32_16x16x32_bf16 v[28:31], v[116:119], v[132:135], v[28:31]
    s_waitcnt lgkmcnt(3)
    buffer_store_dwordx4 v[188:191], v183, s[20:23], s57 offen
    s_waitcnt lgkmcnt(1)
    s_barrier
    v_mfma_f32_16x16x32_bf16 v[32:35], v[120:123], v[132:135], v[32:35]
    v_mfma_f32_16x16x32_bf16 v[28:31], v[124:127], v[144:147], v[28:31]
    v_cvt_pk_bf16_f32 v20, v20, v21
    v_cvt_pk_bf16_f32 v21, v22, v23
    v_mfma_f32_16x16x32_bf16 v[32:35], v[128:131], v[144:147], v[32:35]
    ds_write_b64 v181, v[20:21] offset:3840
    v_cvt_pk_bf16_f32 v24, v24, v25
    v_mfma_f32_16x16x32_bf16 v[36:39], v[108:111], v[132:135], v[36:39]
    v_cvt_pk_bf16_f32 v25, v26, v27
    ds_write_b64 v181, v[24:25] offset:3872
    v_mfma_f32_16x16x32_bf16 v[40:43], v[112:115], v[132:135], v[40:43]
    ds_read_b128 v[196:199], v182 offset:3840
    s_mov_b32 s57, 172032
    v_mfma_f32_16x16x32_bf16 v[36:39], v[116:119], v[144:147], v[36:39]
    s_waitcnt lgkmcnt(3)
    buffer_store_dwordx4 v[192:195], v183, s[20:23], s57 offen
    v_mfma_f32_16x16x32_bf16 v[40:43], v[120:123], v[144:147], v[40:43]
    v_mfma_f32_16x16x32_bf16 v[36:39], v[124:127], v[140:143], v[36:39]
    ds_read_b128 v[148:151], v164 offset:18304
    v_cvt_pk_bf16_f32 v28, v28, v29
    v_cvt_pk_bf16_f32 v29, v30, v31
    v_mfma_f32_16x16x32_bf16 v[40:43], v[128:131], v[140:143], v[40:43]
    ds_write_b64 v181, v[28:29] offset:5120
    v_cvt_pk_bf16_f32 v32, v32, v33
    v_mfma_f32_16x16x32_bf16 v[44:47], v[108:111], v[144:147], v[44:47]
    v_cvt_pk_bf16_f32 v33, v34, v35
    ds_write_b64 v181, v[32:33] offset:5152
    v_mfma_f32_16x16x32_bf16 v[48:51], v[112:115], v[144:147], v[48:51]
    ds_read_b128 v[200:203], v182 offset:5120
    s_mov_b32 s57, 258048
    v_mfma_f32_16x16x32_bf16 v[44:47], v[116:119], v[140:143], v[44:47]
    s_waitcnt lgkmcnt(4)
    buffer_store_dwordx4 v[196:199], v183, s[20:23], s57 offen
    v_mfma_f32_16x16x32_bf16 v[48:51], v[120:123], v[140:143], v[48:51]
    v_mfma_f32_16x16x32_bf16 v[44:47], v[124:127], v[136:139], v[44:47]
    ds_read_b128 v[152:155], v164 offset:19712
    v_cvt_pk_bf16_f32 v36, v36, v37
    v_cvt_pk_bf16_f32 v37, v38, v39
    v_mfma_f32_16x16x32_bf16 v[48:51], v[128:131], v[136:139], v[48:51]
    ds_write_b64 v181, v[36:37] offset:0
    v_cvt_pk_bf16_f32 v40, v40, v41
    v_mfma_f32_16x16x32_bf16 v[52:55], v[108:111], v[140:143], v[52:55]
    v_cvt_pk_bf16_f32 v41, v42, v43
    ds_write_b64 v181, v[40:41] offset:32
    v_mfma_f32_16x16x32_bf16 v[56:59], v[112:115], v[140:143], v[56:59]
    ds_read_b128 v[188:191], v182 offset:0
    s_mov_b32 s57, 344064
    v_mfma_f32_16x16x32_bf16 v[52:55], v[116:119], v[136:139], v[52:55]
    s_waitcnt lgkmcnt(4)
    buffer_store_dwordx4 v[200:203], v183, s[20:23], s57 offen
    v_mfma_f32_16x16x32_bf16 v[56:59], v[120:123], v[136:139], v[56:59]
    v_mfma_f32_16x16x32_bf16 v[52:55], v[124:127], v[148:151], v[52:55]
    ds_read_b128 v[156:159], v164 offset:21120
    v_cvt_pk_bf16_f32 v44, v44, v45
    v_cvt_pk_bf16_f32 v45, v46, v47
    v_mfma_f32_16x16x32_bf16 v[56:59], v[128:131], v[148:151], v[56:59]
    ds_write_b64 v181, v[44:45] offset:1280
    v_cvt_pk_bf16_f32 v48, v48, v49
    v_mfma_f32_16x16x32_bf16 v[60:63], v[108:111], v[136:139], v[60:63]
    v_cvt_pk_bf16_f32 v49, v50, v51
    ds_write_b64 v181, v[48:49] offset:1312
    v_mfma_f32_16x16x32_bf16 v[64:67], v[112:115], v[136:139], v[64:67]
    ds_read_b128 v[192:195], v182 offset:1280
    s_mov_b32 s57, 430080
    v_mfma_f32_16x16x32_bf16 v[60:63], v[116:119], v[148:151], v[60:63]
    s_waitcnt lgkmcnt(4)
    buffer_store_dwordx4 v[188:191], v183, s[20:23], s57 offen
    v_mfma_f32_16x16x32_bf16 v[64:67], v[120:123], v[148:151], v[64:67]
    v_mfma_f32_16x16x32_bf16 v[60:63], v[124:127], v[152:155], v[60:63]
    v_cvt_pk_bf16_f32 v52, v52, v53
    v_cvt_pk_bf16_f32 v53, v54, v55
    v_mfma_f32_16x16x32_bf16 v[64:67], v[128:131], v[152:155], v[64:67]
    ds_write_b64 v181, v[52:53] offset:2560
    v_cvt_pk_bf16_f32 v56, v56, v57
    v_mfma_f32_16x16x32_bf16 v[68:71], v[108:111], v[148:151], v[68:71]
    v_cvt_pk_bf16_f32 v57, v58, v59
    ds_write_b64 v181, v[56:57] offset:2592
    v_mfma_f32_16x16x32_bf16 v[72:75], v[112:115], v[148:151], v[72:75]
    ds_read_b128 v[196:199], v182 offset:2560
    s_mov_b32 s57, 516096
    v_mfma_f32_16x16x32_bf16 v[68:71], v[116:119], v[152:155], v[68:71]
    s_waitcnt lgkmcnt(3)
    buffer_store_dwordx4 v[192:195], v183, s[20:23], s57 offen
    v_mfma_f32_16x16x32_bf16 v[72:75], v[120:123], v[152:155], v[72:75]
    v_mfma_f32_16x16x32_bf16 v[68:71], v[124:127], v[156:159], v[68:71]
    v_cvt_pk_bf16_f32 v60, v60, v61
    v_cvt_pk_bf16_f32 v61, v62, v63
    v_mfma_f32_16x16x32_bf16 v[72:75], v[128:131], v[156:159], v[72:75]
    ds_write_b64 v181, v[60:61] offset:3840
    v_cvt_pk_bf16_f32 v64, v64, v65
    v_cvt_pk_bf16_f32 v65, v66, v67
    ds_write_b64 v181, v[64:65] offset:3872
    ds_read_b128 v[200:203], v182 offset:3840
    s_mov_b32 s57, 602112
    s_waitcnt lgkmcnt(3)
    buffer_store_dwordx4 v[196:199], v183, s[20:23], s57 offen
    v_cvt_pk_bf16_f32 v68, v68, v69
    v_cvt_pk_bf16_f32 v69, v70, v71
    ds_write_b64 v181, v[68:69] offset:5120
    v_cvt_pk_bf16_f32 v72, v72, v73
    v_cvt_pk_bf16_f32 v73, v74, v75
    ds_write_b64 v181, v[72:73] offset:5152
    ds_read_b128 v[188:191], v182 offset:5120
    s_mov_b32 s57, 688128
    s_waitcnt lgkmcnt(3)
    buffer_store_dwordx4 v[200:203], v183, s[20:23], s57 offen
    s_mov_b32 s57, 774144
    s_waitcnt lgkmcnt(0)
    buffer_store_dwordx4 v[188:191], v183, s[20:23], s57 offen
    s_endpgm
L_CODE_END:
.section .rodata,"a"
.p2align 6
.amdhsa_kernel standalone__dilated_atrous__vision_kernel
  .amdhsa_next_free_vgpr 208
  .amdhsa_next_free_sgpr 96
  .amdhsa_accum_offset 208
  .amdhsa_group_segment_fixed_size 0
  .amdhsa_kernarg_size 40
  .amdhsa_user_sgpr_count 2
  .amdhsa_user_sgpr_kernarg_segment_ptr 1
  .amdhsa_system_sgpr_workgroup_id_x 1
.end_amdhsa_kernel
```
